```python
import torch

def _softmax(x, axis=-1):
    return torch.softmax(x, dim=axis)
def _gelu(x):
    return torch.nn.functional.gelu(x, approximate="tanh")
def _silu(x):
    return torch.nn.functional.silu(x)
def _sigmoid(x):
    return torch.sigmoid(x)
def _layernorm(x, axis=-1, eps=1e-5):
    m = x.mean(dim=axis, keepdim=True)
    v = x.var(dim=axis, keepdim=True, unbiased=False)
    return (x - m) / torch.sqrt(v + eps)
def _scatter_add(tgt, idx, src, axis=0):
    return tgt.clone().index_add_(axis, idx, src)
def _segment_sum(src, seg, n):
    out = torch.zeros((n,) + src.shape[1:], dtype=src.dtype)
    return out.index_add_(0, seg, src)
def _pad(x, pw):
    flat = tuple(v for pair in reversed(pw) for v in pair)
    return torch.nn.functional.pad(x, flat)

kernel_name = 'parallel_sum__ssm_conv_s4__dense_activation_relu__prompt'

def setup_inputs():

    _w = (lambda a: (lambda t: t.to(torch.bfloat16) if t.is_floating_point() else t)(torch.as_tensor(a)))
    def _A_setup():
        B, L, D, N = 1, 2048, 576, 128
        A_re = -(lambda _x: torch.exp(torch.as_tensor(_x)))((lambda *s: torch.randn(*s, dtype=torch.bfloat16) * 3.2)(D, N))
        A_im = torch.pi * (lambda *s: torch.randn(*s, dtype=torch.bfloat16) * 0.2)(D, N)
        B_re = (lambda *s: torch.randn(*s, dtype=torch.bfloat16) * 0.4)(D, N)
        B_im = (lambda *s: torch.randn(*s, dtype=torch.bfloat16) * 0.4)(D, N)
        C_re = (lambda *s: torch.randn(*s, dtype=torch.bfloat16) * 0.4)(D, N)
        C_im = (lambda *s: torch.randn(*s, dtype=torch.bfloat16) * 0.4)(D, N)
        log_dt = (lambda *s: torch.randn(*s, dtype=torch.bfloat16) * 0.2)(D) * 0.5 - 4.0
        Dskip = (lambda *s: torch.randn(*s, dtype=torch.bfloat16) * 0.4)(D)
        return {
            "u": _w((lambda *s: torch.randn(*s, dtype=torch.bfloat16) * 0.05)(B, L, D)),
            "A_re": _w(A_re),
            "A_im": _w(A_im),
            "B_re": _w(B_re),
            "B_im": _w(B_im),
            "C_re": _w(C_re),
            "C_im": _w(C_im),
            "log_dt": _w(log_dt),
            "Dskip": _w(Dskip),
        }
    _A_in = _A_setup()

    def _B_setup():
        B, S, D, Dff = 1, 2048, 576, 4608
        return {
            "x": _w((lambda *s: torch.randn(*s, dtype=torch.bfloat16) * 0.05)(B, S, D)),
            "w1": _w((lambda *s: torch.randn(*s, dtype=torch.bfloat16) * 0.05)(D, Dff)),
            "w2": _w((lambda *s: torch.randn(*s, dtype=torch.bfloat16) * 0.05)(Dff, D)),
        }
    _B_in = _B_setup()

    return {
        "A_u": _A_in["u"],
        "A_A_re": _A_in["A_re"],
        "A_A_im": _A_in["A_im"],
        "A_B_re": _A_in["B_re"],
        "A_B_im": _A_in["B_im"],
        "A_C_re": _A_in["C_re"],
        "A_C_im": _A_in["C_im"],
        "A_log_dt": _A_in["log_dt"],
        "A_Dskip": _A_in["Dskip"],
        "B_x": _B_in["x"],
        "B_w1": _B_in["w1"],
        "B_w2": _B_in["w2"],
    }

def reference(A_u, A_A_re, A_A_im, A_B_re, A_B_im, A_C_re, A_C_im, A_log_dt, A_Dskip, B_x, B_w1, B_w2):
    def _A_ref(u, A_re, A_im, B_re, B_im, C_re, C_im, log_dt, Dskip):
        Bsz, L, D = u.shape
        dt = torch.exp(log_dt)[:, None]
        A = A_re + 1j * A_im
        Bc = B_re + 1j * B_im
        Cc = C_re + 1j * C_im
        logdA = dt * A
        dB = dt * Bc
        l = (lambda x, dt: x.to(dt))(torch.arange(L), A_re.dtype)
        P = torch.exp(logdA[:, :, None] * l[None, None, :])
        K = torch.einsum("dn,dnl,dn->dl", Cc, P, dB).real
        L2 = 2 * L
        Kp = _pad(K, ((0, 0), (0, L)))
        up = (lambda x, *d: x.permute(*d))(u, 0, 2, 1)
        up = _pad(up, ((0, 0), (0, 0), (0, L)))
        Kf = (lambda x, axes=(-2,-1): torch.fft.rfft2(x.float(), dim=axes))(Kp[:, None, :], axes=(-2, -1))
        Uf = (lambda x, axes=(-2,-1): torch.fft.rfft2(x.float(), dim=axes))(up[:, :, None, :], axes=(-2, -1))
        Yf = Uf * Kf[None, :, :, :]
        y = (lambda x, s, axes=(-2,-1): torch.fft.irfft2(x, s=s, dim=axes).to(torch.bfloat16))(Yf, (1, L2), axes=(-2, -1))[:, :, 0, :L]
        y = (lambda x, *d: x.permute(*d))(y, 0, 2, 1) + u * Dskip[None, None, :]
        return y

    def _B_ref(x, w1, w2):
        h = torch.einsum("bsd,df->bsf", x, w1)
        zero = torch.zeros_like(h)
        h = torch.maximum(h, zero)
        return torch.einsum("bsf,fd->bsd", h, w2)

    x = A_u
    xn = _layernorm(x, axis=-1)
    return x + _A_ref(xn, A_A_re, A_A_im, A_B_re, A_B_im, A_C_re, A_C_im, A_log_dt, A_Dskip) + _B_ref(xn, B_w1, B_w2)
```

```asm
; @launch grid=(256,1,1) block=(256,1,1) lds=163840
.amdgcn_target "amdgcn-amd-amdhsa--gfx950"
.text
.globl parallel_sum__ssm_conv_s4__dense_activation_relu__prompt_kernel
.p2align 12
.p2align 8
.type parallel_sum__ssm_conv_s4__dense_activation_relu__prompt_kernel,@function
parallel_sum__ssm_conv_s4__dense_activation_relu__prompt_kernel:
    s_cmp_ge_u32 s2, 256
    s_cbranch_scc1 L_exit
    s_load_dwordx16 s[36:51], s[0:1], 0
    s_load_dwordx8 s[52:59], s[0:1], 64
    s_load_dwordx4 s[60:63], s[0:1], 96
    s_load_dwordx2 s[64:65], s[0:1], 112
    s_getpc_b64 s[12:13]
L_pc:
    s_lshr_b32 s24, s2, 3
    v_lshrrev_b32 v41, 4, v0
    s_sub_u32 s12, s12, L_pc-parallel_sum__ssm_conv_s4__dense_activation_relu__prompt_kernel
    s_subb_u32 s13, s13, 0
    s_mov_b32 s14, L_code_end-parallel_sum__ssm_conv_s4__dense_activation_relu__prompt_kernel
    s_mov_b32 s15, 0x00020000
    v_lshlrev_b32 v41, 7, v41
    s_lshl_b32 s31, s24, 11
    v_lshrrev_b32 v1, 6, v0
    buffer_load_dword a200, v41, s[12:15], s31 offen
    v_and_b32 v0, 63, v0
    v_readfirstlane_b32 s3, v1
    s_and_b32 s23, s2, 7
    s_cmp_lt_u32 s24, 8
    s_cbranch_scc1 L_ssm
    s_sub_u32 s24, s24, 8
    s_sub_u32 s2, s2, 64
    s_mul_i32 s88, s24, 43
    s_lshr_b32 s88, s88, 7
    s_mul_i32 s89, s88, 3
    s_sub_u32 s66, s24, s89
    s_and_b32 s89, s23, 1
    s_lshl_b32 s89, s89, 3
    s_add_u32 s89, s89, s88
    s_lshr_b32 s67, s23, 1
    s_lshl_b32 s68, s89, 2
    s_add_u32 s68, s68, s3
    s_mul_i32 s71, s67, 3
    s_add_u32 s71, s71, s66
    s_mul_i32 s69, s68, 36864
    s_mul_i32 s86, s88, 43
    s_lshr_b32 s86, s86, 7
    s_add_u32 s88, s88, s66
    s_mul_i32 s89, s88, 43
    s_lshr_b32 s89, s89, 7
    s_mul_i32 s89, s89, 3
    s_sub_u32 s87, s88, s89
    s_mov_b32 s88, s86
    s_lshl_b32 s91, s88, 7
    s_add_u32 s88, s88, 1
    s_cmp_eq_u32 s88, 3
    s_cselect_b32 s88, 0, s88
    s_lshl_b32 s92, s88, 7
    s_add_u32 s88, s88, 1
    s_cmp_eq_u32 s88, 3
    s_cselect_b32 s88, 0, s88
    s_lshl_b32 s93, s88, 7
    s_mov_b32 s88, s87
    s_mul_i32 s89, s88, 589824
    s_add_u32 s74, s89, s91
    s_add_u32 s75, s89, s92
    s_add_u32 s76, s89, s93
    s_lshl_b32 s89, s88, 7
    s_add_u32 s83, s89, s69
    s_add_u32 s88, s88, 1
    s_cmp_eq_u32 s88, 3
    s_cselect_b32 s88, 0, s88
    s_mul_i32 s89, s88, 589824
    s_add_u32 s77, s89, s91
    s_add_u32 s78, s89, s92
    s_add_u32 s79, s89, s93
    s_lshl_b32 s89, s88, 7
    s_add_u32 s84, s89, s69
    s_add_u32 s88, s88, 1
    s_cmp_eq_u32 s88, 3
    s_cselect_b32 s88, 0, s88
    s_mul_i32 s89, s88, 589824
    s_add_u32 s80, s89, s91
    s_add_u32 s81, s89, s92
    s_add_u32 s82, s89, s93
    s_lshl_b32 s89, s88, 7
    s_add_u32 s85, s89, s69
    v_lshlrev_b32 v1, 4, v0
    v_lshrrev_b32 v20, 3, v0
    v_and_b32 v21, 7, v0
    v_lshrrev_b32 v22, 1, v20
    v_xor_b32 v22, v22, v21
    v_mul_u32_u24 v23, 1152, v20
    v_lshl_add_u32 v54, v22, 4, v23
    v_xor_b32 v22, 4, v22
    v_lshl_add_u32 v55, v22, 4, v23
    v_add_u32 v55, 8192, v55
    v_add_u32 v56, 16384, v54
    v_add_u32 v57, 16384, v55
    s_lshl_b32 s70, s3, 12
    s_add_u32 s70, s70, 98304
    s_lshl_b32 s72, s3, 11
    s_mul_i32 s73, s3, 6144
    v_bfe_u32 v22, v0, 4, 1
    v_lshlrev_b32 v22, 2, v22
    v_xor_b32 v21, v21, v22
    v_lshlrev_b32 v21, 4, v21
    v_mul_u32_u24 v251, 9216, v20
    v_add_u32 v251, v251, v21
    s_mul_i32 s89, s71, 768
    v_add_u32 v251, s89, v251
    s_mul_i32 s89, s3, 147456
    v_add_u32 v2, s89, v251
    v_xor_b32 v3, 32, v2
    v_add_u32 v3, 72704, v3
    s_waitcnt lgkmcnt(0)
    s_mov_b32 s20, s36
    s_mov_b32 s21, s37
    s_mov_b32 s22, 0x240000
    s_mov_b32 s23, 0x00020000
    s_mov_b32 s8, s56
    s_mov_b32 s9, s57
    s_mov_b32 s10, 0x510000
    s_mov_b32 s11, 0x00020000
    s_add_u32 m0, s70, 49152
    s_add_u32 s35, s83, 0
    buffer_load_dwordx4 v54, s[20:23], s35 offen offset:0 lds
    buffer_load_dwordx4 v55, s[20:23], s35 offen offset:1024 lds
    buffer_load_dwordx4 v56, s[20:23], s35 offen offset:2048 lds
    buffer_load_dwordx4 v57, s[20:23], s35 offen offset:3072 lds
    s_add_u32 m0, s72, 0
    s_add_u32 s35, s74, 0
    buffer_load_dwordx4 v2, s[8:11], s35 offen lds
    buffer_load_dwordx4 v3, s[8:11], s35 offen offset:1024 lds
    s_add_u32 m0, s72, 8192
    s_add_u32 s35, s75, 0
    buffer_load_dwordx4 v2, s[8:11], s35 offen lds
    buffer_load_dwordx4 v3, s[8:11], s35 offen offset:1024 lds
    s_add_u32 m0, s72, 16384
    s_add_u32 s35, s76, 0
    buffer_load_dwordx4 v2, s[8:11], s35 offen lds
    buffer_load_dwordx4 v3, s[8:11], s35 offen offset:1024 lds
    s_sub_u32 s12, s58, 0x1000
    s_subb_u32 s13, s59, 0
    s_mov_b32 s14, 0x511000
    s_mov_b32 s15, 0x00020000
    s_mov_b32 s16, s64
    s_mov_b32 s17, s65
    s_mov_b32 s18, 0x2000000
    s_mov_b32 s19, 0x00020000
    s_mov_b32 s24, s60
    s_mov_b32 s25, s61
    s_mov_b32 s26, 0x240000
    s_mov_b32 s27, 0x00020000
    s_mov_b32 s28, s62
    s_mov_b32 s29, s63
    s_mov_b32 s30, 0x100
    s_mov_b32 s31, 0x00020000
    v_mov_b32 v240, 0
    v_lshlrev_b32 v254, 2, v0
    s_lshl_b32 s4, s2, 8
    s_add_u32 s4, s4, 33423360
    buffer_store_dword v240, v254, s[16:19], s4 offen sc1
    v_bfe_u32 v24, v0, 2, 2
    v_lshlrev_b32 v24, 7, v24
    v_and_b32 v25, 3, v0
    v_lshl_add_u32 v24, v25, 3, v24
    v_bfe_u32 v25, v0, 3, 1
    v_lshl_add_u32 v24, v25, 6, v24
    v_bfe_u32 v25, v0, 4, 1
    v_lshl_add_u32 v24, v25, 5, v24
    v_lshrrev_b32 v25, 4, v0
    v_lshl_add_u32 v8, v25, 10, v24
    v_xor_b32 v9, 32, v8
    v_xor_b32 v10, 64, v8
    v_xor_b32 v11, 96, v8
    v_add_u32 v12, 49152, v8
    v_add_u32 v13, 49152, v9
    v_add_u32 v14, 49152, v10
    v_add_u32 v15, 49152, v11
    v_bfe_u32 v24, v0, 1, 3
    v_xor_b32 v24, v24, v25
    v_and_b32 v25, 15, v0
    v_lshlrev_b32 v25, 7, v25
    v_add_u32 v25, s70, v25
    v_lshl_add_u32 v58, v24, 4, v25
    v_xor_b32 v59, 64, v58
    s_mov_b64 exec, 0
    s_cmp_eq_u32 s3, 0
    s_cbranch_scc1 L_pg0
    s_cmp_eq_u32 s3, 1
    s_cbranch_scc1 L_pg1
    s_cmp_eq_u32 s3, 2
    s_cbranch_scc1 L_pg2
    s_branch L_pg3
L_pgret:
    s_mov_b64 exec, -1
    s_add_u32 m0, s70, 0
    s_add_u32 s35, s84, 0
    buffer_load_dwordx4 v54, s[20:23], s35 offen offset:0 lds
    buffer_load_dwordx4 v55, s[20:23], s35 offen offset:1024 lds
    buffer_load_dwordx4 v56, s[20:23], s35 offen offset:2048 lds
    buffer_load_dwordx4 v57, s[20:23], s35 offen offset:3072 lds
    s_waitcnt vmcnt(9)
    ds_read_b128 a[0:3], v58 offset:49152
    ds_read_b128 a[4:7], v58 offset:51200
    ds_read_b128 a[8:11], v59 offset:49152
    ds_read_b128 a[12:15], v59 offset:51200
    s_barrier
    ds_read_b64_tr_b16 v[24:25], v8 offset:0
    ds_read_b64_tr_b16 v[26:27], v8 offset:512
    ds_read_b64_tr_b16 v[28:29], v9 offset:0
    ds_read_b64_tr_b16 v[30:31], v9 offset:512
    ds_read_b64_tr_b16 v[32:33], v10 offset:0
    ds_read_b64_tr_b16 v[34:35], v10 offset:512
    ds_read_b64_tr_b16 v[36:37], v11 offset:0
    ds_read_b64_tr_b16 v[38:39], v11 offset:512
    s_waitcnt lgkmcnt(4)
    v_mfma_f32_16x16x32_bf16 v[208:211], v[24:27], a[0:3], 0
    ds_read_b64_tr_b16 v[40:41], v8 offset:4096
    s_add_u32 m0, s72, 24576
    s_add_u32 s35, s77, 0
    v_mfma_f32_16x16x32_bf16 v[212:215], v[24:27], a[4:7], 0
    ds_read_b64_tr_b16 v[42:43], v8 offset:4608
    buffer_load_dwordx4 v2, s[8:11], s35 offen lds
    s_mul_i32 s88, s3, 3
    v_mfma_f32_16x16x32_bf16 v[216:219], v[28:31], a[0:3], 0
    ds_read_b64_tr_b16 v[44:45], v9 offset:4096
    buffer_load_dwordx4 v3, s[8:11], s35 offen offset:1024 lds
    v_mfma_f32_16x16x32_bf16 v[220:223], v[28:31], a[4:7], 0
    ds_read_b64_tr_b16 v[46:47], v9 offset:4608
    s_add_u32 s88, s88, 0
    s_waitcnt lgkmcnt(4)
    v_mfma_f32_16x16x32_bf16 v[224:227], v[32:35], a[0:3], 0
    ds_read_b64_tr_b16 v[24:25], v10 offset:4096
    s_add_u32 m0, s72, 32768
    s_add_u32 s35, s78, 0
    v_mfma_f32_16x16x32_bf16 v[228:231], v[32:35], a[4:7], 0
    ds_read_b64_tr_b16 v[26:27], v10 offset:4608
    buffer_load_dwordx4 v2, s[8:11], s35 offen lds
    s_and_b32 s89, s88, 1
    v_mfma_f32_16x16x32_bf16 v[232:235], v[36:39], a[0:3], 0
    ds_read_b64_tr_b16 v[28:29], v11 offset:4096
    buffer_load_dwordx4 v3, s[8:11], s35 offen offset:1024 lds
    v_mfma_f32_16x16x32_bf16 v[236:239], v[36:39], a[4:7], 0
    ds_read_b64_tr_b16 v[30:31], v11 offset:4608
    s_mul_i32 s89, s89, 73728
    s_waitcnt vmcnt(9)
    s_barrier
    s_waitcnt lgkmcnt(4)
    v_mfma_f32_16x16x32_bf16 v[208:211], v[40:43], a[8:11], v[208:211]
    ds_read_b64_tr_b16 v[32:33], v8 offset:8192
    s_add_u32 m0, s72, 40960
    s_add_u32 s35, s79, 0
    v_mfma_f32_16x16x32_bf16 v[212:215], v[40:43], a[12:15], v[212:215]
    ds_read_b64_tr_b16 v[34:35], v8 offset:8704
    buffer_load_dwordx4 v2, s[8:11], s35 offen lds
    s_lshr_b32 s88, s88, 1
    v_mfma_f32_16x16x32_bf16 v[216:219], v[44:47], a[8:11], v[216:219]
    ds_read_b64_tr_b16 v[36:37], v9 offset:8192
    buffer_load_dwordx4 v3, s[8:11], s35 offen offset:1024 lds
    v_mfma_f32_16x16x32_bf16 v[220:223], v[44:47], a[12:15], v[220:223]
    ds_read_b64_tr_b16 v[38:39], v9 offset:8704
    s_cmp_ge_u32 s88, 3
    s_cselect_b32 s90, 384, 0
    s_waitcnt lgkmcnt(4)
    v_mfma_f32_16x16x32_bf16 v[224:227], v[24:27], a[8:11], v[224:227]
    ds_read_b64_tr_b16 v[40:41], v10 offset:8192
    s_add_u32 m0, s70, 16384
    s_add_u32 s35, s85, 0
    v_mfma_f32_16x16x32_bf16 v[228:231], v[24:27], a[12:15], v[228:231]
    ds_read_b64_tr_b16 v[42:43], v10 offset:8704
    buffer_load_dwordx4 v54, s[20:23], s35 offen offset:0 lds
    v_mfma_f32_16x16x32_bf16 v[232:235], v[28:31], a[8:11], v[232:235]
    ds_read_b64_tr_b16 v[44:45], v11 offset:8192
    buffer_load_dwordx4 v55, s[20:23], s35 offen offset:1024 lds
    v_mfma_f32_16x16x32_bf16 v[236:239], v[28:31], a[12:15], v[236:239]
    ds_read_b64_tr_b16 v[46:47], v11 offset:8704
    s_add_u32 s89, s89, s90
    s_waitcnt lgkmcnt(4)
    v_mfma_f32_16x16x32_bf16 v[176:179], v[32:35], a[0:3], 0
    ds_read_b64_tr_b16 v[24:25], v8 offset:16384
    buffer_load_dwordx4 v56, s[20:23], s35 offen offset:2048 lds
    v_mfma_f32_16x16x32_bf16 v[180:183], v[32:35], a[4:7], 0
    ds_read_b64_tr_b16 v[26:27], v8 offset:16896
    s_add_u32 s88, s88, s86
    v_mfma_f32_16x16x32_bf16 v[184:187], v[36:39], a[0:3], 0
    ds_read_b64_tr_b16 v[28:29], v9 offset:16384
    buffer_load_dwordx4 v57, s[20:23], s35 offen offset:3072 lds
    v_mfma_f32_16x16x32_bf16 v[188:191], v[36:39], a[4:7], 0
    ds_read_b64_tr_b16 v[30:31], v9 offset:16896
    s_mul_i32 s90, s88, 43
    s_waitcnt lgkmcnt(4)
    v_mfma_f32_16x16x32_bf16 v[192:195], v[40:43], a[0:3], 0
    ds_read_b64_tr_b16 v[32:33], v10 offset:16384
    s_add_u32 m0, s72, 49152
    s_add_u32 s35, s80, 0
    v_mfma_f32_16x16x32_bf16 v[196:199], v[40:43], a[4:7], 0
    ds_read_b64_tr_b16 v[34:35], v10 offset:16896
    buffer_load_dwordx4 v2, s[8:11], s35 offen lds
    s_lshr_b32 s90, s90, 7
    v_mfma_f32_16x16x32_bf16 v[200:203], v[44:47], a[0:3], 0
    ds_read_b64_tr_b16 v[36:37], v11 offset:16384
    buffer_load_dwordx4 v3, s[8:11], s35 offen offset:1024 lds
    v_mfma_f32_16x16x32_bf16 v[204:207], v[44:47], a[4:7], 0
    ds_read_b64_tr_b16 v[38:39], v11 offset:16896
    s_mul_i32 s90, s90, 3
    s_waitcnt lgkmcnt(4)
    v_mfma_f32_16x16x32_bf16 v[144:147], v[24:27], a[0:3], 0
    ds_read_b64_tr_b16 v[40:41], v8 offset:12288
    s_add_u32 m0, s72, 57344
    v_mfma_f32_16x16x32_bf16 v[148:151], v[24:27], a[4:7], 0
    ds_read_b64_tr_b16 v[42:43], v8 offset:12800
    s_add_u32 s35, s81, 0
    s_sub_u32 s88, s88, s90
    v_mfma_f32_16x16x32_bf16 v[152:155], v[28:31], a[0:3], 0
    ds_read_b64_tr_b16 v[44:45], v9 offset:12288
    v_mfma_f32_16x16x32_bf16 v[156:159], v[28:31], a[4:7], 0
    ds_read_b64_tr_b16 v[46:47], v9 offset:12800
    s_lshl_b32 s88, s88, 7
    s_waitcnt lgkmcnt(4)
    v_mfma_f32_16x16x32_bf16 v[160:163], v[32:35], a[0:3], 0
    ds_read_b64_tr_b16 v[24:25], v10 offset:12288
    v_mfma_f32_16x16x32_bf16 v[164:167], v[32:35], a[4:7], 0
    ds_read_b64_tr_b16 v[26:27], v10 offset:12800
    s_add_u32 s88, s88, s89
    v_mfma_f32_16x16x32_bf16 v[168:171], v[36:39], a[0:3], 0
    ds_read_b64_tr_b16 v[28:29], v11 offset:12288
    v_mfma_f32_16x16x32_bf16 v[172:175], v[36:39], a[4:7], 0
    ds_read_b64_tr_b16 v[30:31], v11 offset:12800
    s_add_u32 s52, s88, 33161216
    s_waitcnt lgkmcnt(4)
    v_mfma_f32_16x16x32_bf16 v[176:179], v[40:43], a[8:11], v[176:179]
    ds_read_b64_tr_b16 v[32:33], v8 offset:20480
    v_mfma_f32_16x16x32_bf16 v[180:183], v[40:43], a[12:15], v[180:183]
    ds_read_b64_tr_b16 v[34:35], v8 offset:20992
    s_mul_i32 s88, s3, 3
    v_mfma_f32_16x16x32_bf16 v[184:187], v[44:47], a[8:11], v[184:187]
    ds_read_b64_tr_b16 v[36:37], v9 offset:20480
    v_mfma_f32_16x16x32_bf16 v[188:191], v[44:47], a[12:15], v[188:191]
    ds_read_b64_tr_b16 v[38:39], v9 offset:20992
    s_add_u32 s88, s88, 1
    s_waitcnt lgkmcnt(4)
    v_mfma_f32_16x16x32_bf16 v[192:195], v[24:27], a[8:11], v[192:195]
    ds_read_b64_tr_b16 v[40:41], v10 offset:20480
    v_mfma_f32_16x16x32_bf16 v[196:199], v[24:27], a[12:15], v[196:199]
    ds_read_b64_tr_b16 v[42:43], v10 offset:20992
    s_and_b32 s89, s88, 1
    v_mfma_f32_16x16x32_bf16 v[200:203], v[28:31], a[8:11], v[200:203]
    ds_read_b64_tr_b16 v[44:45], v11 offset:20480
    v_mfma_f32_16x16x32_bf16 v[204:207], v[28:31], a[12:15], v[204:207]
    ds_read_b64_tr_b16 v[46:47], v11 offset:20992
    s_mul_i32 s89, s89, 73728
    s_waitcnt vmcnt(6)
    s_barrier
    s_waitcnt lgkmcnt(4)
    v_mfma_f32_16x16x32_bf16 v[144:147], v[32:35], a[8:11], v[144:147]
    ds_read_b64_tr_b16 v[24:25], v8 offset:24576
    buffer_load_dwordx4 v2, s[8:11], s35 offen lds
    v_mfma_f32_16x16x32_bf16 v[148:151], v[32:35], a[12:15], v[148:151]
    ds_read_b64_tr_b16 v[26:27], v8 offset:25088
    ds_read_b128 a[16:19], v58 offset:0
    s_lshr_b32 s88, s88, 1
    v_mfma_f32_16x16x32_bf16 v[152:155], v[36:39], a[8:11], v[152:155]
    ds_read_b64_tr_b16 v[28:29], v9 offset:24576
    buffer_load_dwordx4 v3, s[8:11], s35 offen offset:1024 lds
    ds_read_b128 a[20:23], v58 offset:2048
    v_mfma_f32_16x16x32_bf16 v[156:159], v[36:39], a[12:15], v[156:159]
    ds_read_b64_tr_b16 v[30:31], v9 offset:25088
    s_cmp_ge_u32 s88, 3
    s_cselect_b32 s90, 384, 0
    s_waitcnt lgkmcnt(6)
    v_mfma_f32_16x16x32_bf16 v[160:163], v[40:43], a[8:11], v[160:163]
    ds_read_b64_tr_b16 v[32:33], v10 offset:24576
    s_add_u32 m0, s72, 65536
    s_add_u32 s35, s82, 0
    v_mfma_f32_16x16x32_bf16 v[164:167], v[40:43], a[12:15], v[164:167]
    ds_read_b64_tr_b16 v[34:35], v10 offset:25088
    buffer_load_dwordx4 v2, s[8:11], s35 offen lds
    ds_read_b128 a[24:27], v59 offset:0
    v_mfma_f32_16x16x32_bf16 v[168:171], v[44:47], a[8:11], v[168:171]
    ds_read_b64_tr_b16 v[36:37], v11 offset:24576
    buffer_load_dwordx4 v3, s[8:11], s35 offen offset:1024 lds
    ds_read_b128 a[28:31], v59 offset:2048
    v_mfma_f32_16x16x32_bf16 v[172:175], v[44:47], a[12:15], v[172:175]
    ds_read_b64_tr_b16 v[38:39], v11 offset:25088
    s_add_u32 s89, s89, s90
    s_waitcnt lgkmcnt(6)
    v_mfma_f32_16x16x32_bf16 v[208:211], v[24:27], a[16:19], v[208:211]
    ds_read_b64_tr_b16 v[40:41], v8 offset:32768
    s_add_u32 m0, s70, 32768
    v_mfma_f32_16x16x32_bf16 v[212:215], v[24:27], a[20:23], v[212:215]
    ds_read_b64_tr_b16 v[42:43], v8 offset:33280
    s_add_u32 s35, s83, 384
    s_add_u32 s88, s88, s86
    s_mul_i32 s90, s88, 43
    v_mfma_f32_16x16x32_bf16 v[216:219], v[28:31], a[16:19], v[216:219]
    ds_read_b64_tr_b16 v[44:45], v9 offset:32768
    v_mfma_f32_16x16x32_bf16 v[220:223], v[28:31], a[20:23], v[220:223]
    ds_read_b64_tr_b16 v[46:47], v9 offset:33280
    s_lshr_b32 s90, s90, 7
    s_mul_i32 s90, s90, 3
    s_waitcnt lgkmcnt(4)
    v_mfma_f32_16x16x32_bf16 v[224:227], v[32:35], a[16:19], v[224:227]
    ds_read_b64_tr_b16 v[24:25], v10 offset:32768
    v_mfma_f32_16x16x32_bf16 v[228:231], v[32:35], a[20:23], v[228:231]
    ds_read_b64_tr_b16 v[26:27], v10 offset:33280
    s_sub_u32 s88, s88, s90
    s_lshl_b32 s88, s88, 7
    v_mfma_f32_16x16x32_bf16 v[232:235], v[36:39], a[16:19], v[232:235]
    ds_read_b64_tr_b16 v[28:29], v11 offset:32768
    v_mfma_f32_16x16x32_bf16 v[236:239], v[36:39], a[20:23], v[236:239]
    ds_read_b64_tr_b16 v[30:31], v11 offset:33280
    s_add_u32 s88, s88, s89
    s_add_u32 s53, s88, 33161216
    s_waitcnt lgkmcnt(4)
    v_mfma_f32_16x16x32_bf16 v[176:179], v[40:43], a[16:19], v[176:179]
    ds_read_b64_tr_b16 v[32:33], v8 offset:40960
    v_mfma_f32_16x16x32_bf16 v[180:183], v[40:43], a[20:23], v[180:183]
    ds_read_b64_tr_b16 v[34:35], v8 offset:41472
    s_mul_i32 s88, s3, 3
    s_add_u32 s88, s88, 2
    v_mfma_f32_16x16x32_bf16 v[184:187], v[44:47], a[16:19], v[184:187]
    ds_read_b64_tr_b16 v[36:37], v9 offset:40960
    buffer_load_dwordx4 v54, s[20:23], s35 offen offset:0 lds
    v_mfma_f32_16x16x32_bf16 v[188:191], v[44:47], a[20:23], v[188:191]
    ds_read_b64_tr_b16 v[38:39], v9 offset:41472
    s_and_b32 s89, s88, 1
    s_mul_i32 s89, s89, 73728
    s_waitcnt lgkmcnt(4)
    v_mfma_f32_16x16x32_bf16 v[192:195], v[24:27], a[16:19], v[192:195]
    ds_read_b64_tr_b16 v[40:41], v10 offset:40960
    v_mfma_f32_16x16x32_bf16 v[196:199], v[24:27], a[20:23], v[196:199]
    ds_read_b64_tr_b16 v[42:43], v10 offset:41472
    s_lshr_b32 s88, s88, 1
    s_cmp_ge_u32 s88, 3
    s_cselect_b32 s90, 384, 0
    v_mfma_f32_16x16x32_bf16 v[200:203], v[28:31], a[16:19], v[200:203]
    ds_read_b64_tr_b16 v[44:45], v11 offset:40960
    buffer_load_dwordx4 v55, s[20:23], s35 offen offset:1024 lds
    v_mfma_f32_16x16x32_bf16 v[204:207], v[28:31], a[20:23], v[204:207]
    ds_read_b64_tr_b16 v[46:47], v11 offset:41472
    s_add_u32 s89, s89, s90
    s_waitcnt lgkmcnt(4)
    v_mfma_f32_16x16x32_bf16 v[144:147], v[32:35], a[16:19], v[144:147]
    ds_read_b64_tr_b16 v[24:25], v8 offset:28672
    v_mfma_f32_16x16x32_bf16 v[148:151], v[32:35], a[20:23], v[148:151]
    ds_read_b64_tr_b16 v[26:27], v8 offset:29184
    s_add_u32 s88, s88, s86
    s_mul_i32 s90, s88, 43
    v_mfma_f32_16x16x32_bf16 v[152:155], v[36:39], a[16:19], v[152:155]
    ds_read_b64_tr_b16 v[28:29], v9 offset:28672
    buffer_load_dwordx4 v56, s[20:23], s35 offen offset:2048 lds
    v_mfma_f32_16x16x32_bf16 v[156:159], v[36:39], a[20:23], v[156:159]
    ds_read_b64_tr_b16 v[30:31], v9 offset:29184
    s_lshr_b32 s90, s90, 7
    s_mul_i32 s90, s90, 3
    s_waitcnt lgkmcnt(4)
    v_mfma_f32_16x16x32_bf16 v[160:163], v[40:43], a[16:19], v[160:163]
    ds_read_b64_tr_b16 v[32:33], v10 offset:28672
    v_mfma_f32_16x16x32_bf16 v[164:167], v[40:43], a[20:23], v[164:167]
    ds_read_b64_tr_b16 v[34:35], v10 offset:29184
    s_sub_u32 s88, s88, s90
    s_lshl_b32 s88, s88, 7
    v_mfma_f32_16x16x32_bf16 v[168:171], v[44:47], a[16:19], v[168:171]
    ds_read_b64_tr_b16 v[36:37], v11 offset:28672
    buffer_load_dwordx4 v57, s[20:23], s35 offen offset:3072 lds
    v_mfma_f32_16x16x32_bf16 v[172:175], v[44:47], a[20:23], v[172:175]
    ds_read_b64_tr_b16 v[38:39], v11 offset:29184
    s_add_u32 s88, s88, s89
    s_add_u32 s54, s88, 33161216
    s_waitcnt lgkmcnt(4)
    v_mfma_f32_16x16x32_bf16 v[208:211], v[24:27], a[24:27], v[208:211]
    ds_read_b64_tr_b16 v[40:41], v8 offset:36864
    s_add_u32 m0, s72, 73728
    v_mfma_f32_16x16x32_bf16 v[212:215], v[24:27], a[28:31], v[212:215]
    ds_read_b64_tr_b16 v[42:43], v8 offset:37376
    s_add_u32 s35, s74, 1769472
    s_mul_i32 s90, s67, 1327104
    s_mov_b32 s88, s66
    v_mfma_f32_16x16x32_bf16 v[216:219], v[28:31], a[24:27], v[216:219]
    ds_read_b64_tr_b16 v[44:45], v9 offset:36864
    buffer_load_dwordx4 v2, s[8:11], s35 offen lds
    v_mfma_f32_16x16x32_bf16 v[220:223], v[28:31], a[28:31], v[220:223]
    ds_read_b64_tr_b16 v[46:47], v9 offset:37376
    s_mul_i32 s97, s68, 294912
    s_mul_i32 s89, s67, 73728
    s_waitcnt lgkmcnt(4)
    v_mfma_f32_16x16x32_bf16 v[224:227], v[32:35], a[24:27], v[224:227]
    ds_read_b64_tr_b16 v[24:25], v10 offset:36864
    v_mfma_f32_16x16x32_bf16 v[228:231], v[32:35], a[28:31], v[228:231]
    ds_read_b64_tr_b16 v[26:27], v10 offset:37376
    s_add_u32 s97, s97, s89
    s_add_u32 s97, s97, 4718592
    v_mfma_f32_16x16x32_bf16 v[232:235], v[36:39], a[24:27], v[232:235]
    ds_read_b64_tr_b16 v[28:29], v11 offset:36864
    buffer_load_dwordx4 v3, s[8:11], s35 offen offset:1024 lds
    v_mfma_f32_16x16x32_bf16 v[236:239], v[36:39], a[28:31], v[236:239]
    ds_read_b64_tr_b16 v[30:31], v11 offset:37376
    s_mul_i32 s47, s91, 576
    s_mul_i32 s48, s92, 576
    s_waitcnt lgkmcnt(4)
    v_mfma_f32_16x16x32_bf16 v[176:179], v[40:43], a[24:27], v[176:179]
    ds_read_b64_tr_b16 v[32:33], v8 offset:45056
    s_add_u32 m0, s72, 81920
    v_mfma_f32_16x16x32_bf16 v[180:183], v[40:43], a[28:31], v[180:183]
    ds_read_b64_tr_b16 v[34:35], v8 offset:45568
    s_add_u32 s35, s75, 1769472
    s_mul_i32 s49, s93, 576
    s_mul_i32 s89, s88, 442368
    v_mfma_f32_16x16x32_bf16 v[184:187], v[44:47], a[24:27], v[184:187]
    ds_read_b64_tr_b16 v[36:37], v9 offset:45056
    buffer_load_dwordx4 v2, s[8:11], s35 offen lds
    v_mfma_f32_16x16x32_bf16 v[188:191], v[44:47], a[28:31], v[188:191]
    ds_read_b64_tr_b16 v[38:39], v9 offset:45568
    s_add_u32 s89, s89, s90
    s_add_u32 s38, s89, s47
    s_waitcnt lgkmcnt(4)
    v_mfma_f32_16x16x32_bf16 v[192:195], v[24:27], a[24:27], v[192:195]
    ds_read_b64_tr_b16 v[40:41], v10 offset:45056
    v_mfma_f32_16x16x32_bf16 v[196:199], v[24:27], a[28:31], v[196:199]
    ds_read_b64_tr_b16 v[42:43], v10 offset:45568
    s_add_u32 s39, s89, s48
    s_add_u32 s40, s89, s49
    v_mfma_f32_16x16x32_bf16 v[200:203], v[28:31], a[24:27], v[200:203]
    ds_read_b64_tr_b16 v[44:45], v11 offset:45056
    buffer_load_dwordx4 v3, s[8:11], s35 offen offset:1024 lds
    v_mfma_f32_16x16x32_bf16 v[204:207], v[28:31], a[28:31], v[204:207]
    ds_read_b64_tr_b16 v[46:47], v11 offset:45568
    s_mul_i32 s91, s88, 24576
    s_add_u32 s91, s91, s97
    s_waitcnt vmcnt(8)
    s_barrier
    s_waitcnt lgkmcnt(4)
    v_mfma_f32_16x16x32_bf16 v[144:147], v[32:35], a[24:27], v[144:147]
    ds_read_b64_tr_b16 v[24:25], v12 offset:0
    s_add_u32 m0, s72, 90112
    s_add_u32 s35, s76, 1769472
    v_mfma_f32_16x16x32_bf16 v[148:151], v[32:35], a[28:31], v[148:151]
    ds_read_b64_tr_b16 v[26:27], v12 offset:512
    buffer_load_dwordx4 v2, s[8:11], s35 offen lds
    ds_read_b128 a[32:35], v58 offset:16384
    s_add_u32 s88, s88, 1
    s_cmp_eq_u32 s88, 3
    s_cselect_b32 s88, 0, s88
    v_mfma_f32_16x16x32_bf16 v[152:155], v[36:39], a[24:27], v[152:155]
    ds_read_b64_tr_b16 v[28:29], v13 offset:0
    buffer_load_dwordx4 v3, s[8:11], s35 offen offset:1024 lds
    ds_read_b128 a[36:39], v58 offset:18432
    v_mfma_f32_16x16x32_bf16 v[156:159], v[36:39], a[28:31], v[156:159]
    ds_read_b64_tr_b16 v[30:31], v13 offset:512
    s_mul_i32 s89, s88, 442368
    s_waitcnt lgkmcnt(6)
    v_mfma_f32_16x16x32_bf16 v[160:163], v[40:43], a[24:27], v[160:163]
    ds_read_b64_tr_b16 v[32:33], v14 offset:0
    ds_read_b128 a[40:43], v59 offset:16384
    v_mfma_f32_16x16x32_bf16 v[164:167], v[40:43], a[28:31], v[164:167]
    ds_read_b64_tr_b16 v[34:35], v14 offset:512
    ds_read_b128 a[44:47], v59 offset:18432
    s_add_u32 s89, s89, s90
    s_add_u32 s41, s89, s47
    v_mfma_f32_16x16x32_bf16 v[168:171], v[44:47], a[24:27], v[168:171]
    ds_read_b64_tr_b16 v[36:37], v15 offset:0
    s_add_u32 m0, s70, 49152
    v_mfma_f32_16x16x32_bf16 v[172:175], v[44:47], a[28:31], v[172:175]
    ds_read_b64_tr_b16 v[38:39], v15 offset:512
    s_add_u32 s42, s89, s48
    s_add_u32 s43, s89, s49
    s_waitcnt lgkmcnt(6)
    v_mfma_f32_16x16x32_bf16 v[208:211], v[24:27], a[32:35], v[208:211]
    ds_read_b64_tr_b16 v[40:41], v12 offset:8192
    s_add_u32 s35, s84, 384
    v_mfma_f32_16x16x32_bf16 v[212:215], v[24:27], a[36:39], v[212:215]
    ds_read_b64_tr_b16 v[42:43], v12 offset:8704
    s_mul_i32 s92, s88, 24576
    s_add_u32 s92, s92, s97
    v_mfma_f32_16x16x32_bf16 v[216:219], v[28:31], a[32:35], v[216:219]
    ds_read_b64_tr_b16 v[44:45], v13 offset:8192
    buffer_load_dwordx4 v54, s[20:23], s35 offen offset:0 lds
    v_mfma_f32_16x16x32_bf16 v[220:223], v[28:31], a[36:39], v[220:223]
    ds_read_b64_tr_b16 v[46:47], v13 offset:8704
    s_add_u32 s88, s88, 1
    s_cmp_eq_u32 s88, 3
    s_cselect_b32 s88, 0, s88
    s_waitcnt lgkmcnt(4)
    v_mfma_f32_16x16x32_bf16 v[224:227], v[32:35], a[32:35], v[224:227]
    ds_read_b64_tr_b16 v[24:25], v14 offset:8192
    v_mfma_f32_16x16x32_bf16 v[228:231], v[32:35], a[36:39], v[228:231]
    ds_read_b64_tr_b16 v[26:27], v14 offset:8704
    s_mul_i32 s89, s88, 442368
    v_mfma_f32_16x16x32_bf16 v[232:235], v[36:39], a[32:35], v[232:235]
    ds_read_b64_tr_b16 v[28:29], v15 offset:8192
    buffer_load_dwordx4 v55, s[20:23], s35 offen offset:1024 lds
    v_mfma_f32_16x16x32_bf16 v[236:239], v[36:39], a[36:39], v[236:239]
    ds_read_b64_tr_b16 v[30:31], v15 offset:8704
    s_add_u32 s89, s89, s90
    s_add_u32 s44, s89, s47
    s_waitcnt lgkmcnt(4)
    v_mfma_f32_16x16x32_bf16 v[176:179], v[40:43], a[32:35], v[176:179]
    ds_read_b64_tr_b16 v[32:33], v12 offset:16384
    v_mfma_f32_16x16x32_bf16 v[180:183], v[40:43], a[36:39], v[180:183]
    ds_read_b64_tr_b16 v[34:35], v12 offset:16896
    s_add_u32 s45, s89, s48
    s_add_u32 s46, s89, s49
    v_mfma_f32_16x16x32_bf16 v[184:187], v[44:47], a[32:35], v[184:187]
    ds_read_b64_tr_b16 v[36:37], v13 offset:16384
    buffer_load_dwordx4 v56, s[20:23], s35 offen offset:2048 lds
    v_mfma_f32_16x16x32_bf16 v[188:191], v[44:47], a[36:39], v[188:191]
    ds_read_b64_tr_b16 v[38:39], v13 offset:16896
    s_mul_i32 s93, s88, 24576
    s_add_u32 s93, s93, s97
    s_waitcnt lgkmcnt(4)
    v_mfma_f32_16x16x32_bf16 v[192:195], v[24:27], a[32:35], v[192:195]
    ds_read_b64_tr_b16 v[40:41], v14 offset:16384
    v_mfma_f32_16x16x32_bf16 v[196:199], v[24:27], a[36:39], v[196:199]
    ds_read_b64_tr_b16 v[42:43], v14 offset:16896
    v_mul_u32_u24 v5, 1152, v20
    v_add_u32 v5, v5, v21
    v_mfma_f32_16x16x32_bf16 v[200:203], v[28:31], a[32:35], v[200:203]
    ds_read_b64_tr_b16 v[44:45], v15 offset:16384
    buffer_load_dwordx4 v57, s[20:23], s35 offen offset:3072 lds
    v_mfma_f32_16x16x32_bf16 v[204:207], v[28:31], a[36:39], v[204:207]
    ds_read_b64_tr_b16 v[46:47], v15 offset:16896
    s_mul_i32 s88, s3, 18432
    s_mul_i32 s89, s66, 384
    s_waitcnt lgkmcnt(4)
    v_mfma_f32_16x16x32_bf16 v[144:147], v[32:35], a[32:35], v[144:147]
    ds_read_b64_tr_b16 v[24:25], v12 offset:4096
    s_add_u32 m0, s70, 0
    v_mfma_f32_16x16x32_bf16 v[148:151], v[32:35], a[36:39], v[148:151]
    ds_read_b64_tr_b16 v[26:27], v12 offset:4608
    s_add_u32 s35, s85, 384
    s_add_u32 s88, s88, s89
    s_add_u32 s88, s88, 4096
    v_mfma_f32_16x16x32_bf16 v[152:155], v[36:39], a[32:35], v[152:155]
    ds_read_b64_tr_b16 v[28:29], v13 offset:4096
    buffer_load_dwordx4 v54, s[20:23], s35 offen offset:0 lds
L_pg0:
    s_cbranch_execz L_pg4
    v_mfma_f32_16x16x32_bf16 v[156:159], v[36:39], a[36:39], v[156:159]
    ds_read_b64_tr_b16 v[30:31], v13 offset:4608
    v_add_u32 v5, s88, v5
    v_subrev_u32 v6, 896, v5
    s_waitcnt lgkmcnt(4)
    v_mfma_f32_16x16x32_bf16 v[160:163], v[40:43], a[32:35], v[160:163]
    ds_read_b64_tr_b16 v[32:33], v14 offset:4096
    v_mfma_f32_16x16x32_bf16 v[164:167], v[40:43], a[36:39], v[164:167]
    ds_read_b64_tr_b16 v[34:35], v14 offset:4608
    v_subrev_u32 v7, 1792, v5
    v_and_b32 v20, 15, v0
    v_mfma_f32_16x16x32_bf16 v[168:171], v[44:47], a[32:35], v[168:171]
    ds_read_b64_tr_b16 v[36:37], v15 offset:4096
    buffer_load_dwordx4 v55, s[20:23], s35 offen offset:1024 lds
    v_mfma_f32_16x16x32_bf16 v[172:175], v[44:47], a[36:39], v[172:175]
    ds_read_b64_tr_b16 v[38:39], v15 offset:4608
    v_lshrrev_b32 v21, 2, v20
    v_lshlrev_b32 v21, 7, v21
    s_waitcnt lgkmcnt(4)
    v_mfma_f32_16x16x32_bf16 v[208:211], v[24:27], a[40:43], v[208:211]
    ds_read_b64_tr_b16 v[40:41], v12 offset:12288
    v_mfma_f32_16x16x32_bf16 v[212:215], v[24:27], a[44:47], v[212:215]
    ds_read_b64_tr_b16 v[42:43], v12 offset:12800
    v_and_b32 v22, 3, v20
    v_lshl_add_u32 v21, v22, 3, v21
    v_mfma_f32_16x16x32_bf16 v[216:219], v[28:31], a[40:43], v[216:219]
    ds_read_b64_tr_b16 v[44:45], v13 offset:12288
    buffer_load_dwordx4 v56, s[20:23], s35 offen offset:2048 lds
    v_mfma_f32_16x16x32_bf16 v[220:223], v[28:31], a[44:47], v[220:223]
    ds_read_b64_tr_b16 v[46:47], v13 offset:12800
    v_lshrrev_b32 v22, 3, v20
    v_lshlrev_b32 v22, 6, v22
    s_waitcnt lgkmcnt(4)
    v_mfma_f32_16x16x32_bf16 v[224:227], v[32:35], a[40:43], v[224:227]
    ds_read_b64_tr_b16 v[24:25], v14 offset:12288
    v_mfma_f32_16x16x32_bf16 v[228:231], v[32:35], a[44:47], v[228:231]
    ds_read_b64_tr_b16 v[26:27], v14 offset:12800
    v_xor_b32 v21, v21, v22
    v_bfe_u32 v23, v0, 4, 1
    v_mfma_f32_16x16x32_bf16 v[232:235], v[36:39], a[40:43], v[232:235]
    ds_read_b64_tr_b16 v[28:29], v15 offset:12288
    buffer_load_dwordx4 v57, s[20:23], s35 offen offset:3072 lds
    v_mfma_f32_16x16x32_bf16 v[236:239], v[36:39], a[44:47], v[236:239]
    ds_read_b64_tr_b16 v[30:31], v15 offset:12800
    v_lshrrev_b32 v22, 5, v0
    v_add_u32 v16, 98304, v8
    s_waitcnt lgkmcnt(4)
    v_mfma_f32_16x16x32_bf16 v[176:179], v[40:43], a[40:43], v[176:179]
    ds_read_b64_tr_b16 v[32:33], v12 offset:20480
    s_add_u32 m0, s72, 0
    v_mfma_f32_16x16x32_bf16 v[180:183], v[40:43], a[44:47], v[180:183]
    ds_read_b64_tr_b16 v[34:35], v12 offset:20992
    s_add_u32 s35, s77, 1769472
    v_add_u32 v17, 98304, v9
    v_add_u32 v18, 98304, v10
    v_mfma_f32_16x16x32_bf16 v[184:187], v[44:47], a[40:43], v[184:187]
    ds_read_b64_tr_b16 v[36:37], v13 offset:20480
    buffer_load_dwordx4 v2, s[8:11], s35 offen lds
    v_mfma_f32_16x16x32_bf16 v[188:191], v[44:47], a[44:47], v[188:191]
    ds_read_b64_tr_b16 v[38:39], v13 offset:20992
    v_add_u32 v19, 98304, v11
    v_mul_u32_u24 v4, 3072, v22
    s_waitcnt lgkmcnt(4)
    v_mfma_f32_16x16x32_bf16 v[192:195], v[24:27], a[40:43], v[192:195]
    ds_read_b64_tr_b16 v[40:41], v14 offset:20480
    v_mfma_f32_16x16x32_bf16 v[196:199], v[24:27], a[44:47], v[196:199]
    ds_read_b64_tr_b16 v[42:43], v14 offset:20992
    v_add_u32 v21, v21, v4
    s_and_b32 s88, s3, 1
    v_mfma_f32_16x16x32_bf16 v[200:203], v[28:31], a[40:43], v[200:203]
    ds_read_b64_tr_b16 v[44:45], v15 offset:20480
    buffer_load_dwordx4 v3, s[8:11], s35 offen offset:1024 lds
    v_mfma_f32_16x16x32_bf16 v[204:207], v[28:31], a[44:47], v[204:207]
    ds_read_b64_tr_b16 v[46:47], v15 offset:20992
    s_lshl_b32 s88, s88, 5
    v_xor_b32 v251, s88, v251
    s_waitcnt vmcnt(10)
    s_barrier
    s_waitcnt lgkmcnt(4)
    v_mfma_f32_16x16x32_bf16 v[144:147], v[32:35], a[40:43], v[144:147]
    ds_read_b64_tr_b16 v[24:25], v12 offset:24576
    ds_read_b128 a[48:51], v58 offset:32768
    v_mfma_f32_16x16x32_bf16 v[148:151], v[32:35], a[44:47], v[148:151]
    ds_read_b64_tr_b16 v[26:27], v12 offset:25088
    ds_read_b128 a[52:55], v58 offset:34816
    s_mul_i32 s88, s67, 3
    s_add_u32 s88, s88, 3
    v_mfma_f32_16x16x32_bf16 v[152:155], v[36:39], a[40:43], v[152:155]
    ds_read_b64_tr_b16 v[28:29], v13 offset:24576
    s_add_u32 m0, s72, 8192
    s_add_u32 s35, s78, 1769472
    v_mfma_f32_16x16x32_bf16 v[156:159], v[36:39], a[44:47], v[156:159]
    ds_read_b64_tr_b16 v[30:31], v13 offset:25088
    buffer_load_dwordx4 v2, s[8:11], s35 offen lds
    ds_read_b128 a[56:59], v59 offset:32768
    v_add_u32 v23, s88, v23
    v_add_u32 v4, 0, v23
    s_waitcnt lgkmcnt(7)
    v_mfma_f32_16x16x32_bf16 v[160:163], v[40:43], a[40:43], v[160:163]
    ds_read_b64_tr_b16 v[32:33], v14 offset:24576
    ds_read_b128 a[60:63], v59 offset:34816
    v_mfma_f32_16x16x32_bf16 v[164:167], v[40:43], a[44:47], v[164:167]
    ds_read_b64_tr_b16 v[34:35], v14 offset:25088
    v_subrev_u32 v63, 12, v4
    v_min_u32 v4, v4, v63
    v_mfma_f32_16x16x32_bf16 v[168:171], v[44:47], a[40:43], v[168:171]
    ds_read_b64_tr_b16 v[36:37], v15 offset:24576
    buffer_load_dwordx4 v3, s[8:11], s35 offen offset:1024 lds
    v_mfma_f32_16x16x32_bf16 v[172:175], v[44:47], a[44:47], v[172:175]
    ds_read_b64_tr_b16 v[38:39], v15 offset:25088
    v_and_b32 v63, 3, v4
    v_lshlrev_b32 v63, 5, v63
    s_waitcnt lgkmcnt(6)
    v_mfma_f32_16x16x32_bf16 v[208:211], v[24:27], a[48:51], v[208:211]
    ds_read_b64_tr_b16 v[40:41], v12 offset:32768
    s_add_u32 m0, s72, 16384
    v_mfma_f32_16x16x32_bf16 v[212:215], v[24:27], a[52:55], v[212:215]
    ds_read_b64_tr_b16 v[42:43], v12 offset:33280
    s_add_u32 s35, s79, 1769472
    v_xor_b32 v63, v63, v21
    v_lshrrev_b32 v4, 2, v4
    v_lshl_add_u32 v4, v4, 10, v63
    v_mfma_f32_16x16x32_bf16 v[216:219], v[28:31], a[48:51], v[216:219]
    ds_read_b64_tr_b16 v[44:45], v13 offset:32768
    buffer_load_dwordx4 v2, s[8:11], s35 offen lds
    v_mfma_f32_16x16x32_bf16 v[220:223], v[28:31], a[52:55], v[220:223]
    ds_read_b64_tr_b16 v[46:47], v13 offset:33280
    v_accvgpr_write_b32 a240, v4
    v_add_u32 v4, 2, v23
    v_subrev_u32 v63, 12, v4
    s_waitcnt lgkmcnt(4)
    v_mfma_f32_16x16x32_bf16 v[224:227], v[32:35], a[48:51], v[224:227]
    ds_read_b64_tr_b16 v[24:25], v14 offset:32768
    v_mfma_f32_16x16x32_bf16 v[228:231], v[32:35], a[52:55], v[228:231]
    ds_read_b64_tr_b16 v[26:27], v14 offset:33280
    v_min_u32 v4, v4, v63
    v_and_b32 v63, 3, v4
    v_lshlrev_b32 v63, 5, v63
    v_mfma_f32_16x16x32_bf16 v[232:235], v[36:39], a[48:51], v[232:235]
    ds_read_b64_tr_b16 v[28:29], v15 offset:32768
    buffer_load_dwordx4 v3, s[8:11], s35 offen offset:1024 lds
    v_mfma_f32_16x16x32_bf16 v[236:239], v[36:39], a[52:55], v[236:239]
    ds_read_b64_tr_b16 v[30:31], v15 offset:33280
    v_xor_b32 v63, v63, v21
    v_lshrrev_b32 v4, 2, v4
    v_lshl_add_u32 v4, v4, 10, v63
    s_waitcnt lgkmcnt(4)
    v_mfma_f32_16x16x32_bf16 v[176:179], v[40:43], a[48:51], v[176:179]
    ds_read_b64_tr_b16 v[32:33], v12 offset:40960
    s_add_u32 m0, s70, 16384
    v_mfma_f32_16x16x32_bf16 v[180:183], v[40:43], a[52:55], v[180:183]
    ds_read_b64_tr_b16 v[34:35], v12 offset:41472
    s_add_u32 s35, s83, 768
    v_accvgpr_write_b32 a241, v4
    v_add_u32 v4, 4, v23
    v_subrev_u32 v63, 12, v4
    v_mfma_f32_16x16x32_bf16 v[184:187], v[44:47], a[48:51], v[184:187]
    ds_read_b64_tr_b16 v[36:37], v13 offset:40960
    buffer_load_dwordx4 v54, s[20:23], s35 offen offset:0 lds
    v_mfma_f32_16x16x32_bf16 v[188:191], v[44:47], a[52:55], v[188:191]
    ds_read_b64_tr_b16 v[38:39], v13 offset:41472
    v_min_u32 v4, v4, v63
    v_and_b32 v63, 3, v4
    v_lshlrev_b32 v63, 5, v63
    s_waitcnt lgkmcnt(4)
    v_mfma_f32_16x16x32_bf16 v[192:195], v[24:27], a[48:51], v[192:195]
    ds_read_b64_tr_b16 v[40:41], v14 offset:40960
    v_mfma_f32_16x16x32_bf16 v[196:199], v[24:27], a[52:55], v[196:199]
    ds_read_b64_tr_b16 v[42:43], v14 offset:41472
    v_xor_b32 v63, v63, v21
    v_lshrrev_b32 v4, 2, v4
    v_lshl_add_u32 v4, v4, 10, v63
    v_mfma_f32_16x16x32_bf16 v[200:203], v[28:31], a[48:51], v[200:203]
    ds_read_b64_tr_b16 v[44:45], v15 offset:40960
    buffer_load_dwordx4 v55, s[20:23], s35 offen offset:1024 lds
    v_mfma_f32_16x16x32_bf16 v[204:207], v[28:31], a[52:55], v[204:207]
    ds_read_b64_tr_b16 v[46:47], v15 offset:41472
    v_accvgpr_write_b32 a242, v4
    v_add_u32 v4, 6, v23
    v_subrev_u32 v63, 12, v4
    s_waitcnt lgkmcnt(4)
    v_mfma_f32_16x16x32_bf16 v[144:147], v[32:35], a[48:51], v[144:147]
    ds_read_b64_tr_b16 v[24:25], v12 offset:28672
    v_mfma_f32_16x16x32_bf16 v[148:151], v[32:35], a[52:55], v[148:151]
    ds_read_b64_tr_b16 v[26:27], v12 offset:29184
    v_min_u32 v4, v4, v63
    v_and_b32 v63, 3, v4
    v_lshlrev_b32 v63, 5, v63
    v_mfma_f32_16x16x32_bf16 v[152:155], v[36:39], a[48:51], v[152:155]
    ds_read_b64_tr_b16 v[28:29], v13 offset:28672
    buffer_load_dwordx4 v56, s[20:23], s35 offen offset:2048 lds
    v_mfma_f32_16x16x32_bf16 v[156:159], v[36:39], a[52:55], v[156:159]
    ds_read_b64_tr_b16 v[30:31], v13 offset:29184
    v_xor_b32 v63, v63, v21
    v_lshrrev_b32 v4, 2, v4
    v_lshl_add_u32 v4, v4, 10, v63
    s_waitcnt lgkmcnt(4)
    v_mfma_f32_16x16x32_bf16 v[160:163], v[40:43], a[48:51], v[160:163]
    ds_read_b64_tr_b16 v[32:33], v14 offset:28672
    v_mfma_f32_16x16x32_bf16 v[164:167], v[40:43], a[52:55], v[164:167]
    ds_read_b64_tr_b16 v[34:35], v14 offset:29184
    v_accvgpr_write_b32 a243, v4
    v_add_u32 v4, 8, v23
    v_subrev_u32 v63, 12, v4
    v_mfma_f32_16x16x32_bf16 v[168:171], v[44:47], a[48:51], v[168:171]
    ds_read_b64_tr_b16 v[36:37], v15 offset:28672
    buffer_load_dwordx4 v57, s[20:23], s35 offen offset:3072 lds
    v_mfma_f32_16x16x32_bf16 v[172:175], v[44:47], a[52:55], v[172:175]
    ds_read_b64_tr_b16 v[38:39], v15 offset:29184
    v_min_u32 v4, v4, v63
    v_and_b32 v63, 3, v4
    v_lshlrev_b32 v63, 5, v63
    s_waitcnt lgkmcnt(4)
    v_mfma_f32_16x16x32_bf16 v[208:211], v[24:27], a[56:59], v[208:211]
    ds_read_b64_tr_b16 v[40:41], v12 offset:36864
    s_add_u32 m0, s72, 24576
    v_mfma_f32_16x16x32_bf16 v[212:215], v[24:27], a[60:63], v[212:215]
    ds_read_b64_tr_b16 v[42:43], v12 offset:37376
    s_add_u32 s35, s80, 1769472
    v_xor_b32 v63, v63, v21
    v_lshrrev_b32 v4, 2, v4
    v_lshl_add_u32 v4, v4, 10, v63
    v_mfma_f32_16x16x32_bf16 v[216:219], v[28:31], a[56:59], v[216:219]
    ds_read_b64_tr_b16 v[44:45], v13 offset:36864
    buffer_load_dwordx4 v2, s[8:11], s35 offen lds
    v_mfma_f32_16x16x32_bf16 v[220:223], v[28:31], a[60:63], v[220:223]
    ds_read_b64_tr_b16 v[46:47], v13 offset:37376
    v_accvgpr_write_b32 a244, v4
    v_add_u32 v4, 10, v23
    v_subrev_u32 v63, 12, v4
    s_waitcnt lgkmcnt(4)
    v_mfma_f32_16x16x32_bf16 v[224:227], v[32:35], a[56:59], v[224:227]
    ds_read_b64_tr_b16 v[24:25], v14 offset:36864
    v_mfma_f32_16x16x32_bf16 v[228:231], v[32:35], a[60:63], v[228:231]
    ds_read_b64_tr_b16 v[26:27], v14 offset:37376
    v_min_u32 v4, v4, v63
    v_and_b32 v63, 3, v4
    v_lshlrev_b32 v63, 5, v63
    v_mfma_f32_16x16x32_bf16 v[232:235], v[36:39], a[56:59], v[232:235]
    ds_read_b64_tr_b16 v[28:29], v15 offset:36864
    buffer_load_dwordx4 v3, s[8:11], s35 offen offset:1024 lds
    v_mfma_f32_16x16x32_bf16 v[236:239], v[36:39], a[60:63], v[236:239]
    ds_read_b64_tr_b16 v[30:31], v15 offset:37376
    v_xor_b32 v63, v63, v21
    v_lshrrev_b32 v4, 2, v4
    v_lshl_add_u32 v4, v4, 10, v63
    s_waitcnt lgkmcnt(4)
    v_mfma_f32_16x16x32_bf16 v[176:179], v[40:43], a[56:59], v[176:179]
    ds_read_b64_tr_b16 v[32:33], v12 offset:45056
    s_add_u32 m0, s72, 32768
    v_mfma_f32_16x16x32_bf16 v[180:183], v[40:43], a[60:63], v[180:183]
    ds_read_b64_tr_b16 v[34:35], v12 offset:45568
    s_add_u32 s35, s81, 1769472
    v_accvgpr_write_b32 a245, v4
    v_and_b32 v20, 31, v0
    v_mul_u32_u24 v242, 1152, v20
    v_mfma_f32_16x16x32_bf16 v[184:187], v[44:47], a[56:59], v[184:187]
    ds_read_b64_tr_b16 v[36:37], v13 offset:45056
    buffer_load_dwordx4 v2, s[8:11], s35 offen lds
    v_mfma_f32_16x16x32_bf16 v[188:191], v[44:47], a[60:63], v[188:191]
    ds_read_b64_tr_b16 v[38:39], v13 offset:45568
    v_lshl_add_u32 v242, v22, 4, v242
    v_lshlrev_b32 v253, 2, v20
    s_lshl_b32 s89, s68, 11
    s_waitcnt lgkmcnt(4)
    v_mfma_f32_16x16x32_bf16 v[192:195], v[24:27], a[56:59], v[192:195]
    ds_read_b64_tr_b16 v[40:41], v14 offset:45056
    v_mfma_f32_16x16x32_bf16 v[196:199], v[24:27], a[60:63], v[196:199]
    ds_read_b64_tr_b16 v[42:43], v14 offset:45568
    s_add_u32 s89, s89, 33030144
    s_lshl_b32 s88, s67, 7
    s_add_u32 s94, s89, s88
    v_mfma_f32_16x16x32_bf16 v[200:203], v[28:31], a[56:59], v[200:203]
    ds_read_b64_tr_b16 v[44:45], v15 offset:45056
    buffer_load_dwordx4 v3, s[8:11], s35 offen offset:1024 lds
    v_mfma_f32_16x16x32_bf16 v[204:207], v[28:31], a[60:63], v[204:207]
    ds_read_b64_tr_b16 v[46:47], v15 offset:45568
    s_lshl_b32 s88, s66, 2
    s_add_u32 s95, s94, s88
    s_lshl_b32 s88, s66, 7
    s_waitcnt vmcnt(8)
    s_barrier
    s_waitcnt lgkmcnt(4)
    v_mfma_f32_16x16x32_bf16 v[144:147], v[32:35], a[56:59], v[144:147]
    ds_read_b64_tr_b16 v[24:25], v8 offset:0
    ds_read_b128 a[64:67], v58 offset:49152
    v_mfma_f32_16x16x32_bf16 v[148:151], v[32:35], a[60:63], v[148:151]
    ds_read_b64_tr_b16 v[26:27], v8 offset:512
    ds_read_b128 a[68:71], v58 offset:51200
    s_add_u32 s89, s89, s88
    s_add_u32 s89, s89, 512
    s_mul_i32 s90, s68, 3
    v_mfma_f32_16x16x32_bf16 v[152:155], v[36:39], a[56:59], v[152:155]
    ds_read_b64_tr_b16 v[28:29], v9 offset:0
    s_add_u32 m0, s72, 40960
    s_add_u32 s35, s82, 1769472
    v_mfma_f32_16x16x32_bf16 v[156:159], v[36:39], a[60:63], v[156:159]
    ds_read_b64_tr_b16 v[30:31], v9 offset:512
    buffer_load_dwordx4 v2, s[8:11], s35 offen lds
    ds_read_b128 a[72:75], v59 offset:49152
    s_add_u32 s90, s90, s66
    s_mul_i32 s90, s90, 49152
    s_add_u32 s90, s90, 23592960
    s_waitcnt lgkmcnt(7)
    v_mfma_f32_16x16x32_bf16 v[160:163], v[40:43], a[56:59], v[160:163]
    ds_read_b64_tr_b16 v[32:33], v10 offset:0
    ds_read_b128 a[76:79], v59 offset:51200
    v_mfma_f32_16x16x32_bf16 v[164:167], v[40:43], a[60:63], v[164:167]
    ds_read_b64_tr_b16 v[34:35], v10 offset:512
    s_lshl_b32 s88, s67, 4
    s_add_u32 s48, s89, s88
    s_mul_i32 s88, s67, 12288
    v_mfma_f32_16x16x32_bf16 v[168:171], v[44:47], a[56:59], v[168:171]
    ds_read_b64_tr_b16 v[36:37], v11 offset:0
    buffer_load_dwordx4 v3, s[8:11], s35 offen offset:1024 lds
    v_mfma_f32_16x16x32_bf16 v[172:175], v[44:47], a[60:63], v[172:175]
    ds_read_b64_tr_b16 v[38:39], v11 offset:512
    s_add_u32 s58, s90, s88
    s_add_u32 s88, s67, 1
    s_and_b32 s88, s88, 3
    s_waitcnt lgkmcnt(6)
    v_mfma_f32_16x16x32_bf16 v[208:211], v[24:27], a[64:67], v[208:211]
    ds_read_b64_tr_b16 v[40:41], v8 offset:8192
    s_add_u32 m0, s70, 32768
    v_mfma_f32_16x16x32_bf16 v[212:215], v[24:27], a[68:71], v[212:215]
    ds_read_b64_tr_b16 v[42:43], v8 offset:8704
    s_add_u32 s35, s84, 768
    s_lshl_b32 s97, s88, 4
    s_add_u32 s97, s97, s89
    v_mfma_f32_16x16x32_bf16 v[216:219], v[28:31], a[64:67], v[216:219]
    ds_read_b64_tr_b16 v[44:45], v9 offset:8192
    buffer_load_dwordx4 v54, s[20:23], s35 offen offset:0 lds
    v_mfma_f32_16x16x32_bf16 v[220:223], v[28:31], a[68:71], v[220:223]
    ds_read_b64_tr_b16 v[46:47], v9 offset:8704
    s_add_u32 s49, s97, 0
    s_mul_i32 s88, s88, 12288
    s_waitcnt lgkmcnt(4)
    v_mfma_f32_16x16x32_bf16 v[224:227], v[32:35], a[64:67], v[224:227]
    ds_read_b64_tr_b16 v[24:25], v10 offset:8192
    v_mfma_f32_16x16x32_bf16 v[228:231], v[32:35], a[68:71], v[228:231]
    ds_read_b64_tr_b16 v[26:27], v10 offset:8704
    s_add_u32 s88, s88, s90
    s_add_u32 s55, s88, 0
    v_mfma_f32_16x16x32_bf16 v[232:235], v[36:39], a[64:67], v[232:235]
    ds_read_b64_tr_b16 v[28:29], v11 offset:8192
    buffer_load_dwordx4 v55, s[20:23], s35 offen offset:1024 lds
    v_mfma_f32_16x16x32_bf16 v[236:239], v[36:39], a[68:71], v[236:239]
    ds_read_b64_tr_b16 v[30:31], v11 offset:8704
    s_add_u32 s88, s67, 2
    s_and_b32 s88, s88, 3
    s_waitcnt lgkmcnt(4)
    v_mfma_f32_16x16x32_bf16 v[176:179], v[40:43], a[64:67], v[176:179]
    ds_read_b64_tr_b16 v[32:33], v8 offset:16384
    v_mfma_f32_16x16x32_bf16 v[180:183], v[40:43], a[68:71], v[180:183]
    ds_read_b64_tr_b16 v[34:35], v8 offset:16896
    s_lshl_b32 s97, s88, 4
    s_add_u32 s97, s97, s89
    v_mfma_f32_16x16x32_bf16 v[184:187], v[44:47], a[64:67], v[184:187]
    ds_read_b64_tr_b16 v[36:37], v9 offset:16384
    buffer_load_dwordx4 v56, s[20:23], s35 offen offset:2048 lds
    v_mfma_f32_16x16x32_bf16 v[188:191], v[44:47], a[68:71], v[188:191]
    ds_read_b64_tr_b16 v[38:39], v9 offset:16896
    s_add_u32 s50, s97, 4
    s_mul_i32 s88, s88, 12288
    s_waitcnt lgkmcnt(4)
    v_mfma_f32_16x16x32_bf16 v[192:195], v[24:27], a[64:67], v[192:195]
    ds_read_b64_tr_b16 v[40:41], v10 offset:16384
    v_mfma_f32_16x16x32_bf16 v[196:199], v[24:27], a[68:71], v[196:199]
    ds_read_b64_tr_b16 v[42:43], v10 offset:16896
    s_add_u32 s88, s88, s90
    s_add_u32 s56, s88, 3072
    v_mfma_f32_16x16x32_bf16 v[200:203], v[28:31], a[64:67], v[200:203]
    ds_read_b64_tr_b16 v[44:45], v11 offset:16384
    buffer_load_dwordx4 v57, s[20:23], s35 offen offset:3072 lds
    v_mfma_f32_16x16x32_bf16 v[204:207], v[28:31], a[68:71], v[204:207]
    ds_read_b64_tr_b16 v[46:47], v11 offset:16896
    s_add_u32 s88, s67, 3
    s_and_b32 s88, s88, 3
    s_waitcnt lgkmcnt(4)
    v_mfma_f32_16x16x32_bf16 v[144:147], v[32:35], a[64:67], v[144:147]
    ds_read_b64_tr_b16 v[24:25], v8 offset:4096
    s_add_u32 m0, s72, 49152
    v_mfma_f32_16x16x32_bf16 v[148:151], v[32:35], a[68:71], v[148:151]
    ds_read_b64_tr_b16 v[26:27], v8 offset:4608
    s_add_u32 s35, s74, 3538944
    s_lshl_b32 s97, s88, 4
    s_add_u32 s97, s97, s89
    v_mfma_f32_16x16x32_bf16 v[152:155], v[36:39], a[64:67], v[152:155]
    ds_read_b64_tr_b16 v[28:29], v9 offset:4096
    buffer_load_dwordx4 v2, s[8:11], s35 offen lds
    v_mfma_f32_16x16x32_bf16 v[156:159], v[36:39], a[68:71], v[156:159]
    ds_read_b64_tr_b16 v[30:31], v9 offset:4608
    s_add_u32 s51, s97, 8
    s_mul_i32 s88, s88, 12288
    s_waitcnt lgkmcnt(4)
    v_mfma_f32_16x16x32_bf16 v[160:163], v[40:43], a[64:67], v[160:163]
    ds_read_b64_tr_b16 v[32:33], v10 offset:4096
    v_mfma_f32_16x16x32_bf16 v[164:167], v[40:43], a[68:71], v[164:167]
    ds_read_b64_tr_b16 v[34:35], v10 offset:4608
    s_add_u32 s88, s88, s90
    s_add_u32 s57, s88, 6144
    v_mfma_f32_16x16x32_bf16 v[168:171], v[44:47], a[64:67], v[168:171]
    ds_read_b64_tr_b16 v[36:37], v11 offset:4096
    buffer_load_dwordx4 v3, s[8:11], s35 offen offset:1024 lds
    v_mfma_f32_16x16x32_bf16 v[172:175], v[44:47], a[68:71], v[172:175]
    ds_read_b64_tr_b16 v[38:39], v11 offset:4608
    s_lshl_b32 s88, s66, 2
    s_add_u32 s88, s88, s67
    s_waitcnt lgkmcnt(4)
    v_mfma_f32_16x16x32_bf16 v[208:211], v[24:27], a[72:75], v[208:211]
    ds_read_b64_tr_b16 v[40:41], v8 offset:12288
    s_add_u32 m0, s72, 57344
    v_mfma_f32_16x16x32_bf16 v[212:215], v[24:27], a[76:79], v[212:215]
    ds_read_b64_tr_b16 v[42:43], v8 offset:12800
    s_add_u32 s35, s75, 3538944
    s_mul_i32 s47, s88, 96
    s_mul_i32 s89, s88, 43
    v_mfma_f32_16x16x32_bf16 v[216:219], v[28:31], a[72:75], v[216:219]
    ds_read_b64_tr_b16 v[44:45], v9 offset:12288
    buffer_load_dwordx4 v2, s[8:11], s35 offen lds
    v_mfma_f32_16x16x32_bf16 v[220:223], v[28:31], a[76:79], v[220:223]
    ds_read_b64_tr_b16 v[46:47], v9 offset:12800
    s_lshr_b32 s89, s89, 7
    s_and_b32 s5, s68, 60
    s_waitcnt lgkmcnt(4)
    v_mfma_f32_16x16x32_bf16 v[224:227], v[32:35], a[72:75], v[224:227]
    ds_read_b64_tr_b16 v[24:25], v10 offset:12288
    v_mfma_f32_16x16x32_bf16 v[228:231], v[32:35], a[76:79], v[228:231]
    ds_read_b64_tr_b16 v[26:27], v10 offset:12800
    s_add_u32 s5, s5, s89
    s_lshl_b32 s5, s5, 11
    v_mfma_f32_16x16x32_bf16 v[232:235], v[36:39], a[72:75], v[232:235]
    ds_read_b64_tr_b16 v[28:29], v11 offset:12288
    buffer_load_dwordx4 v3, s[8:11], s35 offen offset:1024 lds
    v_mfma_f32_16x16x32_bf16 v[236:239], v[36:39], a[76:79], v[236:239]
    ds_read_b64_tr_b16 v[30:31], v11 offset:12800
    s_mul_i32 s89, s89, 3
    s_sub_u32 s89, s88, s89
    s_waitcnt lgkmcnt(4)
    v_mfma_f32_16x16x32_bf16 v[176:179], v[40:43], a[72:75], v[176:179]
    ds_read_b64_tr_b16 v[32:33], v8 offset:20480
    s_add_u32 m0, s72, 65536
    v_mfma_f32_16x16x32_bf16 v[180:183], v[40:43], a[76:79], v[180:183]
    ds_read_b64_tr_b16 v[34:35], v8 offset:20992
    s_add_u32 s35, s76, 3538944
    s_lshl_b32 s89, s89, 8
    s_add_u32 s5, s5, s89
    v_mfma_f32_16x16x32_bf16 v[184:187], v[44:47], a[72:75], v[184:187]
    ds_read_b64_tr_b16 v[36:37], v9 offset:20480
    buffer_load_dwordx4 v2, s[8:11], s35 offen lds
    v_mfma_f32_16x16x32_bf16 v[188:191], v[44:47], a[76:79], v[188:191]
    ds_read_b64_tr_b16 v[38:39], v9 offset:20992
    s_add_u32 s5, s5, 33031168
    s_add_u32 s47, s47, s69
    s_waitcnt lgkmcnt(4)
    v_mfma_f32_16x16x32_bf16 v[192:195], v[24:27], a[72:75], v[192:195]
    ds_read_b64_tr_b16 v[40:41], v10 offset:20480
    v_mfma_f32_16x16x32_bf16 v[196:199], v[24:27], a[76:79], v[196:199]
    ds_read_b64_tr_b16 v[42:43], v10 offset:20992
    s_lshl_b32 s96, s68, 8
    s_add_u32 s96, s96, 33357824
    v_mfma_f32_16x16x32_bf16 v[200:203], v[28:31], a[72:75], v[200:203]
    ds_read_b64_tr_b16 v[44:45], v11 offset:20480
    buffer_load_dwordx4 v3, s[8:11], s35 offen offset:1024 lds
    v_mfma_f32_16x16x32_bf16 v[204:207], v[28:31], a[76:79], v[204:207]
    ds_read_b64_tr_b16 v[46:47], v11 offset:20992
    v_min_u32 v249, 19, v0
    v_lshlrev_b32 v249, 2, v249
    s_waitcnt vmcnt(10)
    s_barrier
    s_waitcnt lgkmcnt(4)
    v_mfma_f32_16x16x32_bf16 v[144:147], v[32:35], a[72:75], v[144:147]
    ds_read_b64_tr_b16 v[24:25], v8 offset:24576
    ds_read_b128 a[80:83], v58 offset:0
    v_mfma_f32_16x16x32_bf16 v[148:151], v[32:35], a[76:79], v[148:151]
    ds_read_b64_tr_b16 v[26:27], v8 offset:25088
    ds_read_b128 a[84:87], v58 offset:2048
    s_mul_i32 s60, s88, 196608
    s_add_u32 s60, s60, 2359296
    v_mfma_f32_16x16x32_bf16 v[152:155], v[36:39], a[72:75], v[152:155]
    ds_read_b64_tr_b16 v[28:29], v9 offset:24576
    s_add_u32 m0, s70, 49152
    s_add_u32 s35, s85, 768
    v_mfma_f32_16x16x32_bf16 v[156:159], v[36:39], a[76:79], v[156:159]
    ds_read_b64_tr_b16 v[30:31], v9 offset:25088
    buffer_load_dwordx4 v54, s[20:23], s35 offen offset:0 lds
    ds_read_b128 a[88:91], v59 offset:0
    s_lshr_b32 s89, s68, 4
    s_lshl_b32 s89, s89, 10
    s_waitcnt lgkmcnt(7)
    v_mfma_f32_16x16x32_bf16 v[160:163], v[40:43], a[72:75], v[160:163]
    ds_read_b64_tr_b16 v[32:33], v10 offset:24576
    ds_read_b128 a[92:95], v59 offset:2048
    v_mfma_f32_16x16x32_bf16 v[164:167], v[40:43], a[76:79], v[164:167]
    ds_read_b64_tr_b16 v[34:35], v10 offset:25088
    s_add_u32 s60, s60, s89
    s_bfe_u32 s89, s68, 0x10003
    v_mfma_f32_16x16x32_bf16 v[168:171], v[44:47], a[72:75], v[168:171]
    ds_read_b64_tr_b16 v[36:37], v11 offset:24576
    buffer_load_dwordx4 v55, s[20:23], s35 offen offset:1024 lds
    v_mfma_f32_16x16x32_bf16 v[172:175], v[44:47], a[76:79], v[172:175]
    ds_read_b64_tr_b16 v[38:39], v11 offset:25088
    s_lshl_b32 s89, s89, 8
    s_add_u32 s60, s60, s89
    s_waitcnt lgkmcnt(6)
    v_mfma_f32_16x16x32_bf16 v[208:211], v[24:27], a[80:83], v[208:211]
    ds_read_b64_tr_b16 v[40:41], v8 offset:32768
    v_mfma_f32_16x16x32_bf16 v[212:215], v[24:27], a[84:87], v[212:215]
    ds_read_b64_tr_b16 v[42:43], v8 offset:33280
    s_and_b32 s89, s68, 4
    v_mfma_f32_16x16x32_bf16 v[216:219], v[28:31], a[80:83], v[216:219]
    ds_read_b64_tr_b16 v[44:45], v9 offset:32768
    buffer_load_dwordx4 v56, s[20:23], s35 offen offset:2048 lds
    v_mfma_f32_16x16x32_bf16 v[220:223], v[28:31], a[84:87], v[220:223]
    ds_read_b64_tr_b16 v[46:47], v9 offset:33280
    s_lshl_b32 s89, s89, 5
    s_waitcnt lgkmcnt(4)
    v_mfma_f32_16x16x32_bf16 v[224:227], v[32:35], a[80:83], v[224:227]
    ds_read_b64_tr_b16 v[24:25], v10 offset:32768
    v_mfma_f32_16x16x32_bf16 v[228:231], v[32:35], a[84:87], v[228:231]
    ds_read_b64_tr_b16 v[26:27], v10 offset:33280
    s_add_u32 s60, s60, s89
    v_mfma_f32_16x16x32_bf16 v[232:235], v[36:39], a[80:83], v[232:235]
    ds_read_b64_tr_b16 v[28:29], v11 offset:32768
    buffer_load_dwordx4 v57, s[20:23], s35 offen offset:3072 lds
    v_mfma_f32_16x16x32_bf16 v[236:239], v[36:39], a[84:87], v[236:239]
    ds_read_b64_tr_b16 v[30:31], v11 offset:33280
    s_mul_i32 s89, s3, 49152
    s_waitcnt lgkmcnt(4)
    v_mfma_f32_16x16x32_bf16 v[176:179], v[40:43], a[80:83], v[176:179]
    ds_read_b64_tr_b16 v[32:33], v8 offset:40960
    s_add_u32 m0, s72, 73728
    v_mfma_f32_16x16x32_bf16 v[180:183], v[40:43], a[84:87], v[180:183]
    ds_read_b64_tr_b16 v[34:35], v8 offset:41472
    s_add_u32 s35, s77, 3538944
    s_add_u32 s60, s60, s89
    v_mfma_f32_16x16x32_bf16 v[184:187], v[44:47], a[80:83], v[184:187]
    ds_read_b64_tr_b16 v[36:37], v9 offset:40960
    buffer_load_dwordx4 v2, s[8:11], s35 offen lds
    v_mfma_f32_16x16x32_bf16 v[188:191], v[44:47], a[84:87], v[188:191]
    ds_read_b64_tr_b16 v[38:39], v9 offset:41472
    s_mul_i32 s59, s3, 3072
    s_waitcnt lgkmcnt(4)
    v_mfma_f32_16x16x32_bf16 v[192:195], v[24:27], a[80:83], v[192:195]
    ds_read_b64_tr_b16 v[40:41], v10 offset:40960
    v_mfma_f32_16x16x32_bf16 v[196:199], v[24:27], a[84:87], v[196:199]
    ds_read_b64_tr_b16 v[42:43], v10 offset:41472
    s_add_u32 s59, s59, 147456
    v_mfma_f32_16x16x32_bf16 v[200:203], v[28:31], a[80:83], v[200:203]
    ds_read_b64_tr_b16 v[44:45], v11 offset:40960
    buffer_load_dwordx4 v3, s[8:11], s35 offen offset:1024 lds
    v_mfma_f32_16x16x32_bf16 v[204:207], v[28:31], a[84:87], v[204:207]
    ds_read_b64_tr_b16 v[46:47], v11 offset:41472
    s_cmp_eq_u32 s88, 10
    s_cselect_b32 s89, 19, 5
    s_waitcnt lgkmcnt(4)
    v_mfma_f32_16x16x32_bf16 v[144:147], v[32:35], a[80:83], v[144:147]
    ds_read_b64_tr_b16 v[24:25], v8 offset:28672
    s_add_u32 m0, s72, 81920
    v_mfma_f32_16x16x32_bf16 v[148:151], v[32:35], a[84:87], v[148:151]
    ds_read_b64_tr_b16 v[26:27], v8 offset:29184
    s_add_u32 s35, s78, 3538944
    v_mfma_f32_16x16x32_bf16 v[152:155], v[36:39], a[80:83], v[152:155]
    ds_read_b64_tr_b16 v[28:29], v9 offset:28672
    buffer_load_dwordx4 v2, s[8:11], s35 offen lds
    v_mfma_f32_16x16x32_bf16 v[156:159], v[36:39], a[84:87], v[156:159]
    ds_read_b64_tr_b16 v[30:31], v9 offset:29184
    s_cmp_eq_u32 s88, 11
    s_cselect_b32 s89, 47, s89
    s_waitcnt lgkmcnt(4)
    v_mfma_f32_16x16x32_bf16 v[160:163], v[40:43], a[80:83], v[160:163]
    ds_read_b64_tr_b16 v[32:33], v10 offset:28672
    v_mfma_f32_16x16x32_bf16 v[164:167], v[40:43], a[84:87], v[164:167]
    ds_read_b64_tr_b16 v[34:35], v10 offset:29184
    v_mfma_f32_16x16x32_bf16 v[168:171], v[44:47], a[80:83], v[168:171]
    ds_read_b64_tr_b16 v[36:37], v11 offset:28672
    buffer_load_dwordx4 v3, s[8:11], s35 offen offset:1024 lds
    v_mfma_f32_16x16x32_bf16 v[172:175], v[44:47], a[84:87], v[172:175]
    ds_read_b64_tr_b16 v[38:39], v11 offset:29184
    v_min_u32 v250, s89, v0
    s_waitcnt lgkmcnt(4)
    v_mfma_f32_16x16x32_bf16 v[208:211], v[24:27], a[88:91], v[208:211]
    ds_read_b64_tr_b16 v[40:41], v8 offset:36864
    s_add_u32 m0, s72, 90112
    v_mfma_f32_16x16x32_bf16 v[212:215], v[24:27], a[92:95], v[212:215]
    ds_read_b64_tr_b16 v[42:43], v8 offset:37376
    s_add_u32 s35, s79, 3538944
    v_lshlrev_b32 v250, 2, v250
    v_mfma_f32_16x16x32_bf16 v[216:219], v[28:31], a[88:91], v[216:219]
    ds_read_b64_tr_b16 v[44:45], v9 offset:36864
    buffer_load_dwordx4 v2, s[8:11], s35 offen lds
    v_mfma_f32_16x16x32_bf16 v[220:223], v[28:31], a[92:95], v[220:223]
    ds_read_b64_tr_b16 v[46:47], v9 offset:37376
    v_accvgpr_write_b32 a252, -1
L_pg1:
    s_cbranch_execz L_pg5
    s_waitcnt lgkmcnt(4)
    v_mfma_f32_16x16x32_bf16 v[224:227], v[32:35], a[88:91], v[224:227]
    ds_read_b64_tr_b16 v[24:25], v10 offset:36864
    v_mfma_f32_16x16x32_bf16 v[228:231], v[32:35], a[92:95], v[228:231]
    ds_read_b64_tr_b16 v[26:27], v10 offset:37376
    v_accvgpr_write_b32 a253, -1
    v_mfma_f32_16x16x32_bf16 v[232:235], v[36:39], a[88:91], v[232:235]
    ds_read_b64_tr_b16 v[28:29], v11 offset:36864
    buffer_load_dwordx4 v3, s[8:11], s35 offen offset:1024 lds
    v_mfma_f32_16x16x32_bf16 v[236:239], v[36:39], a[92:95], v[236:239]
    ds_read_b64_tr_b16 v[30:31], v11 offset:37376
    v_accvgpr_write_b32 a254, -1
    s_waitcnt lgkmcnt(4)
    v_mfma_f32_16x16x32_bf16 v[176:179], v[40:43], a[88:91], v[176:179]
    ds_read_b64_tr_b16 v[32:33], v8 offset:45056
    v_mfma_f32_16x16x32_bf16 v[180:183], v[40:43], a[92:95], v[180:183]
    ds_read_b64_tr_b16 v[34:35], v8 offset:45568
    v_accvgpr_write_b32 a255, -1
    v_mfma_f32_16x16x32_bf16 v[184:187], v[44:47], a[88:91], v[184:187]
    ds_read_b64_tr_b16 v[36:37], v9 offset:45056
    v_mfma_f32_16x16x32_bf16 v[188:191], v[44:47], a[92:95], v[188:191]
    ds_read_b64_tr_b16 v[38:39], v9 offset:45568
    v_mov_b32 v243, 1
    s_waitcnt lgkmcnt(4)
    v_mfma_f32_16x16x32_bf16 v[192:195], v[24:27], a[88:91], v[192:195]
    ds_read_b64_tr_b16 v[40:41], v10 offset:45056
    v_mfma_f32_16x16x32_bf16 v[196:199], v[24:27], a[92:95], v[196:199]
    ds_read_b64_tr_b16 v[42:43], v10 offset:45568
    v_mov_b32 v241, s51
    v_mfma_f32_16x16x32_bf16 v[200:203], v[28:31], a[88:91], v[200:203]
    ds_read_b64_tr_b16 v[44:45], v11 offset:45056
    v_mfma_f32_16x16x32_bf16 v[204:207], v[28:31], a[92:95], v[204:207]
    ds_read_b64_tr_b16 v[46:47], v11 offset:45568
    v_writelane_b32 v241, s49, 0
    s_waitcnt vmcnt(10)
    s_barrier
    s_waitcnt lgkmcnt(4)
    v_mfma_f32_16x16x32_bf16 v[144:147], v[32:35], a[88:91], v[144:147]
    ds_read_b64_tr_b16 v[24:25], v12 offset:0
    s_add_u32 m0, s72, 0
    s_add_u32 s35, s80, 3538944
    v_mfma_f32_16x16x32_bf16 v[148:151], v[32:35], a[92:95], v[148:151]
    ds_read_b64_tr_b16 v[26:27], v12 offset:512
    buffer_load_dwordx4 v2, s[8:11], s35 offen lds
    ds_read_b128 a[96:99], v58 offset:16384
    v_writelane_b32 v241, s50, 1
    v_mfma_f32_16x16x32_bf16 v[152:155], v[36:39], a[88:91], v[152:155]
    ds_read_b64_tr_b16 v[28:29], v13 offset:0
    ds_read_b128 a[100:103], v58 offset:18432
    v_mfma_f32_16x16x32_bf16 v[156:159], v[36:39], a[92:95], v[156:159]
    ds_read_b64_tr_b16 v[30:31], v13 offset:512
    s_waitcnt lgkmcnt(6)
    v_mfma_f32_16x16x32_bf16 v[160:163], v[40:43], a[88:91], v[160:163]
    ds_read_b64_tr_b16 v[32:33], v14 offset:0
    buffer_load_dwordx4 v3, s[8:11], s35 offen offset:1024 lds
    v_mfma_f32_16x16x32_bf16 v[164:167], v[40:43], a[92:95], v[164:167]
    ds_read_b64_tr_b16 v[34:35], v14 offset:512
    ds_read_b128 a[104:107], v59 offset:16384
    v_mfma_f32_16x16x32_bf16 v[168:171], v[44:47], a[88:91], v[168:171]
    ds_read_b64_tr_b16 v[36:37], v15 offset:0
    ds_read_b128 a[108:111], v59 offset:18432
    v_mfma_f32_16x16x32_bf16 v[172:175], v[44:47], a[92:95], v[172:175]
    ds_read_b64_tr_b16 v[38:39], v15 offset:512
    s_waitcnt lgkmcnt(6)
    v_mfma_f32_16x16x32_bf16 v[208:211], v[24:27], a[96:99], v[208:211]
    ds_read_b64_tr_b16 v[40:41], v12 offset:8192
    s_add_u32 m0, s72, 8192
    s_add_u32 s35, s81, 3538944
    v_mfma_f32_16x16x32_bf16 v[212:215], v[24:27], a[100:103], v[212:215]
    ds_read_b64_tr_b16 v[42:43], v12 offset:8704
    buffer_load_dwordx4 v2, s[8:11], s35 offen lds
    v_mfma_f32_16x16x32_bf16 v[216:219], v[28:31], a[96:99], v[216:219]
    ds_read_b64_tr_b16 v[44:45], v13 offset:8192
    v_mfma_f32_16x16x32_bf16 v[220:223], v[28:31], a[100:103], v[220:223]
    ds_read_b64_tr_b16 v[46:47], v13 offset:8704
    s_waitcnt lgkmcnt(4)
    v_mfma_f32_16x16x32_bf16 v[224:227], v[32:35], a[96:99], v[224:227]
    ds_read_b64_tr_b16 v[24:25], v14 offset:8192
    buffer_load_dwordx4 v3, s[8:11], s35 offen offset:1024 lds
    v_mfma_f32_16x16x32_bf16 v[228:231], v[32:35], a[100:103], v[228:231]
    ds_read_b64_tr_b16 v[26:27], v14 offset:8704
    s_add_u32 m0, s72, 16384
    v_mfma_f32_16x16x32_bf16 v[232:235], v[36:39], a[96:99], v[232:235]
    ds_read_b64_tr_b16 v[28:29], v15 offset:8192
    s_add_u32 s35, s82, 3538944
    v_mfma_f32_16x16x32_bf16 v[236:239], v[36:39], a[100:103], v[236:239]
    ds_read_b64_tr_b16 v[30:31], v15 offset:8704
    s_waitcnt lgkmcnt(4)
    v_mfma_f32_16x16x32_bf16 v[176:179], v[40:43], a[96:99], v[176:179]
    ds_read_b64_tr_b16 v[32:33], v12 offset:16384
    buffer_load_dwordx4 v2, s[8:11], s35 offen lds
    v_mfma_f32_16x16x32_bf16 v[180:183], v[40:43], a[100:103], v[180:183]
    ds_read_b64_tr_b16 v[34:35], v12 offset:16896
    v_mfma_f32_16x16x32_bf16 v[184:187], v[44:47], a[96:99], v[184:187]
    ds_read_b64_tr_b16 v[36:37], v13 offset:16384
    v_mfma_f32_16x16x32_bf16 v[188:191], v[44:47], a[100:103], v[188:191]
    ds_read_b64_tr_b16 v[38:39], v13 offset:16896
    s_waitcnt lgkmcnt(4)
    v_mfma_f32_16x16x32_bf16 v[192:195], v[24:27], a[96:99], v[192:195]
    ds_read_b64_tr_b16 v[40:41], v14 offset:16384
    buffer_load_dwordx4 v3, s[8:11], s35 offen offset:1024 lds
    v_mfma_f32_16x16x32_bf16 v[196:199], v[24:27], a[100:103], v[196:199]
    ds_read_b64_tr_b16 v[42:43], v14 offset:16896
    v_mfma_f32_16x16x32_bf16 v[200:203], v[28:31], a[96:99], v[200:203]
    ds_read_b64_tr_b16 v[44:45], v15 offset:16384
    v_mfma_f32_16x16x32_bf16 v[204:207], v[28:31], a[100:103], v[204:207]
    ds_read_b64_tr_b16 v[46:47], v15 offset:16896
    s_waitcnt lgkmcnt(4)
    v_mfma_f32_16x16x32_bf16 v[144:147], v[32:35], a[96:99], v[144:147]
    ds_read_b64_tr_b16 v[24:25], v12 offset:4096
    v_mfma_f32_16x16x32_bf16 v[148:151], v[32:35], a[100:103], v[148:151]
    ds_read_b64_tr_b16 v[26:27], v12 offset:4608
    v_mfma_f32_16x16x32_bf16 v[152:155], v[36:39], a[96:99], v[152:155]
    ds_read_b64_tr_b16 v[28:29], v13 offset:4096
    v_mfma_f32_16x16x32_bf16 v[156:159], v[36:39], a[100:103], v[156:159]
    ds_read_b64_tr_b16 v[30:31], v13 offset:4608
    s_waitcnt lgkmcnt(4)
    v_mfma_f32_16x16x32_bf16 v[160:163], v[40:43], a[96:99], v[160:163]
    ds_read_b64_tr_b16 v[32:33], v14 offset:4096
    v_mfma_f32_16x16x32_bf16 v[164:167], v[40:43], a[100:103], v[164:167]
    ds_read_b64_tr_b16 v[34:35], v14 offset:4608
    v_mfma_f32_16x16x32_bf16 v[168:171], v[44:47], a[96:99], v[168:171]
    ds_read_b64_tr_b16 v[36:37], v15 offset:4096
    v_mfma_f32_16x16x32_bf16 v[172:175], v[44:47], a[100:103], v[172:175]
    ds_read_b64_tr_b16 v[38:39], v15 offset:4608
    s_waitcnt lgkmcnt(4)
    v_mfma_f32_16x16x32_bf16 v[208:211], v[24:27], a[104:107], v[208:211]
    ds_read_b64_tr_b16 v[40:41], v12 offset:12288
    v_mfma_f32_16x16x32_bf16 v[212:215], v[24:27], a[108:111], v[212:215]
    ds_read_b64_tr_b16 v[42:43], v12 offset:12800
    v_mfma_f32_16x16x32_bf16 v[216:219], v[28:31], a[104:107], v[216:219]
    ds_read_b64_tr_b16 v[44:45], v13 offset:12288
    v_mfma_f32_16x16x32_bf16 v[220:223], v[28:31], a[108:111], v[220:223]
    ds_read_b64_tr_b16 v[46:47], v13 offset:12800
    s_waitcnt lgkmcnt(4)
    v_mfma_f32_16x16x32_bf16 v[224:227], v[32:35], a[104:107], v[224:227]
    ds_read_b64_tr_b16 v[24:25], v14 offset:12288
    v_mfma_f32_16x16x32_bf16 v[228:231], v[32:35], a[108:111], v[228:231]
    ds_read_b64_tr_b16 v[26:27], v14 offset:12800
    v_mfma_f32_16x16x32_bf16 v[232:235], v[36:39], a[104:107], v[232:235]
    ds_read_b64_tr_b16 v[28:29], v15 offset:12288
    v_mfma_f32_16x16x32_bf16 v[236:239], v[36:39], a[108:111], v[236:239]
    ds_read_b64_tr_b16 v[30:31], v15 offset:12800
    s_waitcnt lgkmcnt(4)
    v_mfma_f32_16x16x32_bf16 v[176:179], v[40:43], a[104:107], v[176:179]
    ds_read_b64_tr_b16 v[32:33], v12 offset:20480
    v_mfma_f32_16x16x32_bf16 v[180:183], v[40:43], a[108:111], v[180:183]
    ds_read_b64_tr_b16 v[34:35], v12 offset:20992
    v_mfma_f32_16x16x32_bf16 v[184:187], v[44:47], a[104:107], v[184:187]
    ds_read_b64_tr_b16 v[36:37], v13 offset:20480
    v_mfma_f32_16x16x32_bf16 v[188:191], v[44:47], a[108:111], v[188:191]
    ds_read_b64_tr_b16 v[38:39], v13 offset:20992
    s_waitcnt lgkmcnt(4)
    v_mfma_f32_16x16x32_bf16 v[192:195], v[24:27], a[104:107], v[192:195]
    ds_read_b64_tr_b16 v[40:41], v14 offset:20480
    v_mfma_f32_16x16x32_bf16 v[196:199], v[24:27], a[108:111], v[196:199]
    ds_read_b64_tr_b16 v[42:43], v14 offset:20992
    v_mfma_f32_16x16x32_bf16 v[200:203], v[28:31], a[104:107], v[200:203]
    ds_read_b64_tr_b16 v[44:45], v15 offset:20480
    v_mfma_f32_16x16x32_bf16 v[204:207], v[28:31], a[108:111], v[204:207]
    ds_read_b64_tr_b16 v[46:47], v15 offset:20992
    s_waitcnt vmcnt(6)
    s_barrier
    s_waitcnt lgkmcnt(4)
    v_mfma_f32_16x16x32_bf16 v[144:147], v[32:35], a[104:107], v[144:147]
    ds_read_b64_tr_b16 v[24:25], v12 offset:24576
    s_add_u32 m0, s72, 24576
    s_add_u32 s35, s74, 384
    v_mfma_f32_16x16x32_bf16 v[148:151], v[32:35], a[108:111], v[148:151]
    ds_read_b64_tr_b16 v[26:27], v12 offset:25088
    buffer_load_dwordx4 v2, s[8:11], s35 offen lds
    ds_read_b128 a[112:115], v58 offset:32768
    v_mfma_f32_16x16x32_bf16 v[152:155], v[36:39], a[104:107], v[152:155]
    ds_read_b64_tr_b16 v[28:29], v13 offset:24576
    ds_read_b128 a[116:119], v58 offset:34816
    v_mfma_f32_16x16x32_bf16 v[156:159], v[36:39], a[108:111], v[156:159]
    ds_read_b64_tr_b16 v[30:31], v13 offset:25088
    s_waitcnt lgkmcnt(6)
    v_mfma_f32_16x16x32_bf16 v[160:163], v[40:43], a[104:107], v[160:163]
    ds_read_b64_tr_b16 v[32:33], v14 offset:24576
    buffer_load_dwordx4 v3, s[8:11], s35 offen offset:1024 lds
    v_mfma_f32_16x16x32_bf16 v[164:167], v[40:43], a[108:111], v[164:167]
    ds_read_b64_tr_b16 v[34:35], v14 offset:25088
    ds_read_b128 a[120:123], v59 offset:32768
    v_mfma_f32_16x16x32_bf16 v[168:171], v[44:47], a[104:107], v[168:171]
    ds_read_b64_tr_b16 v[36:37], v15 offset:24576
    ds_read_b128 a[124:127], v59 offset:34816
    v_mfma_f32_16x16x32_bf16 v[172:175], v[44:47], a[108:111], v[172:175]
    ds_read_b64_tr_b16 v[38:39], v15 offset:25088
    s_waitcnt lgkmcnt(6)
    v_mfma_f32_16x16x32_bf16 v[208:211], v[24:27], a[112:115], v[208:211]
    ds_read_b64_tr_b16 v[40:41], v12 offset:32768
    s_add_u32 m0, s72, 32768
    s_add_u32 s35, s77, 384
    v_mfma_f32_16x16x32_bf16 v[212:215], v[24:27], a[116:119], v[212:215]
    ds_read_b64_tr_b16 v[42:43], v12 offset:33280
    buffer_load_dwordx4 v2, s[8:11], s35 offen lds
    v_mfma_f32_16x16x32_bf16 v[216:219], v[28:31], a[112:115], v[216:219]
    ds_read_b64_tr_b16 v[44:45], v13 offset:32768
    v_mfma_f32_16x16x32_bf16 v[220:223], v[28:31], a[116:119], v[220:223]
    ds_read_b64_tr_b16 v[46:47], v13 offset:33280
    s_waitcnt lgkmcnt(4)
    v_mfma_f32_16x16x32_bf16 v[224:227], v[32:35], a[112:115], v[224:227]
    ds_read_b64_tr_b16 v[24:25], v14 offset:32768
    buffer_load_dwordx4 v3, s[8:11], s35 offen offset:1024 lds
    v_mfma_f32_16x16x32_bf16 v[228:231], v[32:35], a[116:119], v[228:231]
    ds_read_b64_tr_b16 v[26:27], v14 offset:33280
    s_add_u32 m0, s72, 40960
    v_mfma_f32_16x16x32_bf16 v[232:235], v[36:39], a[112:115], v[232:235]
    ds_read_b64_tr_b16 v[28:29], v15 offset:32768
    s_add_u32 s35, s80, 384
    v_mfma_f32_16x16x32_bf16 v[236:239], v[36:39], a[116:119], v[236:239]
    ds_read_b64_tr_b16 v[30:31], v15 offset:33280
    s_waitcnt lgkmcnt(4)
    v_mfma_f32_16x16x32_bf16 v[176:179], v[40:43], a[112:115], v[176:179]
    ds_read_b64_tr_b16 v[32:33], v12 offset:40960
    buffer_load_dwordx4 v2, s[8:11], s35 offen lds
    v_mfma_f32_16x16x32_bf16 v[180:183], v[40:43], a[116:119], v[180:183]
    ds_read_b64_tr_b16 v[34:35], v12 offset:41472
    v_mfma_f32_16x16x32_bf16 v[184:187], v[44:47], a[112:115], v[184:187]
    ds_read_b64_tr_b16 v[36:37], v13 offset:40960
    v_mfma_f32_16x16x32_bf16 v[188:191], v[44:47], a[116:119], v[188:191]
    ds_read_b64_tr_b16 v[38:39], v13 offset:41472
    s_waitcnt lgkmcnt(4)
    v_mfma_f32_16x16x32_bf16 v[192:195], v[24:27], a[112:115], v[192:195]
    ds_read_b64_tr_b16 v[40:41], v14 offset:40960
    buffer_load_dwordx4 v3, s[8:11], s35 offen offset:1024 lds
    v_mfma_f32_16x16x32_bf16 v[196:199], v[24:27], a[116:119], v[196:199]
    ds_read_b64_tr_b16 v[42:43], v14 offset:41472
    s_add_u32 m0, s72, 98304
    v_mfma_f32_16x16x32_bf16 v[200:203], v[28:31], a[112:115], v[200:203]
    ds_read_b64_tr_b16 v[44:45], v15 offset:40960
    s_add_u32 s35, s74, 1769856
    v_mfma_f32_16x16x32_bf16 v[204:207], v[28:31], a[116:119], v[204:207]
    ds_read_b64_tr_b16 v[46:47], v15 offset:41472
    s_waitcnt lgkmcnt(4)
    v_mfma_f32_16x16x32_bf16 v[144:147], v[32:35], a[112:115], v[144:147]
    ds_read_b64_tr_b16 v[24:25], v12 offset:28672
    buffer_load_dwordx4 v2, s[8:11], s35 offen lds
    v_mfma_f32_16x16x32_bf16 v[148:151], v[32:35], a[116:119], v[148:151]
    ds_read_b64_tr_b16 v[26:27], v12 offset:29184
    v_mfma_f32_16x16x32_bf16 v[152:155], v[36:39], a[112:115], v[152:155]
    ds_read_b64_tr_b16 v[28:29], v13 offset:28672
    v_mfma_f32_16x16x32_bf16 v[156:159], v[36:39], a[116:119], v[156:159]
    ds_read_b64_tr_b16 v[30:31], v13 offset:29184
    s_waitcnt lgkmcnt(4)
    v_mfma_f32_16x16x32_bf16 v[160:163], v[40:43], a[112:115], v[160:163]
    ds_read_b64_tr_b16 v[32:33], v14 offset:28672
    buffer_load_dwordx4 v3, s[8:11], s35 offen offset:1024 lds
    v_mfma_f32_16x16x32_bf16 v[164:167], v[40:43], a[116:119], v[164:167]
    ds_read_b64_tr_b16 v[34:35], v14 offset:29184
    s_add_u32 m0, s72, 106496
    v_mfma_f32_16x16x32_bf16 v[168:171], v[44:47], a[112:115], v[168:171]
    ds_read_b64_tr_b16 v[36:37], v15 offset:28672
    s_add_u32 s35, s77, 1769856
    v_mfma_f32_16x16x32_bf16 v[172:175], v[44:47], a[116:119], v[172:175]
    ds_read_b64_tr_b16 v[38:39], v15 offset:29184
    s_waitcnt lgkmcnt(4)
    v_mfma_f32_16x16x32_bf16 v[208:211], v[24:27], a[120:123], v[208:211]
    ds_read_b64_tr_b16 v[40:41], v12 offset:36864
    buffer_load_dwordx4 v2, s[8:11], s35 offen lds
    v_mfma_f32_16x16x32_bf16 v[212:215], v[24:27], a[124:127], v[212:215]
    ds_read_b64_tr_b16 v[42:43], v12 offset:37376
    v_mfma_f32_16x16x32_bf16 v[216:219], v[28:31], a[120:123], v[216:219]
    ds_read_b64_tr_b16 v[44:45], v13 offset:36864
    v_mfma_f32_16x16x32_bf16 v[220:223], v[28:31], a[124:127], v[220:223]
    ds_read_b64_tr_b16 v[46:47], v13 offset:37376
    s_waitcnt lgkmcnt(4)
    v_mfma_f32_16x16x32_bf16 v[224:227], v[32:35], a[120:123], v[224:227]
    ds_read_b64_tr_b16 v[24:25], v14 offset:36864
    buffer_load_dwordx4 v3, s[8:11], s35 offen offset:1024 lds
    v_mfma_f32_16x16x32_bf16 v[228:231], v[32:35], a[124:127], v[228:231]
    ds_read_b64_tr_b16 v[26:27], v14 offset:37376
    s_add_u32 m0, s72, 114688
    v_mfma_f32_16x16x32_bf16 v[232:235], v[36:39], a[120:123], v[232:235]
    ds_read_b64_tr_b16 v[28:29], v15 offset:36864
    s_add_u32 s35, s80, 1769856
    v_mfma_f32_16x16x32_bf16 v[236:239], v[36:39], a[124:127], v[236:239]
    ds_read_b64_tr_b16 v[30:31], v15 offset:37376
    s_waitcnt lgkmcnt(4)
    v_mfma_f32_16x16x32_bf16 v[176:179], v[40:43], a[120:123], v[176:179]
    ds_read_b64_tr_b16 v[32:33], v12 offset:45056
    buffer_load_dwordx4 v2, s[8:11], s35 offen lds
    v_mfma_f32_16x16x32_bf16 v[180:183], v[40:43], a[124:127], v[180:183]
    ds_read_b64_tr_b16 v[34:35], v12 offset:45568
    v_mfma_f32_16x16x32_bf16 v[184:187], v[44:47], a[120:123], v[184:187]
    ds_read_b64_tr_b16 v[36:37], v13 offset:45056
    v_mfma_f32_16x16x32_bf16 v[188:191], v[44:47], a[124:127], v[188:191]
    ds_read_b64_tr_b16 v[38:39], v13 offset:45568
    s_waitcnt lgkmcnt(4)
    v_mfma_f32_16x16x32_bf16 v[192:195], v[24:27], a[120:123], v[192:195]
    ds_read_b64_tr_b16 v[40:41], v14 offset:45056
    buffer_load_dwordx4 v3, s[8:11], s35 offen offset:1024 lds
    v_mfma_f32_16x16x32_bf16 v[196:199], v[24:27], a[124:127], v[196:199]
    ds_read_b64_tr_b16 v[42:43], v14 offset:45568
    v_mfma_f32_16x16x32_bf16 v[200:203], v[28:31], a[120:123], v[200:203]
    ds_read_b64_tr_b16 v[44:45], v15 offset:45056
    v_mfma_f32_16x16x32_bf16 v[204:207], v[28:31], a[124:127], v[204:207]
    ds_read_b64_tr_b16 v[46:47], v15 offset:45568
    s_waitcnt vmcnt(12)
    s_barrier
    s_waitcnt lgkmcnt(4)
    v_mfma_f32_16x16x32_bf16 v[144:147], v[32:35], a[120:123], v[144:147]
    ds_read_b64_tr_b16 v[24:25], v8 offset:0
    s_add_u32 m0, s72, 49152
    s_add_u32 s35, s74, 3539328
    v_mfma_f32_16x16x32_bf16 v[148:151], v[32:35], a[124:127], v[148:151]
    ds_read_b64_tr_b16 v[26:27], v8 offset:512
    buffer_load_dwordx4 v2, s[8:11], s35 offen lds
    ds_read_b128 a[128:131], v58 offset:49152
    v_mfma_f32_16x16x32_bf16 v[152:155], v[36:39], a[120:123], v[152:155]
    ds_read_b64_tr_b16 v[28:29], v9 offset:0
    ds_read_b128 a[132:135], v58 offset:51200
    v_mfma_f32_16x16x32_bf16 v[156:159], v[36:39], a[124:127], v[156:159]
    ds_read_b64_tr_b16 v[30:31], v9 offset:512
    s_waitcnt lgkmcnt(6)
    v_mfma_f32_16x16x32_bf16 v[160:163], v[40:43], a[120:123], v[160:163]
    ds_read_b64_tr_b16 v[32:33], v10 offset:0
    buffer_load_dwordx4 v3, s[8:11], s35 offen offset:1024 lds
    v_mfma_f32_16x16x32_bf16 v[164:167], v[40:43], a[124:127], v[164:167]
    ds_read_b64_tr_b16 v[34:35], v10 offset:512
    ds_read_b128 a[136:139], v59 offset:49152
    v_mfma_f32_16x16x32_bf16 v[168:171], v[44:47], a[120:123], v[168:171]
    ds_read_b64_tr_b16 v[36:37], v11 offset:0
    ds_read_b128 a[140:143], v59 offset:51200
    v_mfma_f32_16x16x32_bf16 v[172:175], v[44:47], a[124:127], v[172:175]
    ds_read_b64_tr_b16 v[38:39], v11 offset:512
    s_waitcnt lgkmcnt(6)
    v_mfma_f32_16x16x32_bf16 v[208:211], v[24:27], a[128:131], v[208:211]
    ds_read_b64_tr_b16 v[40:41], v8 offset:8192
    s_add_u32 m0, s72, 57344
    s_add_u32 s35, s77, 3539328
    v_mfma_f32_16x16x32_bf16 v[212:215], v[24:27], a[132:135], v[212:215]
    ds_read_b64_tr_b16 v[42:43], v8 offset:8704
    buffer_load_dwordx4 v2, s[8:11], s35 offen lds
    v_mfma_f32_16x16x32_bf16 v[216:219], v[28:31], a[128:131], v[216:219]
    ds_read_b64_tr_b16 v[44:45], v9 offset:8192
    v_mfma_f32_16x16x32_bf16 v[220:223], v[28:31], a[132:135], v[220:223]
    ds_read_b64_tr_b16 v[46:47], v9 offset:8704
    s_waitcnt lgkmcnt(4)
    v_mfma_f32_16x16x32_bf16 v[224:227], v[32:35], a[128:131], v[224:227]
    ds_read_b64_tr_b16 v[24:25], v10 offset:8192
    buffer_load_dwordx4 v3, s[8:11], s35 offen offset:1024 lds
    v_mfma_f32_16x16x32_bf16 v[228:231], v[32:35], a[132:135], v[228:231]
    ds_read_b64_tr_b16 v[26:27], v10 offset:8704
    s_add_u32 m0, s72, 65536
    v_mfma_f32_16x16x32_bf16 v[232:235], v[36:39], a[128:131], v[232:235]
    ds_read_b64_tr_b16 v[28:29], v11 offset:8192
    s_add_u32 s35, s80, 3539328
    v_mfma_f32_16x16x32_bf16 v[236:239], v[36:39], a[132:135], v[236:239]
    ds_read_b64_tr_b16 v[30:31], v11 offset:8704
    s_waitcnt lgkmcnt(4)
    v_mfma_f32_16x16x32_bf16 v[176:179], v[40:43], a[128:131], v[176:179]
    ds_read_b64_tr_b16 v[32:33], v8 offset:16384
    buffer_load_dwordx4 v2, s[8:11], s35 offen lds
    v_mfma_f32_16x16x32_bf16 v[180:183], v[40:43], a[132:135], v[180:183]
    ds_read_b64_tr_b16 v[34:35], v8 offset:16896
    v_mfma_f32_16x16x32_bf16 v[184:187], v[44:47], a[128:131], v[184:187]
    ds_read_b64_tr_b16 v[36:37], v9 offset:16384
    v_mfma_f32_16x16x32_bf16 v[188:191], v[44:47], a[132:135], v[188:191]
    ds_read_b64_tr_b16 v[38:39], v9 offset:16896
    s_waitcnt lgkmcnt(4)
    v_mfma_f32_16x16x32_bf16 v[192:195], v[24:27], a[128:131], v[192:195]
    ds_read_b64_tr_b16 v[40:41], v10 offset:16384
    buffer_load_dwordx4 v3, s[8:11], s35 offen offset:1024 lds
    v_mfma_f32_16x16x32_bf16 v[196:199], v[24:27], a[132:135], v[196:199]
    ds_read_b64_tr_b16 v[42:43], v10 offset:16896
    s_add_u32 m0, s72, 122880
    v_mfma_f32_16x16x32_bf16 v[200:203], v[28:31], a[128:131], v[200:203]
    ds_read_b64_tr_b16 v[44:45], v11 offset:16384
    s_add_u32 s35, s75, 384
    v_mfma_f32_16x16x32_bf16 v[204:207], v[28:31], a[132:135], v[204:207]
    ds_read_b64_tr_b16 v[46:47], v11 offset:16896
    s_waitcnt lgkmcnt(4)
    v_mfma_f32_16x16x32_bf16 v[144:147], v[32:35], a[128:131], v[144:147]
    ds_read_b64_tr_b16 v[24:25], v8 offset:4096
    buffer_load_dwordx4 v2, s[8:11], s35 offen lds
    v_mfma_f32_16x16x32_bf16 v[148:151], v[32:35], a[132:135], v[148:151]
    ds_read_b64_tr_b16 v[26:27], v8 offset:4608
    v_mfma_f32_16x16x32_bf16 v[152:155], v[36:39], a[128:131], v[152:155]
    ds_read_b64_tr_b16 v[28:29], v9 offset:4096
    v_mfma_f32_16x16x32_bf16 v[156:159], v[36:39], a[132:135], v[156:159]
    ds_read_b64_tr_b16 v[30:31], v9 offset:4608
    s_waitcnt lgkmcnt(4)
    v_mfma_f32_16x16x32_bf16 v[160:163], v[40:43], a[128:131], v[160:163]
    ds_read_b64_tr_b16 v[32:33], v10 offset:4096
    buffer_load_dwordx4 v3, s[8:11], s35 offen offset:1024 lds
    v_mfma_f32_16x16x32_bf16 v[164:167], v[40:43], a[132:135], v[164:167]
    ds_read_b64_tr_b16 v[34:35], v10 offset:4608
    s_add_u32 m0, s72, 131072
    v_mfma_f32_16x16x32_bf16 v[168:171], v[44:47], a[128:131], v[168:171]
    ds_read_b64_tr_b16 v[36:37], v11 offset:4096
    s_add_u32 s35, s78, 384
    v_mfma_f32_16x16x32_bf16 v[172:175], v[44:47], a[132:135], v[172:175]
    ds_read_b64_tr_b16 v[38:39], v11 offset:4608
    s_waitcnt lgkmcnt(4)
    v_mfma_f32_16x16x32_bf16 v[208:211], v[24:27], a[136:139], v[208:211]
    ds_read_b64_tr_b16 v[40:41], v8 offset:12288
    buffer_load_dwordx4 v2, s[8:11], s35 offen lds
    v_mfma_f32_16x16x32_bf16 v[212:215], v[24:27], a[140:143], v[212:215]
    ds_read_b64_tr_b16 v[42:43], v8 offset:12800
    v_mfma_f32_16x16x32_bf16 v[216:219], v[28:31], a[136:139], v[216:219]
    ds_read_b64_tr_b16 v[44:45], v9 offset:12288
    v_mfma_f32_16x16x32_bf16 v[220:223], v[28:31], a[140:143], v[220:223]
    ds_read_b64_tr_b16 v[46:47], v9 offset:12800
    s_waitcnt lgkmcnt(4)
    v_mfma_f32_16x16x32_bf16 v[224:227], v[32:35], a[136:139], v[224:227]
    ds_read_b64_tr_b16 v[24:25], v10 offset:12288
    buffer_load_dwordx4 v3, s[8:11], s35 offen offset:1024 lds
    v_mfma_f32_16x16x32_bf16 v[228:231], v[32:35], a[140:143], v[228:231]
    ds_read_b64_tr_b16 v[26:27], v10 offset:12800
    s_add_u32 m0, s72, 139264
    v_mfma_f32_16x16x32_bf16 v[232:235], v[36:39], a[136:139], v[232:235]
    ds_read_b64_tr_b16 v[28:29], v11 offset:12288
    s_add_u32 s35, s81, 384
    v_mfma_f32_16x16x32_bf16 v[236:239], v[36:39], a[140:143], v[236:239]
    ds_read_b64_tr_b16 v[30:31], v11 offset:12800
    s_waitcnt lgkmcnt(4)
    v_mfma_f32_16x16x32_bf16 v[176:179], v[40:43], a[136:139], v[176:179]
    ds_read_b64_tr_b16 v[32:33], v8 offset:20480
    buffer_load_dwordx4 v2, s[8:11], s35 offen lds
    v_mfma_f32_16x16x32_bf16 v[180:183], v[40:43], a[140:143], v[180:183]
    ds_read_b64_tr_b16 v[34:35], v8 offset:20992
    v_mfma_f32_16x16x32_bf16 v[184:187], v[44:47], a[136:139], v[184:187]
    ds_read_b64_tr_b16 v[36:37], v9 offset:20480
    v_mfma_f32_16x16x32_bf16 v[188:191], v[44:47], a[140:143], v[188:191]
    ds_read_b64_tr_b16 v[38:39], v9 offset:20992
    s_waitcnt lgkmcnt(4)
    v_mfma_f32_16x16x32_bf16 v[192:195], v[24:27], a[136:139], v[192:195]
    ds_read_b64_tr_b16 v[40:41], v10 offset:20480
    buffer_load_dwordx4 v3, s[8:11], s35 offen offset:1024 lds
    v_mfma_f32_16x16x32_bf16 v[196:199], v[24:27], a[140:143], v[196:199]
    ds_read_b64_tr_b16 v[42:43], v10 offset:20992
    v_mfma_f32_16x16x32_bf16 v[200:203], v[28:31], a[136:139], v[200:203]
    ds_read_b64_tr_b16 v[44:45], v11 offset:20480
    v_mfma_f32_16x16x32_bf16 v[204:207], v[28:31], a[140:143], v[204:207]
    ds_read_b64_tr_b16 v[46:47], v11 offset:20992
    s_waitcnt vmcnt(18)
    s_barrier
    s_cmp_lg_u32 s3, 0
    s_cbranch_scc1 L_w0_1
    buffer_load_dword v248, v249, s[16:19], s4 offen sc1
L_w0_1:
    s_waitcnt lgkmcnt(4)
    v_mfma_f32_16x16x32_bf16 v[144:147], v[32:35], a[136:139], v[144:147]
    ds_read_b64_tr_b16 v[24:25], v8 offset:24576
    buffer_store_dwordx4 a[252:255], v1, s[16:19], s55 offen offset:0 sc1
    v_mfma_f32_16x16x32_bf16 v[148:151], v[32:35], a[140:143], v[148:151]
    ds_read_b64_tr_b16 v[26:27], v8 offset:25088
    s_add_u32 m0, s72, 73728
    v_mfma_f32_16x16x32_bf16 v[152:155], v[36:39], a[136:139], v[152:155]
    ds_read_b64_tr_b16 v[28:29], v9 offset:24576
    s_add_u32 s35, s75, 1769856
    v_mfma_f32_16x16x32_bf16 v[156:159], v[36:39], a[140:143], v[156:159]
    ds_read_b64_tr_b16 v[30:31], v9 offset:25088
    s_waitcnt lgkmcnt(4)
    v_mfma_f32_16x16x32_bf16 v[160:163], v[40:43], a[136:139], v[160:163]
    ds_read_b64_tr_b16 v[32:33], v10 offset:24576
    buffer_load_dwordx4 v2, s[8:11], s35 offen lds
    v_mfma_f32_16x16x32_bf16 v[164:167], v[40:43], a[140:143], v[164:167]
    ds_read_b64_tr_b16 v[34:35], v10 offset:25088
    v_mfma_f32_16x16x32_bf16 v[168:171], v[44:47], a[136:139], v[168:171]
    ds_read_b64_tr_b16 v[36:37], v11 offset:24576
    v_mfma_f32_16x16x32_bf16 v[172:175], v[44:47], a[140:143], v[172:175]
    ds_read_b64_tr_b16 v[38:39], v11 offset:25088
    s_waitcnt lgkmcnt(4)
    v_mfma_f32_16x16x32_bf16 v[48:51], v[24:27], a[0:3], 0
    ds_read_b64_tr_b16 v[40:41], v8 offset:28672
    v_mfma_f32_16x16x32_bf16 v[52:55], v[24:27], a[4:7], 0
    ds_read_b64_tr_b16 v[42:43], v8 offset:29184
    v_mfma_f32_16x16x32_bf16 v[56:59], v[28:31], a[0:3], 0
    ds_read_b64_tr_b16 v[44:45], v9 offset:28672
    v_mfma_f32_16x16x32_bf16 v[60:63], v[28:31], a[4:7], 0
    ds_read_b64_tr_b16 v[46:47], v9 offset:29184
    s_waitcnt lgkmcnt(4)
    v_mfma_f32_16x16x32_bf16 v[64:67], v[32:35], a[0:3], 0
    ds_read_b64_tr_b16 v[24:25], v10 offset:28672
    buffer_load_dwordx4 v3, s[8:11], s35 offen offset:1024 lds
    v_mfma_f32_16x16x32_bf16 v[68:71], v[32:35], a[4:7], 0
    ds_read_b64_tr_b16 v[26:27], v10 offset:29184
    s_add_u32 m0, s72, 81920
    v_mfma_f32_16x16x32_bf16 v[72:75], v[36:39], a[0:3], 0
    ds_read_b64_tr_b16 v[28:29], v11 offset:28672
    s_add_u32 s35, s78, 1769856
    v_mfma_f32_16x16x32_bf16 v[76:79], v[36:39], a[4:7], 0
    ds_read_b64_tr_b16 v[30:31], v11 offset:29184
    s_waitcnt lgkmcnt(4)
    v_mfma_f32_16x16x32_bf16 v[48:51], v[40:43], a[8:11], v[48:51]
    ds_read_b64_tr_b16 v[32:33], v8 offset:32768
    buffer_store_dwordx4 a[252:255], v1, s[16:19], s55 offen offset:1024 sc1
    v_mfma_f32_16x16x32_bf16 v[52:55], v[40:43], a[12:15], v[52:55]
    ds_read_b64_tr_b16 v[34:35], v8 offset:33280
    v_mfma_f32_16x16x32_bf16 v[56:59], v[44:47], a[8:11], v[56:59]
    ds_read_b64_tr_b16 v[36:37], v9 offset:32768
    v_mfma_f32_16x16x32_bf16 v[60:63], v[44:47], a[12:15], v[60:63]
    ds_read_b64_tr_b16 v[38:39], v9 offset:33280
    s_waitcnt lgkmcnt(4)
    v_mfma_f32_16x16x32_bf16 v[64:67], v[24:27], a[8:11], v[64:67]
    ds_read_b64_tr_b16 v[40:41], v10 offset:32768
    buffer_load_dwordx4 v2, s[8:11], s35 offen lds
    v_mfma_f32_16x16x32_bf16 v[68:71], v[24:27], a[12:15], v[68:71]
    ds_read_b64_tr_b16 v[42:43], v10 offset:33280
    v_mfma_f32_16x16x32_bf16 v[72:75], v[28:31], a[8:11], v[72:75]
    ds_read_b64_tr_b16 v[44:45], v11 offset:32768
    v_mfma_f32_16x16x32_bf16 v[76:79], v[28:31], a[12:15], v[76:79]
    ds_read_b64_tr_b16 v[46:47], v11 offset:33280
    s_waitcnt lgkmcnt(4)
    v_mfma_f32_16x16x32_bf16 v[48:51], v[32:35], a[16:19], v[48:51]
    ds_read_b64_tr_b16 v[24:25], v8 offset:36864
    v_mfma_f32_16x16x32_bf16 v[52:55], v[32:35], a[20:23], v[52:55]
    ds_read_b64_tr_b16 v[26:27], v8 offset:37376
    v_mfma_f32_16x16x32_bf16 v[56:59], v[36:39], a[16:19], v[56:59]
    ds_read_b64_tr_b16 v[28:29], v9 offset:36864
    v_mfma_f32_16x16x32_bf16 v[60:63], v[36:39], a[20:23], v[60:63]
    ds_read_b64_tr_b16 v[30:31], v9 offset:37376
    s_waitcnt lgkmcnt(4)
    v_mfma_f32_16x16x32_bf16 v[64:67], v[40:43], a[16:19], v[64:67]
    ds_read_b64_tr_b16 v[32:33], v10 offset:36864
    buffer_load_dwordx4 v3, s[8:11], s35 offen offset:1024 lds
    v_mfma_f32_16x16x32_bf16 v[68:71], v[40:43], a[20:23], v[68:71]
    ds_read_b64_tr_b16 v[34:35], v10 offset:37376
    s_add_u32 m0, s72, 90112
    v_mfma_f32_16x16x32_bf16 v[72:75], v[44:47], a[16:19], v[72:75]
    ds_read_b64_tr_b16 v[36:37], v11 offset:36864
    s_add_u32 s35, s81, 1769856
    v_mfma_f32_16x16x32_bf16 v[76:79], v[44:47], a[20:23], v[76:79]
    ds_read_b64_tr_b16 v[38:39], v11 offset:37376
    s_waitcnt lgkmcnt(4)
    v_mfma_f32_16x16x32_bf16 v[48:51], v[24:27], a[24:27], v[48:51]
    ds_read_b64_tr_b16 v[40:41], v8 offset:40960
    buffer_store_dwordx4 a[252:255], v1, s[16:19], s55 offen offset:2048 sc1
    v_mfma_f32_16x16x32_bf16 v[52:55], v[24:27], a[28:31], v[52:55]
    ds_read_b64_tr_b16 v[42:43], v8 offset:41472
    v_mfma_f32_16x16x32_bf16 v[56:59], v[28:31], a[24:27], v[56:59]
    ds_read_b64_tr_b16 v[44:45], v9 offset:40960
    v_mfma_f32_16x16x32_bf16 v[60:63], v[28:31], a[28:31], v[60:63]
    ds_read_b64_tr_b16 v[46:47], v9 offset:41472
    s_waitcnt lgkmcnt(4)
    v_mfma_f32_16x16x32_bf16 v[64:67], v[32:35], a[24:27], v[64:67]
    ds_read_b64_tr_b16 v[24:25], v10 offset:40960
    buffer_load_dwordx4 v2, s[8:11], s35 offen lds
    v_mfma_f32_16x16x32_bf16 v[68:71], v[32:35], a[28:31], v[68:71]
    ds_read_b64_tr_b16 v[26:27], v10 offset:41472
    v_mfma_f32_16x16x32_bf16 v[72:75], v[36:39], a[24:27], v[72:75]
L_pg2:
    s_cbranch_execz L_pg6
    ds_read_b64_tr_b16 v[28:29], v11 offset:40960
    v_mfma_f32_16x16x32_bf16 v[76:79], v[36:39], a[28:31], v[76:79]
    ds_read_b64_tr_b16 v[30:31], v11 offset:41472
    s_waitcnt lgkmcnt(4)
    v_mfma_f32_16x16x32_bf16 v[48:51], v[40:43], a[32:35], v[48:51]
    ds_read_b64_tr_b16 v[32:33], v8 offset:45056
    buffer_load_dwordx4 v3, s[8:11], s35 offen offset:1024 lds
    v_mfma_f32_16x16x32_bf16 v[52:55], v[40:43], a[36:39], v[52:55]
    ds_read_b64_tr_b16 v[34:35], v8 offset:45568
    v_mfma_f32_16x16x32_bf16 v[56:59], v[44:47], a[32:35], v[56:59]
    ds_read_b64_tr_b16 v[36:37], v9 offset:45056
    v_mfma_f32_16x16x32_bf16 v[60:63], v[44:47], a[36:39], v[60:63]
    ds_read_b64_tr_b16 v[38:39], v9 offset:45568
    s_waitcnt lgkmcnt(4)
    v_mfma_f32_16x16x32_bf16 v[64:67], v[24:27], a[32:35], v[64:67]
    ds_read_b64_tr_b16 v[40:41], v10 offset:45056
    v_mfma_f32_16x16x32_bf16 v[68:71], v[24:27], a[36:39], v[68:71]
    ds_read_b64_tr_b16 v[42:43], v10 offset:45568
    v_mfma_f32_16x16x32_bf16 v[72:75], v[28:31], a[32:35], v[72:75]
    ds_read_b64_tr_b16 v[44:45], v11 offset:45056
    v_mfma_f32_16x16x32_bf16 v[76:79], v[28:31], a[36:39], v[76:79]
    ds_read_b64_tr_b16 v[46:47], v11 offset:45568
    s_waitcnt vmcnt(21)
    s_cmp_lg_u32 s3, 0
    s_cbranch_scc1 L_w0_2
    s_waitcnt vmcnt(9)
    v_cmp_eq_u32 vcc, 0, v248
    s_cbranch_vccnz L_slow_5
L_ok_3:
L_w0_2:
    s_barrier
    v_xor_b32 v248, 32, v251
    s_waitcnt lgkmcnt(4)
    v_mfma_f32_16x16x32_bf16 v[48:51], v[32:35], a[40:43], v[48:51]
    ds_read_b64_tr_b16 v[24:25], v16 offset:0
    s_add_u32 m0, s59, 0
    v_mfma_f32_16x16x32_bf16 v[52:55], v[32:35], a[44:47], v[52:55]
    ds_read_b64_tr_b16 v[26:27], v16 offset:512
    buffer_load_dwordx4 v251, s[16:19], s52 offen sc1 lds
    v_mfma_f32_16x16x32_bf16 v[56:59], v[36:39], a[40:43], v[56:59]
    ds_read_b64_tr_b16 v[28:29], v17 offset:0
    buffer_load_dword v244, v253, s[16:19], s96 offen sc1
    v_mfma_f32_16x16x32_bf16 v[60:63], v[36:39], a[44:47], v[60:63]
    ds_read_b64_tr_b16 v[30:31], v17 offset:512
    s_waitcnt lgkmcnt(4)
    v_mfma_f32_16x16x32_bf16 v[64:67], v[40:43], a[40:43], v[64:67]
    ds_read_b64_tr_b16 v[32:33], v18 offset:0
    buffer_load_dword v252, v253, s[16:19], s96 offen offset:128 sc1
    v_mfma_f32_16x16x32_bf16 v[68:71], v[40:43], a[44:47], v[68:71]
    ds_read_b64_tr_b16 v[34:35], v18 offset:512
    s_add_u32 m0, s59, 1024
    v_mfma_f32_16x16x32_bf16 v[72:75], v[44:47], a[40:43], v[72:75]
    ds_read_b64_tr_b16 v[36:37], v19 offset:0
    v_mfma_f32_16x16x32_bf16 v[76:79], v[44:47], a[44:47], v[76:79]
    ds_read_b64_tr_b16 v[38:39], v19 offset:512
    s_waitcnt lgkmcnt(4)
    v_mfma_f32_16x16x32_bf16 v[48:51], v[24:27], a[48:51], v[48:51]
    ds_read_b64_tr_b16 v[40:41], v16 offset:4096
    buffer_load_dwordx4 v248, s[16:19], s53 offen sc1 lds
    v_mfma_f32_16x16x32_bf16 v[52:55], v[24:27], a[52:55], v[52:55]
    ds_read_b64_tr_b16 v[42:43], v16 offset:4608
    s_add_u32 m0, s59, 2048
    v_mfma_f32_16x16x32_bf16 v[56:59], v[28:31], a[48:51], v[56:59]
    ds_read_b64_tr_b16 v[44:45], v17 offset:4096
    v_mfma_f32_16x16x32_bf16 v[60:63], v[28:31], a[52:55], v[60:63]
    ds_read_b64_tr_b16 v[46:47], v17 offset:4608
    s_waitcnt lgkmcnt(4)
    v_mfma_f32_16x16x32_bf16 v[64:67], v[32:35], a[48:51], v[64:67]
    ds_read_b64_tr_b16 v[24:25], v18 offset:4096
    buffer_load_dwordx4 v251, s[16:19], s54 offen sc1 lds
    v_mfma_f32_16x16x32_bf16 v[68:71], v[32:35], a[52:55], v[68:71]
    ds_read_b64_tr_b16 v[26:27], v18 offset:4608
    s_add_u32 m0, s72, 0
    v_mfma_f32_16x16x32_bf16 v[72:75], v[36:39], a[48:51], v[72:75]
    ds_read_b64_tr_b16 v[28:29], v19 offset:4096
    s_add_u32 s35, s75, 3539328
    v_mfma_f32_16x16x32_bf16 v[76:79], v[36:39], a[52:55], v[76:79]
    ds_read_b64_tr_b16 v[30:31], v19 offset:4608
    s_waitcnt lgkmcnt(4)
    v_mfma_f32_16x16x32_bf16 v[48:51], v[40:43], a[56:59], v[48:51]
    ds_read_b64_tr_b16 v[32:33], v16 offset:8192
    buffer_load_dwordx4 v2, s[8:11], s35 offen lds
    v_mfma_f32_16x16x32_bf16 v[52:55], v[40:43], a[60:63], v[52:55]
    ds_read_b64_tr_b16 v[34:35], v16 offset:8704
    v_mfma_f32_16x16x32_bf16 v[56:59], v[44:47], a[56:59], v[56:59]
    ds_read_b64_tr_b16 v[36:37], v17 offset:8192
    v_mfma_f32_16x16x32_bf16 v[60:63], v[44:47], a[60:63], v[60:63]
    ds_read_b64_tr_b16 v[38:39], v17 offset:8704
    s_waitcnt lgkmcnt(4)
    v_mfma_f32_16x16x32_bf16 v[64:67], v[24:27], a[56:59], v[64:67]
    ds_read_b64_tr_b16 v[40:41], v18 offset:8192
    buffer_load_dwordx4 v3, s[8:11], s35 offen offset:1024 lds
    v_mfma_f32_16x16x32_bf16 v[68:71], v[24:27], a[60:63], v[68:71]
    ds_read_b64_tr_b16 v[42:43], v18 offset:8704
    s_add_u32 m0, s72, 8192
    v_mfma_f32_16x16x32_bf16 v[72:75], v[28:31], a[56:59], v[72:75]
    ds_read_b64_tr_b16 v[44:45], v19 offset:8192
    s_add_u32 s35, s78, 3539328
    v_mfma_f32_16x16x32_bf16 v[76:79], v[28:31], a[60:63], v[76:79]
    ds_read_b64_tr_b16 v[46:47], v19 offset:8704
    s_waitcnt lgkmcnt(4)
    v_mfma_f32_16x16x32_bf16 v[48:51], v[32:35], a[64:67], v[48:51]
    ds_read_b64_tr_b16 v[24:25], v16 offset:12288
    buffer_load_dwordx4 v2, s[8:11], s35 offen lds
    v_mfma_f32_16x16x32_bf16 v[52:55], v[32:35], a[68:71], v[52:55]
    ds_read_b64_tr_b16 v[26:27], v16 offset:12800
    v_mfma_f32_16x16x32_bf16 v[56:59], v[36:39], a[64:67], v[56:59]
    ds_read_b64_tr_b16 v[28:29], v17 offset:12288
    v_mfma_f32_16x16x32_bf16 v[60:63], v[36:39], a[68:71], v[60:63]
    ds_read_b64_tr_b16 v[30:31], v17 offset:12800
    s_waitcnt lgkmcnt(4)
    v_mfma_f32_16x16x32_bf16 v[64:67], v[40:43], a[64:67], v[64:67]
    ds_read_b64_tr_b16 v[32:33], v18 offset:12288
    buffer_load_dwordx4 v3, s[8:11], s35 offen offset:1024 lds
    v_mfma_f32_16x16x32_bf16 v[68:71], v[40:43], a[68:71], v[68:71]
    ds_read_b64_tr_b16 v[34:35], v18 offset:12800
    s_add_u32 m0, s72, 16384
    v_mfma_f32_16x16x32_bf16 v[72:75], v[44:47], a[64:67], v[72:75]
    ds_read_b64_tr_b16 v[36:37], v19 offset:12288
    s_add_u32 s35, s81, 3539328
    v_mfma_f32_16x16x32_bf16 v[76:79], v[44:47], a[68:71], v[76:79]
    ds_read_b64_tr_b16 v[38:39], v19 offset:12800
    s_waitcnt lgkmcnt(4)
    v_mfma_f32_16x16x32_bf16 v[48:51], v[24:27], a[72:75], v[48:51]
    ds_read_b64_tr_b16 v[40:41], v16 offset:16384
    buffer_load_dwordx4 v2, s[8:11], s35 offen lds
    v_mfma_f32_16x16x32_bf16 v[52:55], v[24:27], a[76:79], v[52:55]
    ds_read_b64_tr_b16 v[42:43], v16 offset:16896
    v_mfma_f32_16x16x32_bf16 v[56:59], v[28:31], a[72:75], v[56:59]
    ds_read_b64_tr_b16 v[44:45], v17 offset:16384
    v_mfma_f32_16x16x32_bf16 v[60:63], v[28:31], a[76:79], v[60:63]
    ds_read_b64_tr_b16 v[46:47], v17 offset:16896
    s_waitcnt lgkmcnt(4)
    v_mfma_f32_16x16x32_bf16 v[64:67], v[32:35], a[72:75], v[64:67]
    ds_read_b64_tr_b16 v[24:25], v18 offset:16384
    buffer_load_dwordx4 v3, s[8:11], s35 offen offset:1024 lds
    v_mfma_f32_16x16x32_bf16 v[68:71], v[32:35], a[76:79], v[68:71]
    ds_read_b64_tr_b16 v[26:27], v18 offset:16896
    v_mfma_f32_16x16x32_bf16 v[72:75], v[36:39], a[72:75], v[72:75]
    ds_read_b64_tr_b16 v[28:29], v19 offset:16384
    v_mfma_f32_16x16x32_bf16 v[76:79], v[36:39], a[76:79], v[76:79]
    ds_read_b64_tr_b16 v[30:31], v19 offset:16896
    s_waitcnt lgkmcnt(4)
    v_mfma_f32_16x16x32_bf16 v[48:51], v[40:43], a[80:83], v[48:51]
    ds_read_b64_tr_b16 v[32:33], v16 offset:20480
    v_mfma_f32_16x16x32_bf16 v[52:55], v[40:43], a[84:87], v[52:55]
    ds_read_b64_tr_b16 v[34:35], v16 offset:20992
    v_mfma_f32_16x16x32_bf16 v[56:59], v[44:47], a[80:83], v[56:59]
    ds_read_b64_tr_b16 v[36:37], v17 offset:20480
    v_mfma_f32_16x16x32_bf16 v[60:63], v[44:47], a[84:87], v[60:63]
    ds_read_b64_tr_b16 v[38:39], v17 offset:20992
    s_waitcnt lgkmcnt(4)
    v_mfma_f32_16x16x32_bf16 v[64:67], v[24:27], a[80:83], v[64:67]
    ds_read_b64_tr_b16 v[40:41], v18 offset:20480
    v_mfma_f32_16x16x32_bf16 v[68:71], v[24:27], a[84:87], v[68:71]
    ds_read_b64_tr_b16 v[42:43], v18 offset:20992
    v_mfma_f32_16x16x32_bf16 v[72:75], v[28:31], a[80:83], v[72:75]
    ds_read_b64_tr_b16 v[44:45], v19 offset:20480
    v_mfma_f32_16x16x32_bf16 v[76:79], v[28:31], a[84:87], v[76:79]
    ds_read_b64_tr_b16 v[46:47], v19 offset:20992
    s_waitcnt vmcnt(26)
    s_waitcnt vmcnt(6)
    v_mov_b32 v20, v244
    s_mov_b32 vcc_lo, -1
    s_mov_b32 vcc_hi, 0
    v_permlane16_swap_b32 v244, v20
    v_cndmask_b32 v247, 0, v244, vcc
    v_cndmask_b32 v246, 0, v244, vcc
    v_cndmask_b32 v245, 0, v244, vcc
    v_cndmask_b32 v244, 0, v244, vcc
    v_cndmask_b32 v23, 0, v20, vcc
    v_cndmask_b32 v22, 0, v20, vcc
    v_cndmask_b32 v21, 0, v20, vcc
    v_cndmask_b32 v20, 0, v20, vcc
    s_barrier
    s_waitcnt lgkmcnt(4)
    v_mfma_f32_16x16x32_bf16 v[48:51], v[32:35], a[88:91], v[48:51]
    ds_read_b64_tr_b16 v[24:25], v16 offset:49152
    s_add_u32 m0, s72, 24576
    s_add_u32 s35, s76, 384
    v_mfma_f32_16x16x32_bf16 v[52:55], v[32:35], a[92:95], v[52:55]
    ds_read_b64_tr_b16 v[26:27], v16 offset:49664
    buffer_load_dwordx4 v2, s[8:11], s35 offen lds
    v_mfma_f32_16x16x32_bf16 v[56:59], v[36:39], a[88:91], v[56:59]
    ds_read_b64_tr_b16 v[28:29], v17 offset:49152
    v_mfma_f32_16x16x32_bf16 v[60:63], v[36:39], a[92:95], v[60:63]
    ds_read_b64_tr_b16 v[30:31], v17 offset:49664
    s_waitcnt lgkmcnt(4)
    v_mfma_f32_16x16x32_bf16 v[64:67], v[40:43], a[88:91], v[64:67]
    ds_read_b64_tr_b16 v[32:33], v18 offset:49152
    buffer_load_dwordx4 v3, s[8:11], s35 offen offset:1024 lds
    v_mfma_f32_16x16x32_bf16 v[68:71], v[40:43], a[92:95], v[68:71]
    ds_read_b64_tr_b16 v[34:35], v18 offset:49664
    s_add_u32 m0, s72, 32768
    v_mfma_f32_16x16x32_bf16 v[72:75], v[44:47], a[88:91], v[72:75]
    ds_read_b64_tr_b16 v[36:37], v19 offset:49152
    s_add_u32 s35, s79, 384
    v_mfma_f32_16x16x32_bf16 v[76:79], v[44:47], a[92:95], v[76:79]
    ds_read_b64_tr_b16 v[38:39], v19 offset:49664
    s_waitcnt lgkmcnt(4)
    v_mfma_f32_16x16x32_bf16 v[208:211], v[24:27], v[244:247], v[208:211]
    ds_read_b64_tr_b16 v[40:41], v16 offset:51200
    buffer_load_dwordx4 v2, s[8:11], s35 offen lds
    v_mfma_f32_16x16x32_bf16 v[212:215], v[24:27], v[20:23], v[212:215]
    ds_read_b64_tr_b16 v[42:43], v16 offset:51712
    v_mfma_f32_16x16x32_bf16 v[216:219], v[28:31], v[244:247], v[216:219]
    ds_read_b64_tr_b16 v[44:45], v17 offset:51200
    v_mfma_f32_16x16x32_bf16 v[220:223], v[28:31], v[20:23], v[220:223]
    ds_read_b64_tr_b16 v[46:47], v17 offset:51712
    s_waitcnt lgkmcnt(4)
    v_mfma_f32_16x16x32_bf16 v[224:227], v[32:35], v[244:247], v[224:227]
    ds_read_b64_tr_b16 v[24:25], v18 offset:51200
    buffer_load_dwordx4 v3, s[8:11], s35 offen offset:1024 lds
    v_mfma_f32_16x16x32_bf16 v[228:231], v[32:35], v[20:23], v[228:231]
    ds_read_b64_tr_b16 v[26:27], v18 offset:51712
    s_add_u32 m0, s72, 40960
    v_mfma_f32_16x16x32_bf16 v[232:235], v[36:39], v[244:247], v[232:235]
    ds_read_b64_tr_b16 v[28:29], v19 offset:51200
    s_add_u32 s35, s82, 384
    v_mfma_f32_16x16x32_bf16 v[236:239], v[36:39], v[20:23], v[236:239]
    ds_read_b64_tr_b16 v[30:31], v19 offset:51712
    s_waitcnt lgkmcnt(4)
    v_mfma_f32_16x16x32_bf16 v[176:179], v[40:43], v[244:247], v[176:179]
    ds_read_b64_tr_b16 v[32:33], v16 offset:53248
    buffer_load_dwordx4 v2, s[8:11], s35 offen lds
    v_mfma_f32_16x16x32_bf16 v[180:183], v[40:43], v[20:23], v[180:183]
    ds_read_b64_tr_b16 v[34:35], v16 offset:53760
    v_mfma_f32_16x16x32_bf16 v[184:187], v[44:47], v[244:247], v[184:187]
    ds_read_b64_tr_b16 v[36:37], v17 offset:53248
    v_mfma_f32_16x16x32_bf16 v[188:191], v[44:47], v[20:23], v[188:191]
    ds_read_b64_tr_b16 v[38:39], v17 offset:53760
    s_waitcnt lgkmcnt(4)
    v_mfma_f32_16x16x32_bf16 v[192:195], v[24:27], v[244:247], v[192:195]
    ds_read_b64_tr_b16 v[40:41], v18 offset:53248
    buffer_load_dwordx4 v3, s[8:11], s35 offen offset:1024 lds
    v_mfma_f32_16x16x32_bf16 v[196:199], v[24:27], v[20:23], v[196:199]
    ds_read_b64_tr_b16 v[42:43], v18 offset:53760
    v_cvt_pk_bf16_f32 v239, v238, v239
    v_mfma_f32_16x16x32_bf16 v[200:203], v[28:31], v[244:247], v[200:203]
    ds_read_b64_tr_b16 v[44:45], v19 offset:53248
    v_cvt_pk_bf16_f32 v238, v236, v237
    v_mfma_f32_16x16x32_bf16 v[204:207], v[28:31], v[20:23], v[204:207]
    ds_read_b64_tr_b16 v[46:47], v19 offset:53760
    s_waitcnt lgkmcnt(4)
    v_mfma_f32_16x16x32_bf16 v[144:147], v[32:35], v[244:247], v[144:147]
    ds_read_b64_tr_b16 v[24:25], v16 offset:55296
    v_cvt_pk_bf16_f32 v237, v234, v235
    v_mfma_f32_16x16x32_bf16 v[148:151], v[32:35], v[20:23], v[148:151]
    ds_read_b64_tr_b16 v[26:27], v16 offset:55808
    v_cvt_pk_bf16_f32 v236, v232, v233
    v_mfma_f32_16x16x32_bf16 v[152:155], v[36:39], v[244:247], v[152:155]
    ds_read_b64_tr_b16 v[28:29], v17 offset:55296
    v_pk_max_i16 v236, v236, 0
    v_mfma_f32_16x16x32_bf16 v[156:159], v[36:39], v[20:23], v[156:159]
    ds_read_b64_tr_b16 v[30:31], v17 offset:55808
    s_waitcnt lgkmcnt(4)
    v_mfma_f32_16x16x32_bf16 v[160:163], v[40:43], v[244:247], v[160:163]
    ds_read_b64_tr_b16 v[32:33], v18 offset:55296
    v_pk_max_i16 v237, v237, 0
    v_mfma_f32_16x16x32_bf16 v[164:167], v[40:43], v[20:23], v[164:167]
    ds_read_b64_tr_b16 v[34:35], v18 offset:55808
    v_pk_max_i16 v238, v238, 0
    v_mfma_f32_16x16x32_bf16 v[168:171], v[44:47], v[244:247], v[168:171]
    ds_read_b64_tr_b16 v[36:37], v19 offset:55296
    v_pk_max_i16 v239, v239, 0
    v_mfma_f32_16x16x32_bf16 v[172:175], v[44:47], v[20:23], v[172:175]
    ds_read_b64_tr_b16 v[38:39], v19 offset:55808
    s_waitcnt lgkmcnt(4)
    v_mfma_f32_16x16x32_bf16 v[48:51], v[24:27], v[244:247], v[48:51]
    ds_read_b64_tr_b16 v[40:41], v12 offset:0
    v_permlane16_swap_b32 v236, v238
    v_mfma_f32_16x16x32_bf16 v[52:55], v[24:27], v[20:23], v[52:55]
    ds_read_b64_tr_b16 v[42:43], v12 offset:512
    v_permlane16_swap_b32 v237, v239
    v_mfma_f32_16x16x32_bf16 v[56:59], v[28:31], v[244:247], v[56:59]
    ds_read_b64_tr_b16 v[44:45], v13 offset:0
    v_cvt_pk_bf16_f32 v235, v230, v231
    v_mfma_f32_16x16x32_bf16 v[60:63], v[28:31], v[20:23], v[60:63]
    ds_read_b64_tr_b16 v[46:47], v13 offset:512
    s_waitcnt lgkmcnt(4)
    v_mfma_f32_16x16x32_bf16 v[64:67], v[32:35], v[244:247], v[64:67]
    ds_read_b64_tr_b16 v[24:25], v14 offset:0
    s_add_u32 s34, s91, 0
    buffer_store_dwordx4 v[236:239], v1, s[16:19], s34 offen offset:3072 sc1
    v_mfma_f32_16x16x32_bf16 v[68:71], v[32:35], v[20:23], v[68:71]
    ds_read_b64_tr_b16 v[26:27], v14 offset:512
    v_cvt_pk_bf16_f32 v234, v228, v229
    v_mfma_f32_16x16x32_bf16 v[72:75], v[36:39], v[244:247], v[72:75]
    ds_read_b64_tr_b16 v[28:29], v15 offset:0
    v_cvt_pk_bf16_f32 v233, v226, v227
    v_mfma_f32_16x16x32_bf16 v[76:79], v[36:39], v[20:23], v[76:79]
    ds_read_b64_tr_b16 v[30:31], v15 offset:512
    s_waitcnt lgkmcnt(4)
    v_mfma_f32_16x16x32_bf16 v[48:51], v[40:43], a[96:99], v[48:51]
    ds_read_b64_tr_b16 v[32:33], v12 offset:4096
    v_cvt_pk_bf16_f32 v232, v224, v225
    v_mfma_f32_16x16x32_bf16 v[52:55], v[40:43], a[100:103], v[52:55]
    ds_read_b64_tr_b16 v[34:35], v12 offset:4608
    v_pk_max_i16 v232, v232, 0
    v_mfma_f32_16x16x32_bf16 v[56:59], v[44:47], a[96:99], v[56:59]
    ds_read_b64_tr_b16 v[36:37], v13 offset:4096
    v_pk_max_i16 v233, v233, 0
    v_mfma_f32_16x16x32_bf16 v[60:63], v[44:47], a[100:103], v[60:63]
    ds_read_b64_tr_b16 v[38:39], v13 offset:4608
    s_waitcnt lgkmcnt(4)
    v_mfma_f32_16x16x32_bf16 v[64:67], v[24:27], a[96:99], v[64:67]
    ds_read_b64_tr_b16 v[40:41], v14 offset:4096
    v_pk_max_i16 v234, v234, 0
    v_mfma_f32_16x16x32_bf16 v[68:71], v[24:27], a[100:103], v[68:71]
    ds_read_b64_tr_b16 v[42:43], v14 offset:4608
    v_pk_max_i16 v235, v235, 0
    v_mfma_f32_16x16x32_bf16 v[72:75], v[28:31], a[96:99], v[72:75]
    ds_read_b64_tr_b16 v[44:45], v15 offset:4096
    v_permlane16_swap_b32 v232, v234
    v_mfma_f32_16x16x32_bf16 v[76:79], v[28:31], a[100:103], v[76:79]
    ds_read_b64_tr_b16 v[46:47], v15 offset:4608
    s_waitcnt lgkmcnt(4)
    v_mfma_f32_16x16x32_bf16 v[48:51], v[32:35], a[104:107], v[48:51]
    ds_read_b64_tr_b16 v[24:25], v12 offset:8192
    v_permlane16_swap_b32 v233, v235
    v_mfma_f32_16x16x32_bf16 v[52:55], v[32:35], a[108:111], v[52:55]
    ds_read_b64_tr_b16 v[26:27], v12 offset:8704
    v_cvt_pk_bf16_f32 v231, v222, v223
    v_mfma_f32_16x16x32_bf16 v[56:59], v[36:39], a[104:107], v[56:59]
    ds_read_b64_tr_b16 v[28:29], v13 offset:8192
    v_cvt_pk_bf16_f32 v230, v220, v221
    v_mfma_f32_16x16x32_bf16 v[60:63], v[36:39], a[108:111], v[60:63]
    ds_read_b64_tr_b16 v[30:31], v13 offset:8704
    s_waitcnt lgkmcnt(4)
    v_mfma_f32_16x16x32_bf16 v[64:67], v[40:43], a[104:107], v[64:67]
    ds_read_b64_tr_b16 v[32:33], v14 offset:8192
    buffer_store_dwordx4 v[232:235], v1, s[16:19], s34 offen offset:2048 sc1
    v_mfma_f32_16x16x32_bf16 v[68:71], v[40:43], a[108:111], v[68:71]
    ds_read_b64_tr_b16 v[34:35], v14 offset:8704
    v_cvt_pk_bf16_f32 v229, v218, v219
    v_mfma_f32_16x16x32_bf16 v[72:75], v[44:47], a[104:107], v[72:75]
    ds_read_b64_tr_b16 v[36:37], v15 offset:8192
    v_cvt_pk_bf16_f32 v228, v216, v217
    v_mfma_f32_16x16x32_bf16 v[76:79], v[44:47], a[108:111], v[76:79]
    ds_read_b64_tr_b16 v[38:39], v15 offset:8704
    s_waitcnt lgkmcnt(4)
    v_mfma_f32_16x16x32_bf16 v[48:51], v[24:27], a[112:115], v[48:51]
    ds_read_b64_tr_b16 v[40:41], v12 offset:12288
    v_pk_max_i16 v228, v228, 0
    v_mfma_f32_16x16x32_bf16 v[52:55], v[24:27], a[116:119], v[52:55]
    ds_read_b64_tr_b16 v[42:43], v12 offset:12800
    v_pk_max_i16 v229, v229, 0
    v_mfma_f32_16x16x32_bf16 v[56:59], v[28:31], a[112:115], v[56:59]
    ds_read_b64_tr_b16 v[44:45], v13 offset:12288
    v_pk_max_i16 v230, v230, 0
    v_mfma_f32_16x16x32_bf16 v[60:63], v[28:31], a[116:119], v[60:63]
    ds_read_b64_tr_b16 v[46:47], v13 offset:12800
    s_waitcnt lgkmcnt(4)
    v_mfma_f32_16x16x32_bf16 v[64:67], v[32:35], a[112:115], v[64:67]
    ds_read_b64_tr_b16 v[24:25], v14 offset:12288
    v_pk_max_i16 v231, v231, 0
    v_mfma_f32_16x16x32_bf16 v[68:71], v[32:35], a[116:119], v[68:71]
    ds_read_b64_tr_b16 v[26:27], v14 offset:12800
    v_permlane16_swap_b32 v228, v230
    v_mfma_f32_16x16x32_bf16 v[72:75], v[36:39], a[112:115], v[72:75]
    ds_read_b64_tr_b16 v[28:29], v15 offset:12288
    v_permlane16_swap_b32 v229, v231
    v_mfma_f32_16x16x32_bf16 v[76:79], v[36:39], a[116:119], v[76:79]
    ds_read_b64_tr_b16 v[30:31], v15 offset:12800
    s_waitcnt lgkmcnt(4)
    v_mfma_f32_16x16x32_bf16 v[48:51], v[40:43], a[120:123], v[48:51]
    ds_read_b64_tr_b16 v[32:33], v12 offset:16384
    v_cvt_pk_bf16_f32 v227, v214, v215
    v_mfma_f32_16x16x32_bf16 v[52:55], v[40:43], a[124:127], v[52:55]
    ds_read_b64_tr_b16 v[34:35], v12 offset:16896
    v_cvt_pk_bf16_f32 v226, v212, v213
    v_mfma_f32_16x16x32_bf16 v[56:59], v[44:47], a[120:123], v[56:59]
    ds_read_b64_tr_b16 v[36:37], v13 offset:16384
    v_cvt_pk_bf16_f32 v225, v210, v211
    v_mfma_f32_16x16x32_bf16 v[60:63], v[44:47], a[124:127], v[60:63]
    ds_read_b64_tr_b16 v[38:39], v13 offset:16896
    s_waitcnt lgkmcnt(4)
    v_mfma_f32_16x16x32_bf16 v[64:67], v[24:27], a[120:123], v[64:67]
    ds_read_b64_tr_b16 v[40:41], v14 offset:16384
    buffer_store_dwordx4 v[228:231], v1, s[16:19], s34 offen offset:1024 sc1
    v_mfma_f32_16x16x32_bf16 v[68:71], v[24:27], a[124:127], v[68:71]
    ds_read_b64_tr_b16 v[42:43], v14 offset:16896
    v_cvt_pk_bf16_f32 v224, v208, v209
    v_mfma_f32_16x16x32_bf16 v[72:75], v[28:31], a[120:123], v[72:75]
    ds_read_b64_tr_b16 v[44:45], v15 offset:16384
    v_pk_max_i16 v224, v224, 0
    v_mfma_f32_16x16x32_bf16 v[76:79], v[28:31], a[124:127], v[76:79]
    ds_read_b64_tr_b16 v[46:47], v15 offset:16896
    s_waitcnt lgkmcnt(4)
    v_mfma_f32_16x16x32_bf16 v[48:51], v[32:35], a[128:131], v[48:51]
    ds_read_b64_tr_b16 v[24:25], v12 offset:20480
    v_pk_max_i16 v225, v225, 0
    v_mfma_f32_16x16x32_bf16 v[52:55], v[32:35], a[132:135], v[52:55]
    ds_read_b64_tr_b16 v[26:27], v12 offset:20992
    v_pk_max_i16 v226, v226, 0
    v_mfma_f32_16x16x32_bf16 v[56:59], v[36:39], a[128:131], v[56:59]
    ds_read_b64_tr_b16 v[28:29], v13 offset:20480
    v_pk_max_i16 v227, v227, 0
    v_mfma_f32_16x16x32_bf16 v[60:63], v[36:39], a[132:135], v[60:63]
    ds_read_b64_tr_b16 v[30:31], v13 offset:20992
    s_waitcnt lgkmcnt(4)
    v_mfma_f32_16x16x32_bf16 v[64:67], v[40:43], a[128:131], v[64:67]
    ds_read_b64_tr_b16 v[32:33], v14 offset:20480
    v_permlane16_swap_b32 v224, v226
    v_mfma_f32_16x16x32_bf16 v[68:71], v[40:43], a[132:135], v[68:71]
    ds_read_b64_tr_b16 v[34:35], v14 offset:20992
    v_permlane16_swap_b32 v225, v227
    v_mfma_f32_16x16x32_bf16 v[72:75], v[44:47], a[128:131], v[72:75]
    ds_read_b64_tr_b16 v[36:37], v15 offset:20480
    v_cvt_pk_bf16_f32 v208, v176, v177
    v_mfma_f32_16x16x32_bf16 v[76:79], v[44:47], a[132:135], v[76:79]
    ds_read_b64_tr_b16 v[38:39], v15 offset:20992
    s_barrier
    s_waitcnt lgkmcnt(4)
    v_mfma_f32_16x16x32_bf16 v[48:51], v[24:27], a[136:139], v[48:51]
    ds_read_b64_tr_b16 v[40:41], v16 offset:24576
    s_add_u32 m0, s72, 98304
    s_add_u32 s35, s76, 1769856
    v_mfma_f32_16x16x32_bf16 v[52:55], v[24:27], a[140:143], v[52:55]
    ds_read_b64_tr_b16 v[42:43], v16 offset:25088
    buffer_load_dwordx4 v2, s[8:11], s35 offen lds
    v_mfma_f32_16x16x32_bf16 v[56:59], v[28:31], a[136:139], v[56:59]
    ds_read_b64_tr_b16 v[44:45], v17 offset:24576
    v_cvt_pk_bf16_f32 v209, v178, v179
    v_mfma_f32_16x16x32_bf16 v[60:63], v[28:31], a[140:143], v[60:63]
    ds_read_b64_tr_b16 v[46:47], v17 offset:25088
    s_waitcnt lgkmcnt(4)
    v_mfma_f32_16x16x32_bf16 v[64:67], v[32:35], a[136:139], v[64:67]
    ds_read_b64_tr_b16 v[24:25], v18 offset:24576
    buffer_store_dwordx4 v[224:227], v1, s[16:19], s34 offen offset:0 sc1
    v_mfma_f32_16x16x32_bf16 v[68:71], v[32:35], a[140:143], v[68:71]
    ds_read_b64_tr_b16 v[26:27], v18 offset:25088
    v_cvt_pk_bf16_f32 v210, v180, v181
    v_mfma_f32_16x16x32_bf16 v[72:75], v[36:39], a[136:139], v[72:75]
    ds_read_b64_tr_b16 v[28:29], v19 offset:24576
    v_cvt_pk_bf16_f32 v211, v182, v183
    v_mfma_f32_16x16x32_bf16 v[76:79], v[36:39], a[140:143], v[76:79]
    ds_read_b64_tr_b16 v[30:31], v19 offset:25088
    s_waitcnt lgkmcnt(4)
    v_mfma_f32_16x16x32_bf16 v[80:83], v[40:43], a[0:3], 0
    ds_read_b64_tr_b16 v[32:33], v16 offset:28672
    buffer_load_dwordx4 v3, s[8:11], s35 offen offset:1024 lds
    v_mfma_f32_16x16x32_bf16 v[84:87], v[40:43], a[4:7], 0
    ds_read_b64_tr_b16 v[34:35], v16 offset:29184
    s_add_u32 m0, s72, 106496
    v_mfma_f32_16x16x32_bf16 v[88:91], v[44:47], a[0:3], 0
    ds_read_b64_tr_b16 v[36:37], v17 offset:28672
    s_add_u32 s35, s79, 1769856
    v_mfma_f32_16x16x32_bf16 v[92:95], v[44:47], a[4:7], 0
    ds_read_b64_tr_b16 v[38:39], v17 offset:29184
    s_waitcnt lgkmcnt(4)
    v_mfma_f32_16x16x32_bf16 v[96:99], v[24:27], a[0:3], 0
    ds_read_b64_tr_b16 v[40:41], v18 offset:28672
    buffer_load_dwordx4 v2, s[8:11], s35 offen lds
    v_mfma_f32_16x16x32_bf16 v[100:103], v[24:27], a[4:7], 0
    ds_read_b64_tr_b16 v[42:43], v18 offset:29184
    v_pk_max_i16 v208, v208, 0
    v_mfma_f32_16x16x32_bf16 v[104:107], v[28:31], a[0:3], 0
    ds_read_b64_tr_b16 v[44:45], v19 offset:28672
    v_pk_max_i16 v209, v209, 0
    v_mfma_f32_16x16x32_bf16 v[108:111], v[28:31], a[4:7], 0
    ds_read_b64_tr_b16 v[46:47], v19 offset:29184
    s_waitcnt lgkmcnt(4)
    v_mfma_f32_16x16x32_bf16 v[80:83], v[32:35], a[8:11], v[80:83]
    ds_read_b64_tr_b16 v[24:25], v16 offset:32768
    buffer_load_dwordx4 v3, s[8:11], s35 offen offset:1024 lds
    v_mfma_f32_16x16x32_bf16 v[84:87], v[32:35], a[12:15], v[84:87]
    ds_read_b64_tr_b16 v[26:27], v16 offset:33280
    s_add_u32 m0, s72, 114688
    v_mfma_f32_16x16x32_bf16 v[88:91], v[36:39], a[8:11], v[88:91]
    ds_read_b64_tr_b16 v[28:29], v17 offset:32768
    s_add_u32 s35, s82, 1769856
    v_mfma_f32_16x16x32_bf16 v[92:95], v[36:39], a[12:15], v[92:95]
    ds_read_b64_tr_b16 v[30:31], v17 offset:33280
    s_waitcnt lgkmcnt(4)
    v_mfma_f32_16x16x32_bf16 v[96:99], v[40:43], a[8:11], v[96:99]
    ds_read_b64_tr_b16 v[32:33], v18 offset:32768
    buffer_load_dwordx4 v2, s[8:11], s35 offen lds
    v_mfma_f32_16x16x32_bf16 v[100:103], v[40:43], a[12:15], v[100:103]
    ds_read_b64_tr_b16 v[34:35], v18 offset:33280
    v_pk_max_i16 v210, v210, 0
    v_mfma_f32_16x16x32_bf16 v[104:107], v[44:47], a[8:11], v[104:107]
    ds_read_b64_tr_b16 v[36:37], v19 offset:32768
    v_pk_max_i16 v211, v211, 0
    v_mfma_f32_16x16x32_bf16 v[108:111], v[44:47], a[12:15], v[108:111]
    ds_read_b64_tr_b16 v[38:39], v19 offset:33280
    s_waitcnt lgkmcnt(4)
    v_mfma_f32_16x16x32_bf16 v[80:83], v[24:27], a[16:19], v[80:83]
    ds_read_b64_tr_b16 v[40:41], v16 offset:36864
    buffer_load_dwordx4 v3, s[8:11], s35 offen offset:1024 lds
    v_mfma_f32_16x16x32_bf16 v[84:87], v[24:27], a[20:23], v[84:87]
    ds_read_b64_tr_b16 v[42:43], v16 offset:37376
    v_permlane16_swap_b32 v208, v210
    v_mfma_f32_16x16x32_bf16 v[88:91], v[28:31], a[16:19], v[88:91]
    ds_read_b64_tr_b16 v[44:45], v17 offset:36864
    v_permlane16_swap_b32 v209, v211
    v_mfma_f32_16x16x32_bf16 v[92:95], v[28:31], a[20:23], v[92:95]
    ds_read_b64_tr_b16 v[46:47], v17 offset:37376
    s_waitcnt lgkmcnt(4)
    v_mfma_f32_16x16x32_bf16 v[96:99], v[32:35], a[16:19], v[96:99]
    ds_read_b64_tr_b16 v[24:25], v18 offset:36864
    v_cvt_pk_bf16_f32 v212, v184, v185
    v_mfma_f32_16x16x32_bf16 v[100:103], v[32:35], a[20:23], v[100:103]
    ds_read_b64_tr_b16 v[26:27], v18 offset:37376
    v_cvt_pk_bf16_f32 v213, v186, v187
    v_mfma_f32_16x16x32_bf16 v[104:107], v[36:39], a[16:19], v[104:107]
    ds_read_b64_tr_b16 v[28:29], v19 offset:36864
    s_add_u32 s34, s91, 4096
    buffer_store_dwordx4 v[208:211], v1, s[16:19], s34 offen offset:0 sc1
    v_mfma_f32_16x16x32_bf16 v[108:111], v[36:39], a[20:23], v[108:111]
    ds_read_b64_tr_b16 v[30:31], v19 offset:37376
    s_waitcnt lgkmcnt(4)
    v_mfma_f32_16x16x32_bf16 v[80:83], v[40:43], a[24:27], v[80:83]
    ds_read_b64_tr_b16 v[32:33], v16 offset:40960
    v_cvt_pk_bf16_f32 v214, v188, v189
    v_mfma_f32_16x16x32_bf16 v[84:87], v[40:43], a[28:31], v[84:87]
    ds_read_b64_tr_b16 v[34:35], v16 offset:41472
    v_cvt_pk_bf16_f32 v215, v190, v191
    v_mfma_f32_16x16x32_bf16 v[88:91], v[44:47], a[24:27], v[88:91]
    ds_read_b64_tr_b16 v[36:37], v17 offset:40960
    v_pk_max_i16 v212, v212, 0
    v_mfma_f32_16x16x32_bf16 v[92:95], v[44:47], a[28:31], v[92:95]
    ds_read_b64_tr_b16 v[38:39], v17 offset:41472
    s_waitcnt lgkmcnt(4)
    v_mfma_f32_16x16x32_bf16 v[96:99], v[24:27], a[24:27], v[96:99]
    ds_read_b64_tr_b16 v[40:41], v18 offset:40960
    v_pk_max_i16 v213, v213, 0
    v_mfma_f32_16x16x32_bf16 v[100:103], v[24:27], a[28:31], v[100:103]
    ds_read_b64_tr_b16 v[42:43], v18 offset:41472
    v_pk_max_i16 v214, v214, 0
    v_mfma_f32_16x16x32_bf16 v[104:107], v[28:31], a[24:27], v[104:107]
    ds_read_b64_tr_b16 v[44:45], v19 offset:40960
    v_pk_max_i16 v215, v215, 0
    v_mfma_f32_16x16x32_bf16 v[108:111], v[28:31], a[28:31], v[108:111]
    ds_read_b64_tr_b16 v[46:47], v19 offset:41472
    s_waitcnt lgkmcnt(4)
    v_mfma_f32_16x16x32_bf16 v[80:83], v[32:35], a[32:35], v[80:83]
    ds_read_b64_tr_b16 v[24:25], v16 offset:45056
    v_permlane16_swap_b32 v212, v214
    v_mfma_f32_16x16x32_bf16 v[84:87], v[32:35], a[36:39], v[84:87]
    ds_read_b64_tr_b16 v[26:27], v16 offset:45568
    v_permlane16_swap_b32 v213, v215
    v_mfma_f32_16x16x32_bf16 v[88:91], v[36:39], a[32:35], v[88:91]
    ds_read_b64_tr_b16 v[28:29], v17 offset:45056
    v_cvt_pk_bf16_f32 v216, v192, v193
    v_mfma_f32_16x16x32_bf16 v[92:95], v[36:39], a[36:39], v[92:95]
    ds_read_b64_tr_b16 v[30:31], v17 offset:45568
    s_waitcnt lgkmcnt(4)
    v_mfma_f32_16x16x32_bf16 v[96:99], v[40:43], a[32:35], v[96:99]
    ds_read_b64_tr_b16 v[32:33], v18 offset:45056
    v_cvt_pk_bf16_f32 v217, v194, v195
    v_mfma_f32_16x16x32_bf16 v[100:103], v[40:43], a[36:39], v[100:103]
    ds_read_b64_tr_b16 v[34:35], v18 offset:45568
    v_cvt_pk_bf16_f32 v218, v196, v197
    v_mfma_f32_16x16x32_bf16 v[104:107], v[44:47], a[32:35], v[104:107]
    ds_read_b64_tr_b16 v[36:37], v19 offset:45056
L_pg3:
    s_cbranch_execz L_pg7
    buffer_store_dwordx4 v[212:215], v1, s[16:19], s34 offen offset:1024 sc1
    v_mfma_f32_16x16x32_bf16 v[108:111], v[44:47], a[36:39], v[108:111]
    ds_read_b64_tr_b16 v[38:39], v19 offset:45568
    s_barrier
    s_waitcnt lgkmcnt(4)
    v_mfma_f32_16x16x32_bf16 v[80:83], v[24:27], a[40:43], v[80:83]
    ds_read_b64_tr_b16 v[40:41], v12 offset:24576
    s_add_u32 m0, s72, 49152
    v_mfma_f32_16x16x32_bf16 v[84:87], v[24:27], a[44:47], v[84:87]
    ds_read_b64_tr_b16 v[42:43], v12 offset:25088
    s_add_u32 s35, s76, 3539328
    v_mfma_f32_16x16x32_bf16 v[88:91], v[28:31], a[40:43], v[88:91]
    ds_read_b64_tr_b16 v[44:45], v13 offset:24576
    buffer_load_dwordx4 v2, s[8:11], s35 offen lds
    v_mfma_f32_16x16x32_bf16 v[92:95], v[28:31], a[44:47], v[92:95]
    ds_read_b64_tr_b16 v[46:47], v13 offset:25088
    s_waitcnt lgkmcnt(4)
    v_mfma_f32_16x16x32_bf16 v[96:99], v[32:35], a[40:43], v[96:99]
    ds_read_b64_tr_b16 v[24:25], v14 offset:24576
    v_cvt_pk_bf16_f32 v219, v198, v199
    v_mfma_f32_16x16x32_bf16 v[100:103], v[32:35], a[44:47], v[100:103]
    ds_read_b64_tr_b16 v[26:27], v14 offset:25088
    v_pk_max_i16 v216, v216, 0
    v_mfma_f32_16x16x32_bf16 v[104:107], v[36:39], a[40:43], v[104:107]
    ds_read_b64_tr_b16 v[28:29], v15 offset:24576
    buffer_load_dwordx4 v3, s[8:11], s35 offen offset:1024 lds
    v_mfma_f32_16x16x32_bf16 v[108:111], v[36:39], a[44:47], v[108:111]
    ds_read_b64_tr_b16 v[30:31], v15 offset:25088
    s_waitcnt lgkmcnt(4)
    v_mfma_f32_16x16x32_bf16 v[80:83], v[40:43], a[48:51], v[80:83]
    ds_read_b64_tr_b16 v[32:33], v12 offset:28672
    s_add_u32 m0, s72, 57344
    v_mfma_f32_16x16x32_bf16 v[84:87], v[40:43], a[52:55], v[84:87]
    ds_read_b64_tr_b16 v[34:35], v12 offset:29184
    s_add_u32 s35, s79, 3539328
    v_mfma_f32_16x16x32_bf16 v[88:91], v[44:47], a[48:51], v[88:91]
    ds_read_b64_tr_b16 v[36:37], v13 offset:28672
    buffer_load_dwordx4 v2, s[8:11], s35 offen lds
    v_mfma_f32_16x16x32_bf16 v[92:95], v[44:47], a[52:55], v[92:95]
    ds_read_b64_tr_b16 v[38:39], v13 offset:29184
    s_waitcnt lgkmcnt(4)
    v_mfma_f32_16x16x32_bf16 v[96:99], v[24:27], a[48:51], v[96:99]
    ds_read_b64_tr_b16 v[40:41], v14 offset:28672
    v_pk_max_i16 v217, v217, 0
    v_mfma_f32_16x16x32_bf16 v[100:103], v[24:27], a[52:55], v[100:103]
    ds_read_b64_tr_b16 v[42:43], v14 offset:29184
    v_pk_max_i16 v218, v218, 0
    v_mfma_f32_16x16x32_bf16 v[104:107], v[28:31], a[48:51], v[104:107]
    ds_read_b64_tr_b16 v[44:45], v15 offset:28672
    buffer_load_dwordx4 v3, s[8:11], s35 offen offset:1024 lds
    v_mfma_f32_16x16x32_bf16 v[108:111], v[28:31], a[52:55], v[108:111]
    ds_read_b64_tr_b16 v[46:47], v15 offset:29184
    s_waitcnt lgkmcnt(4)
    v_mfma_f32_16x16x32_bf16 v[80:83], v[32:35], a[56:59], v[80:83]
    ds_read_b64_tr_b16 v[24:25], v12 offset:32768
    s_add_u32 m0, s72, 65536
    v_mfma_f32_16x16x32_bf16 v[84:87], v[32:35], a[60:63], v[84:87]
    ds_read_b64_tr_b16 v[26:27], v12 offset:33280
    s_add_u32 s35, s82, 3539328
    v_mfma_f32_16x16x32_bf16 v[88:91], v[36:39], a[56:59], v[88:91]
    ds_read_b64_tr_b16 v[28:29], v13 offset:32768
    buffer_load_dwordx4 v2, s[8:11], s35 offen lds
    v_mfma_f32_16x16x32_bf16 v[92:95], v[36:39], a[60:63], v[92:95]
    ds_read_b64_tr_b16 v[30:31], v13 offset:33280
    s_waitcnt lgkmcnt(4)
    v_mfma_f32_16x16x32_bf16 v[96:99], v[40:43], a[56:59], v[96:99]
    ds_read_b64_tr_b16 v[32:33], v14 offset:32768
    v_pk_max_i16 v219, v219, 0
    v_mfma_f32_16x16x32_bf16 v[100:103], v[40:43], a[60:63], v[100:103]
    ds_read_b64_tr_b16 v[34:35], v14 offset:33280
    v_permlane16_swap_b32 v216, v218
    v_mfma_f32_16x16x32_bf16 v[104:107], v[44:47], a[56:59], v[104:107]
    ds_read_b64_tr_b16 v[36:37], v15 offset:32768
    buffer_load_dwordx4 v3, s[8:11], s35 offen offset:1024 lds
    v_mfma_f32_16x16x32_bf16 v[108:111], v[44:47], a[60:63], v[108:111]
    ds_read_b64_tr_b16 v[38:39], v15 offset:33280
    s_waitcnt lgkmcnt(4)
    v_mfma_f32_16x16x32_bf16 v[80:83], v[24:27], a[64:67], v[80:83]
    ds_read_b64_tr_b16 v[40:41], v12 offset:36864
    v_permlane16_swap_b32 v217, v219
    v_mfma_f32_16x16x32_bf16 v[84:87], v[24:27], a[68:71], v[84:87]
    ds_read_b64_tr_b16 v[42:43], v12 offset:37376
    v_cvt_pk_bf16_f32 v220, v200, v201
    v_mfma_f32_16x16x32_bf16 v[88:91], v[28:31], a[64:67], v[88:91]
    ds_read_b64_tr_b16 v[44:45], v13 offset:36864
    v_cvt_pk_bf16_f32 v221, v202, v203
    v_mfma_f32_16x16x32_bf16 v[92:95], v[28:31], a[68:71], v[92:95]
    ds_read_b64_tr_b16 v[46:47], v13 offset:37376
    s_waitcnt lgkmcnt(4)
    v_mfma_f32_16x16x32_bf16 v[96:99], v[32:35], a[64:67], v[96:99]
    ds_read_b64_tr_b16 v[24:25], v14 offset:36864
    buffer_store_dwordx4 v[216:219], v1, s[16:19], s34 offen offset:2048 sc1
    v_mfma_f32_16x16x32_bf16 v[100:103], v[32:35], a[68:71], v[100:103]
    ds_read_b64_tr_b16 v[26:27], v14 offset:37376
    v_cvt_pk_bf16_f32 v222, v204, v205
    v_mfma_f32_16x16x32_bf16 v[104:107], v[36:39], a[64:67], v[104:107]
    ds_read_b64_tr_b16 v[28:29], v15 offset:36864
    v_cvt_pk_bf16_f32 v223, v206, v207
    v_mfma_f32_16x16x32_bf16 v[108:111], v[36:39], a[68:71], v[108:111]
    ds_read_b64_tr_b16 v[30:31], v15 offset:37376
    s_waitcnt lgkmcnt(4)
    v_mfma_f32_16x16x32_bf16 v[80:83], v[40:43], a[72:75], v[80:83]
    ds_read_b64_tr_b16 v[32:33], v12 offset:40960
    v_pk_max_i16 v220, v220, 0
    v_mfma_f32_16x16x32_bf16 v[84:87], v[40:43], a[76:79], v[84:87]
    ds_read_b64_tr_b16 v[34:35], v12 offset:41472
    v_pk_max_i16 v221, v221, 0
    v_mfma_f32_16x16x32_bf16 v[88:91], v[44:47], a[72:75], v[88:91]
    ds_read_b64_tr_b16 v[36:37], v13 offset:40960
    v_pk_max_i16 v222, v222, 0
    v_mfma_f32_16x16x32_bf16 v[92:95], v[44:47], a[76:79], v[92:95]
    ds_read_b64_tr_b16 v[38:39], v13 offset:41472
    s_waitcnt lgkmcnt(4)
    v_mfma_f32_16x16x32_bf16 v[96:99], v[24:27], a[72:75], v[96:99]
    ds_read_b64_tr_b16 v[40:41], v14 offset:40960
    v_pk_max_i16 v223, v223, 0
    v_mfma_f32_16x16x32_bf16 v[100:103], v[24:27], a[76:79], v[100:103]
    ds_read_b64_tr_b16 v[42:43], v14 offset:41472
    v_permlane16_swap_b32 v220, v222
    v_mfma_f32_16x16x32_bf16 v[104:107], v[28:31], a[72:75], v[104:107]
    ds_read_b64_tr_b16 v[44:45], v15 offset:40960
    v_permlane16_swap_b32 v221, v223
    v_mfma_f32_16x16x32_bf16 v[108:111], v[28:31], a[76:79], v[108:111]
    ds_read_b64_tr_b16 v[46:47], v15 offset:41472
    s_waitcnt lgkmcnt(4)
    v_mfma_f32_16x16x32_bf16 v[80:83], v[32:35], a[80:83], v[80:83]
    ds_read_b64_tr_b16 v[24:25], v12 offset:45056
    v_cvt_pk_bf16_f32 v192, v144, v145
    v_mfma_f32_16x16x32_bf16 v[84:87], v[32:35], a[84:87], v[84:87]
    ds_read_b64_tr_b16 v[26:27], v12 offset:45568
    v_cvt_pk_bf16_f32 v193, v146, v147
    v_mfma_f32_16x16x32_bf16 v[88:91], v[36:39], a[80:83], v[88:91]
    ds_read_b64_tr_b16 v[28:29], v13 offset:45056
    v_cvt_pk_bf16_f32 v194, v148, v149
    v_mfma_f32_16x16x32_bf16 v[92:95], v[36:39], a[84:87], v[92:95]
    ds_read_b64_tr_b16 v[30:31], v13 offset:45568
    s_waitcnt lgkmcnt(4)
    v_mfma_f32_16x16x32_bf16 v[96:99], v[40:43], a[80:83], v[96:99]
    ds_read_b64_tr_b16 v[32:33], v14 offset:45056
    buffer_store_dwordx4 v[220:223], v1, s[16:19], s34 offen offset:3072 sc1
    v_mfma_f32_16x16x32_bf16 v[100:103], v[40:43], a[84:87], v[100:103]
    ds_read_b64_tr_b16 v[34:35], v14 offset:45568
    v_cvt_pk_bf16_f32 v195, v150, v151
    v_mfma_f32_16x16x32_bf16 v[104:107], v[44:47], a[80:83], v[104:107]
    ds_read_b64_tr_b16 v[36:37], v15 offset:45056
    v_pk_max_i16 v192, v192, 0
    v_mfma_f32_16x16x32_bf16 v[108:111], v[44:47], a[84:87], v[108:111]
    ds_read_b64_tr_b16 v[38:39], v15 offset:45568
    s_waitcnt vmcnt(26)
    s_barrier
    s_waitcnt lgkmcnt(4)
    v_mfma_f32_16x16x32_bf16 v[80:83], v[24:27], a[88:91], v[80:83]
    ds_read_b64_tr_b16 v[40:41], v8 offset:0
    s_add_u32 m0, s73, 122880
    s_add_u32 s35, s38, 0
    v_mfma_f32_16x16x32_bf16 v[84:87], v[24:27], a[92:95], v[84:87]
    ds_read_b64_tr_b16 v[42:43], v8 offset:512
    buffer_load_dwordx4 v5, s[12:15], s35 offen offset:0 lds
    v_mfma_f32_16x16x32_bf16 v[88:91], v[28:31], a[88:91], v[88:91]
    ds_read_b64_tr_b16 v[44:45], v9 offset:0
    v_pk_max_i16 v193, v193, 0
    v_mfma_f32_16x16x32_bf16 v[92:95], v[28:31], a[92:95], v[92:95]
    ds_read_b64_tr_b16 v[46:47], v9 offset:512
    s_waitcnt lgkmcnt(4)
    v_mfma_f32_16x16x32_bf16 v[96:99], v[32:35], a[88:91], v[96:99]
    ds_read_b64_tr_b16 v[24:25], v10 offset:0
    buffer_load_dwordx4 v6, s[12:15], s35 offen offset:1024 lds
    v_mfma_f32_16x16x32_bf16 v[100:103], v[32:35], a[92:95], v[100:103]
    ds_read_b64_tr_b16 v[26:27], v10 offset:512
    v_pk_max_i16 v194, v194, 0
    v_mfma_f32_16x16x32_bf16 v[104:107], v[36:39], a[88:91], v[104:107]
    ds_read_b64_tr_b16 v[28:29], v11 offset:0
    v_pk_max_i16 v195, v195, 0
    v_mfma_f32_16x16x32_bf16 v[108:111], v[36:39], a[92:95], v[108:111]
    ds_read_b64_tr_b16 v[30:31], v11 offset:512
    s_waitcnt lgkmcnt(4)
    v_mfma_f32_16x16x32_bf16 v[80:83], v[40:43], a[96:99], v[80:83]
    ds_read_b64_tr_b16 v[32:33], v8 offset:4096
    buffer_load_dwordx4 v7, s[12:15], s35 offen offset:2048 lds
    v_mfma_f32_16x16x32_bf16 v[84:87], v[40:43], a[100:103], v[84:87]
    ds_read_b64_tr_b16 v[34:35], v8 offset:4608
    s_add_u32 m0, s73, 125952
    v_mfma_f32_16x16x32_bf16 v[88:91], v[44:47], a[96:99], v[88:91]
    ds_read_b64_tr_b16 v[36:37], v9 offset:4096
    s_add_u32 s35, s38, 9216
    v_mfma_f32_16x16x32_bf16 v[92:95], v[44:47], a[100:103], v[92:95]
    ds_read_b64_tr_b16 v[38:39], v9 offset:4608
    s_waitcnt lgkmcnt(4)
    v_mfma_f32_16x16x32_bf16 v[96:99], v[24:27], a[96:99], v[96:99]
    ds_read_b64_tr_b16 v[40:41], v10 offset:4096
    buffer_load_dwordx4 v5, s[12:15], s35 offen offset:0 lds
    v_mfma_f32_16x16x32_bf16 v[100:103], v[24:27], a[100:103], v[100:103]
    ds_read_b64_tr_b16 v[42:43], v10 offset:4608
    v_permlane16_swap_b32 v192, v194
    v_mfma_f32_16x16x32_bf16 v[104:107], v[28:31], a[96:99], v[104:107]
    ds_read_b64_tr_b16 v[44:45], v11 offset:4096
    v_permlane16_swap_b32 v193, v195
    v_mfma_f32_16x16x32_bf16 v[108:111], v[28:31], a[100:103], v[108:111]
    ds_read_b64_tr_b16 v[46:47], v11 offset:4608
    s_waitcnt lgkmcnt(4)
    v_mfma_f32_16x16x32_bf16 v[80:83], v[32:35], a[104:107], v[80:83]
    ds_read_b64_tr_b16 v[24:25], v8 offset:8192
    buffer_load_dwordx4 v6, s[12:15], s35 offen offset:1024 lds
    v_mfma_f32_16x16x32_bf16 v[84:87], v[32:35], a[108:111], v[84:87]
    ds_read_b64_tr_b16 v[26:27], v8 offset:8704
    v_cvt_pk_bf16_f32 v196, v152, v153
    v_mfma_f32_16x16x32_bf16 v[88:91], v[36:39], a[104:107], v[88:91]
    ds_read_b64_tr_b16 v[28:29], v9 offset:8192
    v_cvt_pk_bf16_f32 v197, v154, v155
    v_mfma_f32_16x16x32_bf16 v[92:95], v[36:39], a[108:111], v[92:95]
    ds_read_b64_tr_b16 v[30:31], v9 offset:8704
    s_waitcnt lgkmcnt(4)
    v_mfma_f32_16x16x32_bf16 v[96:99], v[40:43], a[104:107], v[96:99]
    ds_read_b64_tr_b16 v[32:33], v10 offset:8192
    v_cvt_pk_bf16_f32 v198, v156, v157
    v_mfma_f32_16x16x32_bf16 v[100:103], v[40:43], a[108:111], v[100:103]
    ds_read_b64_tr_b16 v[34:35], v10 offset:8704
    v_cvt_pk_bf16_f32 v199, v158, v159
    v_mfma_f32_16x16x32_bf16 v[104:107], v[44:47], a[104:107], v[104:107]
    ds_read_b64_tr_b16 v[36:37], v11 offset:8192
    s_add_u32 s34, s91, 8192
    buffer_store_dwordx4 v[192:195], v1, s[16:19], s34 offen offset:0 sc1
    v_mfma_f32_16x16x32_bf16 v[108:111], v[44:47], a[108:111], v[108:111]
    ds_read_b64_tr_b16 v[38:39], v11 offset:8704
    s_waitcnt lgkmcnt(4)
    v_mfma_f32_16x16x32_bf16 v[80:83], v[24:27], a[112:115], v[80:83]
    ds_read_b64_tr_b16 v[40:41], v16 offset:57344
    v_pk_max_i16 v196, v196, 0
    v_mfma_f32_16x16x32_bf16 v[84:87], v[24:27], a[116:119], v[84:87]
    ds_read_b64_tr_b16 v[42:43], v16 offset:57856
    v_pk_max_i16 v197, v197, 0
    v_mfma_f32_16x16x32_bf16 v[88:91], v[28:31], a[112:115], v[88:91]
    ds_read_b64_tr_b16 v[44:45], v17 offset:57344
    buffer_load_dwordx4 v7, s[12:15], s35 offen offset:2048 lds
    v_mfma_f32_16x16x32_bf16 v[92:95], v[28:31], a[116:119], v[92:95]
    ds_read_b64_tr_b16 v[46:47], v17 offset:57856
    s_waitcnt lgkmcnt(4)
    v_mfma_f32_16x16x32_bf16 v[96:99], v[32:35], a[112:115], v[96:99]
    ds_read_b64_tr_b16 v[24:25], v18 offset:57344
    v_pk_max_i16 v198, v198, 0
    v_mfma_f32_16x16x32_bf16 v[100:103], v[32:35], a[116:119], v[100:103]
    ds_read_b64_tr_b16 v[26:27], v18 offset:57856
    v_pk_max_i16 v199, v199, 0
    v_mfma_f32_16x16x32_bf16 v[104:107], v[36:39], a[112:115], v[104:107]
    ds_read_b64_tr_b16 v[28:29], v19 offset:57344
    v_permlane16_swap_b32 v196, v198
    v_mfma_f32_16x16x32_bf16 v[108:111], v[36:39], a[116:119], v[108:111]
    ds_read_b64_tr_b16 v[30:31], v19 offset:57856
    s_waitcnt lgkmcnt(4)
    v_mfma_f32_16x16x32_bf16 v[80:83], v[40:43], v[244:247], v[80:83]
    ds_read_b64_tr_b16 v[32:33], v8 offset:12288
    v_permlane16_swap_b32 v197, v199
    v_mfma_f32_16x16x32_bf16 v[84:87], v[40:43], v[20:23], v[84:87]
    ds_read_b64_tr_b16 v[34:35], v8 offset:12800
    v_cvt_pk_bf16_f32 v200, v160, v161
    v_mfma_f32_16x16x32_bf16 v[88:91], v[44:47], v[244:247], v[88:91]
    ds_read_b64_tr_b16 v[36:37], v9 offset:12288
    v_cvt_pk_bf16_f32 v201, v162, v163
    v_mfma_f32_16x16x32_bf16 v[92:95], v[44:47], v[20:23], v[92:95]
    ds_read_b64_tr_b16 v[38:39], v9 offset:12800
    s_waitcnt lgkmcnt(4)
    v_mfma_f32_16x16x32_bf16 v[96:99], v[24:27], v[244:247], v[96:99]
    ds_read_b64_tr_b16 v[40:41], v10 offset:12288
    v_cvt_pk_bf16_f32 v202, v164, v165
    v_mfma_f32_16x16x32_bf16 v[100:103], v[24:27], v[20:23], v[100:103]
    ds_read_b64_tr_b16 v[42:43], v10 offset:12800
    v_cvt_pk_bf16_f32 v203, v166, v167
    v_mfma_f32_16x16x32_bf16 v[104:107], v[28:31], v[244:247], v[104:107]
    ds_read_b64_tr_b16 v[44:45], v11 offset:12288
    buffer_store_dwordx4 v[196:199], v1, s[16:19], s34 offen offset:1024 sc1
    v_mfma_f32_16x16x32_bf16 v[108:111], v[28:31], v[20:23], v[108:111]
    ds_read_b64_tr_b16 v[46:47], v11 offset:12800
    s_waitcnt lgkmcnt(4)
    v_mfma_f32_16x16x32_bf16 v[80:83], v[32:35], a[120:123], v[80:83]
    ds_read_b64_tr_b16 v[24:25], v8 offset:16384
    v_pk_max_i16 v200, v200, 0
    v_mfma_f32_16x16x32_bf16 v[84:87], v[32:35], a[124:127], v[84:87]
    ds_read_b64_tr_b16 v[26:27], v8 offset:16896
    v_pk_max_i16 v201, v201, 0
    v_mfma_f32_16x16x32_bf16 v[88:91], v[36:39], a[120:123], v[88:91]
    ds_read_b64_tr_b16 v[28:29], v9 offset:16384
    v_pk_max_i16 v202, v202, 0
    v_mfma_f32_16x16x32_bf16 v[92:95], v[36:39], a[124:127], v[92:95]
    ds_read_b64_tr_b16 v[30:31], v9 offset:16896
    s_waitcnt lgkmcnt(4)
    v_mfma_f32_16x16x32_bf16 v[96:99], v[40:43], a[120:123], v[96:99]
    ds_read_b64_tr_b16 v[32:33], v10 offset:16384
    v_pk_max_i16 v203, v203, 0
    v_mfma_f32_16x16x32_bf16 v[100:103], v[40:43], a[124:127], v[100:103]
    ds_read_b64_tr_b16 v[34:35], v10 offset:16896
    v_permlane16_swap_b32 v200, v202
    v_mfma_f32_16x16x32_bf16 v[104:107], v[44:47], a[120:123], v[104:107]
    ds_read_b64_tr_b16 v[36:37], v11 offset:16384
    v_permlane16_swap_b32 v201, v203
    v_mfma_f32_16x16x32_bf16 v[108:111], v[44:47], a[124:127], v[108:111]
    ds_read_b64_tr_b16 v[38:39], v11 offset:16896
    s_waitcnt lgkmcnt(4)
    v_mfma_f32_16x16x32_bf16 v[80:83], v[24:27], a[128:131], v[80:83]
    ds_read_b64_tr_b16 v[40:41], v8 offset:20480
    v_cvt_pk_bf16_f32 v204, v168, v169
    v_mfma_f32_16x16x32_bf16 v[84:87], v[24:27], a[132:135], v[84:87]
    ds_read_b64_tr_b16 v[42:43], v8 offset:20992
    v_cvt_pk_bf16_f32 v205, v170, v171
    v_mfma_f32_16x16x32_bf16 v[88:91], v[28:31], a[128:131], v[88:91]
    ds_read_b64_tr_b16 v[44:45], v9 offset:20480
    v_cvt_pk_bf16_f32 v206, v172, v173
    v_mfma_f32_16x16x32_bf16 v[92:95], v[28:31], a[132:135], v[92:95]
    ds_read_b64_tr_b16 v[46:47], v9 offset:20992
    s_waitcnt lgkmcnt(4)
    v_mfma_f32_16x16x32_bf16 v[96:99], v[32:35], a[128:131], v[96:99]
    ds_read_b64_tr_b16 v[24:25], v10 offset:20480
    v_cvt_pk_bf16_f32 v207, v174, v175
    v_mfma_f32_16x16x32_bf16 v[100:103], v[32:35], a[132:135], v[100:103]
    ds_read_b64_tr_b16 v[26:27], v10 offset:20992
    v_pk_max_i16 v204, v204, 0
    v_mfma_f32_16x16x32_bf16 v[104:107], v[36:39], a[128:131], v[104:107]
    ds_read_b64_tr_b16 v[28:29], v11 offset:20480
    buffer_store_dwordx4 v[200:203], v1, s[16:19], s34 offen offset:2048 sc1
    v_mfma_f32_16x16x32_bf16 v[108:111], v[36:39], a[132:135], v[108:111]
    ds_read_b64_tr_b16 v[30:31], v11 offset:20992
    s_waitcnt vmcnt(29)
    s_barrier
    s_waitcnt lgkmcnt(4)
    v_mfma_f32_16x16x32_bf16 v[80:83], v[40:43], a[136:139], v[80:83]
    ds_read_b64_tr_b16 v[32:33], v8 offset:24576
    s_add_u32 m0, s73, 73728
    v_mfma_f32_16x16x32_bf16 v[84:87], v[40:43], a[140:143], v[84:87]
    ds_read_b64_tr_b16 v[34:35], v8 offset:25088
    s_add_u32 s35, s39, 0
    v_mfma_f32_16x16x32_bf16 v[88:91], v[44:47], a[136:139], v[88:91]
    ds_read_b64_tr_b16 v[36:37], v9 offset:24576
    buffer_load_dwordx4 v5, s[12:15], s35 offen offset:0 lds
    v_mfma_f32_16x16x32_bf16 v[92:95], v[44:47], a[140:143], v[92:95]
    ds_read_b64_tr_b16 v[38:39], v9 offset:25088
    s_waitcnt lgkmcnt(4)
    v_mfma_f32_16x16x32_bf16 v[96:99], v[24:27], a[136:139], v[96:99]
    ds_read_b64_tr_b16 v[40:41], v10 offset:24576
    v_pk_max_i16 v205, v205, 0
    v_mfma_f32_16x16x32_bf16 v[100:103], v[24:27], a[140:143], v[100:103]
    ds_read_b64_tr_b16 v[42:43], v10 offset:25088
    v_pk_max_i16 v206, v206, 0
    v_mfma_f32_16x16x32_bf16 v[104:107], v[28:31], a[136:139], v[104:107]
    ds_read_b64_tr_b16 v[44:45], v11 offset:24576
    v_pk_max_i16 v207, v207, 0
    v_mfma_f32_16x16x32_bf16 v[108:111], v[28:31], a[140:143], v[108:111]
    ds_read_b64_tr_b16 v[46:47], v11 offset:25088
    s_waitcnt lgkmcnt(4)
    v_mfma_f32_16x16x32_bf16 v[112:115], v[32:35], a[0:3], 0
    ds_read_b64_tr_b16 v[24:25], v8 offset:28672
    v_permlane16_swap_b32 v204, v206
    v_mfma_f32_16x16x32_bf16 v[116:119], v[32:35], a[4:7], 0
    ds_read_b64_tr_b16 v[26:27], v8 offset:29184
    v_permlane16_swap_b32 v205, v207
    v_mfma_f32_16x16x32_bf16 v[120:123], v[36:39], a[0:3], 0
    ds_read_b64_tr_b16 v[28:29], v9 offset:28672
    buffer_load_dwordx4 v6, s[12:15], s35 offen offset:1024 lds
    v_mfma_f32_16x16x32_bf16 v[124:127], v[36:39], a[4:7], 0
    ds_read_b64_tr_b16 v[30:31], v9 offset:29184
    s_waitcnt lgkmcnt(4)
    v_mfma_f32_16x16x32_bf16 v[128:131], v[40:43], a[0:3], 0
    ds_read_b64_tr_b16 v[32:33], v10 offset:28672
    v_cvt_pk_bf16_f32 v48, v48, v49
    v_mfma_f32_16x16x32_bf16 v[132:135], v[40:43], a[4:7], 0
    ds_read_b64_tr_b16 v[34:35], v10 offset:29184
    v_cvt_pk_bf16_f32 v49, v50, v51
    v_mfma_f32_16x16x32_bf16 v[136:139], v[44:47], a[0:3], 0
    ds_read_b64_tr_b16 v[36:37], v11 offset:28672
    buffer_store_dwordx4 v[204:207], v1, s[16:19], s34 offen offset:3072 sc1
    v_mfma_f32_16x16x32_bf16 v[140:143], v[44:47], a[4:7], 0
    ds_read_b64_tr_b16 v[38:39], v11 offset:29184
    s_waitcnt lgkmcnt(4)
    v_mfma_f32_16x16x32_bf16 v[112:115], v[24:27], a[8:11], v[112:115]
    ds_read_b64_tr_b16 v[40:41], v8 offset:32768
    v_cvt_pk_bf16_f32 v50, v52, v53
    v_mfma_f32_16x16x32_bf16 v[116:119], v[24:27], a[12:15], v[116:119]
    ds_read_b64_tr_b16 v[42:43], v8 offset:33280
    v_cvt_pk_bf16_f32 v51, v54, v55
    v_mfma_f32_16x16x32_bf16 v[120:123], v[28:31], a[8:11], v[120:123]
    ds_read_b64_tr_b16 v[44:45], v9 offset:32768
    buffer_load_dwordx4 v7, s[12:15], s35 offen offset:2048 lds
    v_mfma_f32_16x16x32_bf16 v[124:127], v[28:31], a[12:15], v[124:127]
    ds_read_b64_tr_b16 v[46:47], v9 offset:33280
    s_waitcnt lgkmcnt(4)
    v_mfma_f32_16x16x32_bf16 v[128:131], v[32:35], a[8:11], v[128:131]
    ds_read_b64_tr_b16 v[24:25], v10 offset:32768
    s_add_u32 m0, s73, 76800
    v_mfma_f32_16x16x32_bf16 v[132:135], v[32:35], a[12:15], v[132:135]
    ds_read_b64_tr_b16 v[26:27], v10 offset:33280
    s_add_u32 s35, s39, 9216
    v_mfma_f32_16x16x32_bf16 v[136:139], v[36:39], a[8:11], v[136:139]
    ds_read_b64_tr_b16 v[28:29], v11 offset:32768
    v_pk_max_i16 v48, v48, 0
    v_mfma_f32_16x16x32_bf16 v[140:143], v[36:39], a[12:15], v[140:143]
    ds_read_b64_tr_b16 v[30:31], v11 offset:33280
    s_waitcnt lgkmcnt(4)
    v_mfma_f32_16x16x32_bf16 v[112:115], v[40:43], a[16:19], v[112:115]
    ds_read_b64_tr_b16 v[32:33], v8 offset:36864
    v_pk_max_i16 v49, v49, 0
    v_mfma_f32_16x16x32_bf16 v[116:119], v[40:43], a[20:23], v[116:119]
    ds_read_b64_tr_b16 v[34:35], v8 offset:37376
    v_pk_max_i16 v50, v50, 0
    v_mfma_f32_16x16x32_bf16 v[120:123], v[44:47], a[16:19], v[120:123]
    ds_read_b64_tr_b16 v[36:37], v9 offset:36864
    buffer_load_dwordx4 v5, s[12:15], s35 offen offset:0 lds
    v_mfma_f32_16x16x32_bf16 v[124:127], v[44:47], a[20:23], v[124:127]
    ds_read_b64_tr_b16 v[38:39], v9 offset:37376
    s_waitcnt lgkmcnt(4)
    v_mfma_f32_16x16x32_bf16 v[128:131], v[24:27], a[16:19], v[128:131]
    ds_read_b64_tr_b16 v[40:41], v10 offset:36864
    v_pk_max_i16 v51, v51, 0
    v_mfma_f32_16x16x32_bf16 v[132:135], v[24:27], a[20:23], v[132:135]
    ds_read_b64_tr_b16 v[42:43], v10 offset:37376
    v_permlane16_swap_b32 v48, v50
    v_mfma_f32_16x16x32_bf16 v[136:139], v[28:31], a[16:19], v[136:139]
    ds_read_b64_tr_b16 v[44:45], v11 offset:36864
    buffer_store_dwordx4 a[252:255], v1, s[16:19], s56 offen offset:0 sc1
    v_mfma_f32_16x16x32_bf16 v[140:143], v[28:31], a[20:23], v[140:143]
    ds_read_b64_tr_b16 v[46:47], v11 offset:37376
    s_waitcnt lgkmcnt(4)
    v_mfma_f32_16x16x32_bf16 v[112:115], v[32:35], a[24:27], v[112:115]
    ds_read_b64_tr_b16 v[24:25], v8 offset:40960
    v_permlane16_swap_b32 v49, v51
    v_mfma_f32_16x16x32_bf16 v[116:119], v[32:35], a[28:31], v[116:119]
    ds_read_b64_tr_b16 v[26:27], v8 offset:41472
    v_cvt_pk_bf16_f32 v52, v56, v57
    v_mfma_f32_16x16x32_bf16 v[120:123], v[36:39], a[24:27], v[120:123]
    ds_read_b64_tr_b16 v[28:29], v9 offset:40960
    buffer_load_dwordx4 v6, s[12:15], s35 offen offset:1024 lds
    v_mfma_f32_16x16x32_bf16 v[124:127], v[36:39], a[28:31], v[124:127]
    ds_read_b64_tr_b16 v[30:31], v9 offset:41472
    s_waitcnt lgkmcnt(4)
    v_mfma_f32_16x16x32_bf16 v[128:131], v[40:43], a[24:27], v[128:131]
    ds_read_b64_tr_b16 v[32:33], v10 offset:40960
    v_cvt_pk_bf16_f32 v53, v58, v59
    v_mfma_f32_16x16x32_bf16 v[132:135], v[40:43], a[28:31], v[132:135]
    ds_read_b64_tr_b16 v[34:35], v10 offset:41472
    v_cvt_pk_bf16_f32 v54, v60, v61
    v_mfma_f32_16x16x32_bf16 v[136:139], v[44:47], a[24:27], v[136:139]
    ds_read_b64_tr_b16 v[36:37], v11 offset:40960
    v_cvt_pk_bf16_f32 v55, v62, v63
    v_mfma_f32_16x16x32_bf16 v[140:143], v[44:47], a[28:31], v[140:143]
    ds_read_b64_tr_b16 v[38:39], v11 offset:41472
    s_waitcnt lgkmcnt(4)
    v_mfma_f32_16x16x32_bf16 v[112:115], v[24:27], a[32:35], v[112:115]
    ds_read_b64_tr_b16 v[40:41], v8 offset:45056
    v_pk_max_i16 v52, v52, 0
    v_mfma_f32_16x16x32_bf16 v[116:119], v[24:27], a[36:39], v[116:119]
    ds_read_b64_tr_b16 v[42:43], v8 offset:45568
    v_pk_max_i16 v53, v53, 0
    v_mfma_f32_16x16x32_bf16 v[120:123], v[28:31], a[32:35], v[120:123]
    ds_read_b64_tr_b16 v[44:45], v9 offset:45056
    buffer_load_dwordx4 v7, s[12:15], s35 offen offset:2048 lds
    v_mfma_f32_16x16x32_bf16 v[124:127], v[28:31], a[36:39], v[124:127]
    ds_read_b64_tr_b16 v[46:47], v9 offset:45568
    s_waitcnt lgkmcnt(4)
    v_mfma_f32_16x16x32_bf16 v[128:131], v[32:35], a[32:35], v[128:131]
    ds_read_b64_tr_b16 v[24:25], v10 offset:45056
    v_pk_max_i16 v54, v54, 0
    v_mfma_f32_16x16x32_bf16 v[132:135], v[32:35], a[36:39], v[132:135]
    ds_read_b64_tr_b16 v[26:27], v10 offset:45568
    v_pk_max_i16 v55, v55, 0
    v_mfma_f32_16x16x32_bf16 v[136:139], v[36:39], a[32:35], v[136:139]
    ds_read_b64_tr_b16 v[28:29], v11 offset:45056
    s_add_u32 s34, s91, 12288
    buffer_store_dwordx4 v[48:51], v1, s[16:19], s34 offen offset:0 sc1
    v_mfma_f32_16x16x32_bf16 v[140:143], v[36:39], a[36:39], v[140:143]
    ds_read_b64_tr_b16 v[30:31], v11 offset:45568
    s_waitcnt vmcnt(28)
    s_barrier
    s_waitcnt lgkmcnt(4)
    v_mfma_f32_16x16x32_bf16 v[112:115], v[40:43], a[40:43], v[112:115]
    ds_read_b64_tr_b16 v[32:33], v16 offset:0
    s_add_u32 m0, s73, 0
    v_mfma_f32_16x16x32_bf16 v[116:119], v[40:43], a[44:47], v[116:119]
    ds_read_b64_tr_b16 v[34:35], v16 offset:512
    s_add_u32 s35, s40, 0
    v_mfma_f32_16x16x32_bf16 v[120:123], v[44:47], a[40:43], v[120:123]
    ds_read_b64_tr_b16 v[36:37], v17 offset:0
    buffer_load_dwordx4 v5, s[12:15], s35 offen offset:0 lds
    v_mfma_f32_16x16x32_bf16 v[124:127], v[44:47], a[44:47], v[124:127]
    ds_read_b64_tr_b16 v[38:39], v17 offset:512
    s_waitcnt lgkmcnt(4)
    v_mfma_f32_16x16x32_bf16 v[128:131], v[24:27], a[40:43], v[128:131]
    ds_read_b64_tr_b16 v[40:41], v18 offset:0
    v_permlane16_swap_b32 v52, v54
    v_mfma_f32_16x16x32_bf16 v[132:135], v[24:27], a[44:47], v[132:135]
    ds_read_b64_tr_b16 v[42:43], v18 offset:512
    v_permlane16_swap_b32 v53, v55
    v_mfma_f32_16x16x32_bf16 v[136:139], v[28:31], a[40:43], v[136:139]
    ds_read_b64_tr_b16 v[44:45], v19 offset:0
    v_cvt_pk_bf16_f32 v56, v64, v65
    v_mfma_f32_16x16x32_bf16 v[140:143], v[28:31], a[44:47], v[140:143]
    ds_read_b64_tr_b16 v[46:47], v19 offset:512
    s_waitcnt lgkmcnt(4)
    v_mfma_f32_16x16x32_bf16 v[112:115], v[32:35], a[48:51], v[112:115]
    ds_read_b64_tr_b16 v[24:25], v16 offset:4096
    v_cvt_pk_bf16_f32 v57, v66, v67
    v_mfma_f32_16x16x32_bf16 v[116:119], v[32:35], a[52:55], v[116:119]
    ds_read_b64_tr_b16 v[26:27], v16 offset:4608
    v_cvt_pk_bf16_f32 v58, v68, v69
    v_mfma_f32_16x16x32_bf16 v[120:123], v[36:39], a[48:51], v[120:123]
    ds_read_b64_tr_b16 v[28:29], v17 offset:4096
    buffer_load_dwordx4 v6, s[12:15], s35 offen offset:1024 lds
    v_mfma_f32_16x16x32_bf16 v[124:127], v[36:39], a[52:55], v[124:127]
    ds_read_b64_tr_b16 v[30:31], v17 offset:4608
    s_waitcnt lgkmcnt(4)
    v_mfma_f32_16x16x32_bf16 v[128:131], v[40:43], a[48:51], v[128:131]
    ds_read_b64_tr_b16 v[32:33], v18 offset:4096
    v_cvt_pk_bf16_f32 v59, v70, v71
    v_mfma_f32_16x16x32_bf16 v[132:135], v[40:43], a[52:55], v[132:135]
    ds_read_b64_tr_b16 v[34:35], v18 offset:4608
    v_pk_max_i16 v56, v56, 0
    v_mfma_f32_16x16x32_bf16 v[136:139], v[44:47], a[48:51], v[136:139]
    ds_read_b64_tr_b16 v[36:37], v19 offset:4096
    buffer_store_dwordx4 v[52:55], v1, s[16:19], s34 offen offset:1024 sc1
    v_mfma_f32_16x16x32_bf16 v[140:143], v[44:47], a[52:55], v[140:143]
    ds_read_b64_tr_b16 v[38:39], v19 offset:4608
    s_waitcnt lgkmcnt(4)
    v_mfma_f32_16x16x32_bf16 v[112:115], v[24:27], a[56:59], v[112:115]
    ds_read_b64_tr_b16 v[40:41], v16 offset:8192
    v_pk_max_i16 v57, v57, 0
    v_mfma_f32_16x16x32_bf16 v[116:119], v[24:27], a[60:63], v[116:119]
    ds_read_b64_tr_b16 v[42:43], v16 offset:8704
    v_pk_max_i16 v58, v58, 0
    v_mfma_f32_16x16x32_bf16 v[120:123], v[28:31], a[56:59], v[120:123]
    ds_read_b64_tr_b16 v[44:45], v17 offset:8192
    buffer_load_dwordx4 v7, s[12:15], s35 offen offset:2048 lds
    v_mfma_f32_16x16x32_bf16 v[124:127], v[28:31], a[60:63], v[124:127]
    ds_read_b64_tr_b16 v[46:47], v17 offset:8704
    s_waitcnt lgkmcnt(4)
    v_mfma_f32_16x16x32_bf16 v[128:131], v[32:35], a[56:59], v[128:131]
    ds_read_b64_tr_b16 v[24:25], v18 offset:8192
    s_add_u32 m0, s73, 3072
    v_mfma_f32_16x16x32_bf16 v[132:135], v[32:35], a[60:63], v[132:135]
    ds_read_b64_tr_b16 v[26:27], v18 offset:8704
    s_add_u32 s35, s40, 9216
    v_mfma_f32_16x16x32_bf16 v[136:139], v[36:39], a[56:59], v[136:139]
    ds_read_b64_tr_b16 v[28:29], v19 offset:8192
    v_pk_max_i16 v59, v59, 0
    v_mfma_f32_16x16x32_bf16 v[140:143], v[36:39], a[60:63], v[140:143]
    ds_read_b64_tr_b16 v[30:31], v19 offset:8704
    s_waitcnt lgkmcnt(4)
    v_mfma_f32_16x16x32_bf16 v[112:115], v[40:43], a[64:67], v[112:115]
    ds_read_b64_tr_b16 v[32:33], v16 offset:59392
    v_permlane16_swap_b32 v56, v58
    v_mfma_f32_16x16x32_bf16 v[116:119], v[40:43], a[68:71], v[116:119]
    ds_read_b64_tr_b16 v[34:35], v16 offset:59904
    v_permlane16_swap_b32 v57, v59
L_pg4:
    s_cbranch_execz L_pg8
    v_mfma_f32_16x16x32_bf16 v[120:123], v[44:47], a[64:67], v[120:123]
    ds_read_b64_tr_b16 v[36:37], v17 offset:59392
    buffer_load_dwordx4 v5, s[12:15], s35 offen offset:0 lds
    v_mfma_f32_16x16x32_bf16 v[124:127], v[44:47], a[68:71], v[124:127]
    ds_read_b64_tr_b16 v[38:39], v17 offset:59904
    s_waitcnt lgkmcnt(4)
    v_mfma_f32_16x16x32_bf16 v[128:131], v[24:27], a[64:67], v[128:131]
    ds_read_b64_tr_b16 v[40:41], v18 offset:59392
    v_cvt_pk_bf16_f32 v60, v72, v73
    v_mfma_f32_16x16x32_bf16 v[132:135], v[24:27], a[68:71], v[132:135]
    ds_read_b64_tr_b16 v[42:43], v18 offset:59904
    v_cvt_pk_bf16_f32 v61, v74, v75
    v_mfma_f32_16x16x32_bf16 v[136:139], v[28:31], a[64:67], v[136:139]
    ds_read_b64_tr_b16 v[44:45], v19 offset:59392
    buffer_store_dwordx4 v[56:59], v1, s[16:19], s34 offen offset:2048 sc1
    v_mfma_f32_16x16x32_bf16 v[140:143], v[28:31], a[68:71], v[140:143]
    ds_read_b64_tr_b16 v[46:47], v19 offset:59904
    s_waitcnt lgkmcnt(4)
    v_mfma_f32_16x16x32_bf16 v[112:115], v[32:35], v[244:247], v[112:115]
    ds_read_b64_tr_b16 v[24:25], v16 offset:12288
    v_cvt_pk_bf16_f32 v62, v76, v77
    v_mfma_f32_16x16x32_bf16 v[116:119], v[32:35], v[20:23], v[116:119]
    ds_read_b64_tr_b16 v[26:27], v16 offset:12800
    v_cvt_pk_bf16_f32 v63, v78, v79
    v_mfma_f32_16x16x32_bf16 v[120:123], v[36:39], v[244:247], v[120:123]
    ds_read_b64_tr_b16 v[28:29], v17 offset:12288
    buffer_load_dwordx4 v6, s[12:15], s35 offen offset:1024 lds
    v_mfma_f32_16x16x32_bf16 v[124:127], v[36:39], v[20:23], v[124:127]
    ds_read_b64_tr_b16 v[30:31], v17 offset:12800
    s_waitcnt lgkmcnt(4)
    v_mfma_f32_16x16x32_bf16 v[128:131], v[40:43], v[244:247], v[128:131]
    ds_read_b64_tr_b16 v[32:33], v18 offset:12288
    v_pk_max_i16 v60, v60, 0
    v_mfma_f32_16x16x32_bf16 v[132:135], v[40:43], v[20:23], v[132:135]
    ds_read_b64_tr_b16 v[34:35], v18 offset:12800
    v_pk_max_i16 v61, v61, 0
    v_mfma_f32_16x16x32_bf16 v[136:139], v[44:47], v[244:247], v[136:139]
    ds_read_b64_tr_b16 v[36:37], v19 offset:12288
    v_pk_max_i16 v62, v62, 0
    v_mfma_f32_16x16x32_bf16 v[140:143], v[44:47], v[20:23], v[140:143]
    ds_read_b64_tr_b16 v[38:39], v19 offset:12800
    s_waitcnt lgkmcnt(4)
    v_mfma_f32_16x16x32_bf16 v[112:115], v[24:27], a[72:75], v[112:115]
    ds_read_b64_tr_b16 v[40:41], v16 offset:16384
    v_pk_max_i16 v63, v63, 0
    v_mfma_f32_16x16x32_bf16 v[116:119], v[24:27], a[76:79], v[116:119]
    ds_read_b64_tr_b16 v[42:43], v16 offset:16896
    v_permlane16_swap_b32 v60, v62
    v_mfma_f32_16x16x32_bf16 v[120:123], v[28:31], a[72:75], v[120:123]
    ds_read_b64_tr_b16 v[44:45], v17 offset:16384
    buffer_load_dwordx4 v7, s[12:15], s35 offen offset:2048 lds
    v_mfma_f32_16x16x32_bf16 v[124:127], v[28:31], a[76:79], v[124:127]
    ds_read_b64_tr_b16 v[46:47], v17 offset:16896
    s_waitcnt lgkmcnt(4)
    v_mfma_f32_16x16x32_bf16 v[128:131], v[32:35], a[72:75], v[128:131]
    ds_read_b64_tr_b16 v[24:25], v18 offset:16384
    v_permlane16_swap_b32 v61, v63
    v_mfma_f32_16x16x32_bf16 v[132:135], v[32:35], a[76:79], v[132:135]
    ds_read_b64_tr_b16 v[26:27], v18 offset:16896
    v_cvt_pk_bf16_f32 v64, v80, v81
    v_mfma_f32_16x16x32_bf16 v[136:139], v[36:39], a[72:75], v[136:139]
    ds_read_b64_tr_b16 v[28:29], v19 offset:16384
    buffer_store_dwordx4 v[60:63], v1, s[16:19], s34 offen offset:3072 sc1
    v_mfma_f32_16x16x32_bf16 v[140:143], v[36:39], a[76:79], v[140:143]
    ds_read_b64_tr_b16 v[30:31], v19 offset:16896
    s_waitcnt lgkmcnt(4)
    v_mfma_f32_16x16x32_bf16 v[112:115], v[40:43], a[80:83], v[112:115]
    ds_read_b64_tr_b16 v[32:33], v16 offset:20480
    v_cvt_pk_bf16_f32 v65, v82, v83
    v_mfma_f32_16x16x32_bf16 v[116:119], v[40:43], a[84:87], v[116:119]
    ds_read_b64_tr_b16 v[34:35], v16 offset:20992
    v_cvt_pk_bf16_f32 v66, v84, v85
    v_mfma_f32_16x16x32_bf16 v[120:123], v[44:47], a[80:83], v[120:123]
    ds_read_b64_tr_b16 v[36:37], v17 offset:20480
    v_cvt_pk_bf16_f32 v67, v86, v87
    v_mfma_f32_16x16x32_bf16 v[124:127], v[44:47], a[84:87], v[124:127]
    ds_read_b64_tr_b16 v[38:39], v17 offset:20992
    s_waitcnt lgkmcnt(4)
    v_mfma_f32_16x16x32_bf16 v[128:131], v[24:27], a[80:83], v[128:131]
    ds_read_b64_tr_b16 v[40:41], v18 offset:20480
    v_pk_max_i16 v64, v64, 0
    v_mfma_f32_16x16x32_bf16 v[132:135], v[24:27], a[84:87], v[132:135]
    ds_read_b64_tr_b16 v[42:43], v18 offset:20992
    v_pk_max_i16 v65, v65, 0
    v_mfma_f32_16x16x32_bf16 v[136:139], v[28:31], a[80:83], v[136:139]
    ds_read_b64_tr_b16 v[44:45], v19 offset:20480
    v_pk_max_i16 v66, v66, 0
    v_mfma_f32_16x16x32_bf16 v[140:143], v[28:31], a[84:87], v[140:143]
    ds_read_b64_tr_b16 v[46:47], v19 offset:20992
    s_waitcnt vmcnt(29)
    s_waitcnt vmcnt(15)
    v_mov_b32 v243, 1
    buffer_store_dword v243, v240, s[16:19], s95 offen sc1
    s_barrier
    s_waitcnt lgkmcnt(4)
    v_mfma_f32_16x16x32_bf16 v[112:115], v[32:35], a[88:91], v[112:115]
    ds_read_b64_tr_b16 v[24:25], v12 offset:0
    s_add_u32 m0, s73, 24576
    s_add_u32 s35, s38, 221184
    v_mfma_f32_16x16x32_bf16 v[116:119], v[32:35], a[92:95], v[116:119]
    ds_read_b64_tr_b16 v[26:27], v12 offset:512
    buffer_load_dwordx4 v5, s[12:15], s35 offen offset:0 lds
    v_mfma_f32_16x16x32_bf16 v[120:123], v[36:39], a[88:91], v[120:123]
    ds_read_b64_tr_b16 v[28:29], v13 offset:0
    v_pk_max_i16 v67, v67, 0
    v_mfma_f32_16x16x32_bf16 v[124:127], v[36:39], a[92:95], v[124:127]
    ds_read_b64_tr_b16 v[30:31], v13 offset:512
    s_waitcnt lgkmcnt(4)
    v_mfma_f32_16x16x32_bf16 v[128:131], v[40:43], a[88:91], v[128:131]
    ds_read_b64_tr_b16 v[32:33], v14 offset:0
    v_permlane16_swap_b32 v64, v66
    v_mfma_f32_16x16x32_bf16 v[132:135], v[40:43], a[92:95], v[132:135]
    ds_read_b64_tr_b16 v[34:35], v14 offset:512
    v_permlane16_swap_b32 v65, v67
    v_mfma_f32_16x16x32_bf16 v[136:139], v[44:47], a[88:91], v[136:139]
    ds_read_b64_tr_b16 v[36:37], v15 offset:0
    buffer_store_dwordx4 a[252:255], v1, s[16:19], s56 offen offset:1024 sc1
    v_mfma_f32_16x16x32_bf16 v[140:143], v[44:47], a[92:95], v[140:143]
    ds_read_b64_tr_b16 v[38:39], v15 offset:512
    s_waitcnt lgkmcnt(4)
    v_mfma_f32_16x16x32_bf16 v[112:115], v[24:27], a[96:99], v[112:115]
    ds_read_b64_tr_b16 v[40:41], v12 offset:4096
    v_cvt_pk_bf16_f32 v68, v88, v89
    v_mfma_f32_16x16x32_bf16 v[116:119], v[24:27], a[100:103], v[116:119]
    ds_read_b64_tr_b16 v[42:43], v12 offset:4608
    v_cvt_pk_bf16_f32 v69, v90, v91
    v_mfma_f32_16x16x32_bf16 v[120:123], v[28:31], a[96:99], v[120:123]
    ds_read_b64_tr_b16 v[44:45], v13 offset:4096
    buffer_load_dwordx4 v6, s[12:15], s35 offen offset:1024 lds
    v_mfma_f32_16x16x32_bf16 v[124:127], v[28:31], a[100:103], v[124:127]
    ds_read_b64_tr_b16 v[46:47], v13 offset:4608
    s_waitcnt lgkmcnt(4)
    v_mfma_f32_16x16x32_bf16 v[128:131], v[32:35], a[96:99], v[128:131]
    ds_read_b64_tr_b16 v[24:25], v14 offset:4096
    v_accvgpr_read_b32 v8, a240
    v_mfma_f32_16x16x32_bf16 v[132:135], v[32:35], a[100:103], v[132:135]
    ds_read_b64_tr_b16 v[26:27], v14 offset:4608
    v_accvgpr_read_b32 v9, a241
    v_mfma_f32_16x16x32_bf16 v[136:139], v[36:39], a[96:99], v[136:139]
    ds_read_b64_tr_b16 v[28:29], v15 offset:4096
    v_accvgpr_read_b32 v10, a242
    v_mfma_f32_16x16x32_bf16 v[140:143], v[36:39], a[100:103], v[140:143]
    ds_read_b64_tr_b16 v[30:31], v15 offset:4608
    s_waitcnt lgkmcnt(4)
    v_mfma_f32_16x16x32_bf16 v[112:115], v[40:43], a[104:107], v[112:115]
    ds_read_b64_tr_b16 v[32:33], v12 offset:8192
    v_accvgpr_read_b32 v11, a243
    v_mfma_f32_16x16x32_bf16 v[116:119], v[40:43], a[108:111], v[116:119]
    ds_read_b64_tr_b16 v[34:35], v12 offset:8704
    v_accvgpr_read_b32 v16, a244
    v_mfma_f32_16x16x32_bf16 v[120:123], v[44:47], a[104:107], v[120:123]
    ds_read_b64_tr_b16 v[36:37], v13 offset:8192
    buffer_load_dwordx4 v7, s[12:15], s35 offen offset:2048 lds
    v_mfma_f32_16x16x32_bf16 v[124:127], v[44:47], a[108:111], v[124:127]
    ds_read_b64_tr_b16 v[38:39], v13 offset:8704
    s_waitcnt lgkmcnt(4)
    v_mfma_f32_16x16x32_bf16 v[128:131], v[24:27], a[104:107], v[128:131]
    ds_read_b64_tr_b16 v[40:41], v14 offset:8192
    s_add_u32 m0, s73, 27648
    v_mfma_f32_16x16x32_bf16 v[132:135], v[24:27], a[108:111], v[132:135]
    ds_read_b64_tr_b16 v[42:43], v14 offset:8704
    s_add_u32 s35, s38, 230400
    v_mfma_f32_16x16x32_bf16 v[136:139], v[28:31], a[104:107], v[136:139]
    ds_read_b64_tr_b16 v[44:45], v15 offset:8192
    s_add_u32 s34, s91, 16384
    buffer_store_dwordx4 v[64:67], v1, s[16:19], s34 offen offset:0 sc1
    v_mfma_f32_16x16x32_bf16 v[140:143], v[28:31], a[108:111], v[140:143]
    ds_read_b64_tr_b16 v[46:47], v15 offset:8704
    s_waitcnt lgkmcnt(4)
    v_mfma_f32_16x16x32_bf16 v[112:115], v[32:35], a[112:115], v[112:115]
    ds_read_b64_tr_b16 v[24:25], v12 offset:12288
    v_accvgpr_read_b32 v17, a245
    v_mfma_f32_16x16x32_bf16 v[116:119], v[32:35], a[116:119], v[116:119]
    ds_read_b64_tr_b16 v[26:27], v12 offset:12800
    v_cvt_pk_bf16_f32 v70, v92, v93
    v_mfma_f32_16x16x32_bf16 v[120:123], v[36:39], a[112:115], v[120:123]
    ds_read_b64_tr_b16 v[28:29], v13 offset:12288
    buffer_load_dwordx4 v5, s[12:15], s35 offen offset:0 lds
    v_mfma_f32_16x16x32_bf16 v[124:127], v[36:39], a[116:119], v[124:127]
    ds_read_b64_tr_b16 v[30:31], v13 offset:12800
    s_waitcnt lgkmcnt(4)
    v_mfma_f32_16x16x32_bf16 v[128:131], v[40:43], a[112:115], v[128:131]
    ds_read_b64_tr_b16 v[32:33], v14 offset:12288
    v_cvt_pk_bf16_f32 v71, v94, v95
    v_mfma_f32_16x16x32_bf16 v[132:135], v[40:43], a[116:119], v[132:135]
    ds_read_b64_tr_b16 v[34:35], v14 offset:12800
    v_pk_max_i16 v68, v68, 0
    v_mfma_f32_16x16x32_bf16 v[136:139], v[44:47], a[112:115], v[136:139]
    ds_read_b64_tr_b16 v[36:37], v15 offset:12288
    v_pk_max_i16 v69, v69, 0
    v_mfma_f32_16x16x32_bf16 v[140:143], v[44:47], a[116:119], v[140:143]
    ds_read_b64_tr_b16 v[38:39], v15 offset:12800
    s_waitcnt lgkmcnt(4)
    v_mfma_f32_16x16x32_bf16 v[112:115], v[24:27], a[120:123], v[112:115]
    ds_read_b64_tr_b16 v[40:41], v12 offset:16384
    v_pk_max_i16 v70, v70, 0
    v_mfma_f32_16x16x32_bf16 v[116:119], v[24:27], a[124:127], v[116:119]
    ds_read_b64_tr_b16 v[42:43], v12 offset:16896
    v_pk_max_i16 v71, v71, 0
    v_mfma_f32_16x16x32_bf16 v[120:123], v[28:31], a[120:123], v[120:123]
    ds_read_b64_tr_b16 v[44:45], v13 offset:16384
    buffer_load_dwordx4 v6, s[12:15], s35 offen offset:1024 lds
    v_mfma_f32_16x16x32_bf16 v[124:127], v[28:31], a[124:127], v[124:127]
    ds_read_b64_tr_b16 v[46:47], v13 offset:16896
    s_waitcnt lgkmcnt(4)
    v_mfma_f32_16x16x32_bf16 v[128:131], v[32:35], a[120:123], v[128:131]
    ds_read_b64_tr_b16 v[24:25], v14 offset:16384
    v_permlane16_swap_b32 v68, v70
    v_mfma_f32_16x16x32_bf16 v[132:135], v[32:35], a[124:127], v[132:135]
    ds_read_b64_tr_b16 v[26:27], v14 offset:16896
    v_permlane16_swap_b32 v69, v71
    v_mfma_f32_16x16x32_bf16 v[136:139], v[36:39], a[120:123], v[136:139]
    ds_read_b64_tr_b16 v[28:29], v15 offset:16384
    buffer_store_dwordx4 a[252:255], v1, s[16:19], s56 offen offset:2048 sc1
    v_mfma_f32_16x16x32_bf16 v[140:143], v[36:39], a[124:127], v[140:143]
    ds_read_b64_tr_b16 v[30:31], v15 offset:16896
    s_waitcnt lgkmcnt(4)
    v_mfma_f32_16x16x32_bf16 v[112:115], v[40:43], a[128:131], v[112:115]
    ds_read_b64_tr_b16 v[32:33], v12 offset:20480
    v_cvt_pk_bf16_f32 v72, v96, v97
    v_mfma_f32_16x16x32_bf16 v[116:119], v[40:43], a[132:135], v[116:119]
    ds_read_b64_tr_b16 v[34:35], v12 offset:20992
    v_cvt_pk_bf16_f32 v73, v98, v99
    v_mfma_f32_16x16x32_bf16 v[120:123], v[44:47], a[128:131], v[120:123]
    ds_read_b64_tr_b16 v[36:37], v13 offset:20480
    buffer_load_dwordx4 v7, s[12:15], s35 offen offset:2048 lds
    v_mfma_f32_16x16x32_bf16 v[124:127], v[44:47], a[132:135], v[124:127]
    ds_read_b64_tr_b16 v[38:39], v13 offset:20992
    s_waitcnt lgkmcnt(4)
    v_mfma_f32_16x16x32_bf16 v[128:131], v[24:27], a[128:131], v[128:131]
    ds_read_b64_tr_b16 v[40:41], v14 offset:20480
    v_cvt_pk_bf16_f32 v74, v100, v101
    v_mfma_f32_16x16x32_bf16 v[132:135], v[24:27], a[132:135], v[132:135]
    ds_read_b64_tr_b16 v[42:43], v14 offset:20992
    v_cvt_pk_bf16_f32 v75, v102, v103
    v_mfma_f32_16x16x32_bf16 v[136:139], v[28:31], a[128:131], v[136:139]
    ds_read_b64_tr_b16 v[44:45], v15 offset:20480
    v_pk_max_i16 v72, v72, 0
    v_mfma_f32_16x16x32_bf16 v[140:143], v[28:31], a[132:135], v[140:143]
    ds_read_b64_tr_b16 v[46:47], v15 offset:20992
    s_barrier
    s_waitcnt lgkmcnt(4)
    v_mfma_f32_16x16x32_bf16 v[112:115], v[32:35], a[136:139], v[112:115]
    v_add_u32 v11, 98304, v11
    ds_read_b64_tr_b16 v[24:25], v11 offset:24576
    s_add_u32 m0, s73, 98304
    v_mfma_f32_16x16x32_bf16 v[116:119], v[32:35], a[140:143], v[116:119]
    ds_read_b64_tr_b16 v[26:27], v11 offset:25088
    s_add_u32 s35, s39, 221184
    v_mfma_f32_16x16x32_bf16 v[120:123], v[36:39], a[136:139], v[120:123]
    v_add_u32 v16, 98304, v16
    ds_read_b64_tr_b16 v[28:29], v16 offset:24576
    buffer_load_dwordx4 v5, s[12:15], s35 offen offset:0 lds
    v_mfma_f32_16x16x32_bf16 v[124:127], v[36:39], a[140:143], v[124:127]
    ds_read_b64_tr_b16 v[30:31], v16 offset:25088
    s_waitcnt lgkmcnt(4)
    v_mfma_f32_16x16x32_bf16 v[128:131], v[40:43], a[136:139], v[128:131]
    v_add_u32 v17, 98304, v17
    ds_read_b64_tr_b16 v[32:33], v17 offset:24576
    v_pk_max_i16 v73, v73, 0
    v_mfma_f32_16x16x32_bf16 v[132:135], v[40:43], a[140:143], v[132:135]
    ds_read_b64_tr_b16 v[34:35], v17 offset:25088
    v_pk_max_i16 v74, v74, 0
    v_mfma_f32_16x16x32_bf16 v[136:139], v[44:47], a[136:139], v[136:139]
    ds_read_b64_tr_b16 v[36:37], v11 offset:30720
    buffer_store_dwordx4 v[68:71], v1, s[16:19], s34 offen offset:1024 sc1
    v_mfma_f32_16x16x32_bf16 v[140:143], v[44:47], a[140:143], v[140:143]
    ds_read_b64_tr_b16 v[38:39], v11 offset:31232
    s_waitcnt lgkmcnt(4)
    v_mfma_f32_32x32x16_bf16 v[144:159], v[24:27], v[224:227], 0
    ds_read_b64_tr_b16 v[40:41], v16 offset:30720
    ds_read_b64_tr_b16 v[42:43], v16 offset:31232
    v_pk_max_i16 v75, v75, 0
    v_permlane16_swap_b32 v72, v74
    s_nop 0
    v_permlane16_swap_b32 v73, v75
    v_cvt_pk_bf16_f32 v76, v104, v105
    v_mfma_f32_32x32x16_bf16 v[160:175], v[28:31], v[224:227], 0
    ds_read_b64_tr_b16 v[44:45], v17 offset:30720
    ds_read_b64_tr_b16 v[46:47], v17 offset:31232
    buffer_load_dwordx4 v6, s[12:15], s35 offen offset:1024 lds
    v_cvt_pk_bf16_f32 v77, v106, v107
    v_cvt_pk_bf16_f32 v78, v108, v109
    v_cvt_pk_bf16_f32 v79, v110, v111
    s_waitcnt lgkmcnt(4)
    v_mfma_f32_32x32x16_bf16 v[176:191], v[32:35], v[224:227], 0
    ds_read_b64_tr_b16 v[24:25], v11 offset:36864
    ds_read_b64_tr_b16 v[26:27], v11 offset:37376
    v_pk_max_i16 v76, v76, 0
    v_pk_max_i16 v77, v77, 0
    v_pk_max_i16 v78, v78, 0
    v_pk_max_i16 v79, v79, 0
    v_mfma_f32_32x32x16_bf16 v[144:159], v[36:39], v[228:231], v[144:159]
    ds_read_b64_tr_b16 v[28:29], v16 offset:36864
    ds_read_b64_tr_b16 v[30:31], v16 offset:37376
    v_permlane16_swap_b32 v76, v78
    v_permlane16_swap_b32 v77, v79
    v_cvt_pk_bf16_f32 v80, v112, v113
    v_cvt_pk_bf16_f32 v81, v114, v115
    s_waitcnt lgkmcnt(4)
    v_mfma_f32_32x32x16_bf16 v[160:175], v[40:43], v[228:231], v[160:175]
    ds_read_b64_tr_b16 v[32:33], v17 offset:36864
    ds_read_b64_tr_b16 v[34:35], v17 offset:37376
    v_cvt_pk_bf16_f32 v82, v116, v117
    v_cvt_pk_bf16_f32 v83, v118, v119
    v_pk_max_i16 v80, v80, 0
    v_pk_max_i16 v81, v81, 0
    v_mfma_f32_32x32x16_bf16 v[176:191], v[44:47], v[228:231], v[176:191]
    ds_read_b64_tr_b16 v[36:37], v11 offset:43008
    ds_read_b64_tr_b16 v[38:39], v11 offset:43520
    buffer_load_dwordx4 v7, s[12:15], s35 offen offset:2048 lds
    s_add_u32 m0, s73, 101376
    s_add_u32 s35, s39, 230400
    v_pk_max_i16 v82, v82, 0
    s_waitcnt lgkmcnt(4)
    v_mfma_f32_32x32x16_bf16 v[144:159], v[24:27], v[232:235], v[144:159]
    ds_read_b64_tr_b16 v[40:41], v16 offset:43008
    ds_read_b64_tr_b16 v[42:43], v16 offset:43520
    v_pk_max_i16 v83, v83, 0
    v_permlane16_swap_b32 v80, v82
    s_nop 0
    v_permlane16_swap_b32 v81, v83
    v_cvt_pk_bf16_f32 v84, v120, v121
    v_mfma_f32_32x32x16_bf16 v[160:175], v[28:31], v[232:235], v[160:175]
    ds_read_b64_tr_b16 v[44:45], v17 offset:43008
    ds_read_b64_tr_b16 v[46:47], v17 offset:43520
    buffer_store_dwordx4 v[72:75], v1, s[16:19], s34 offen offset:2048 sc1
    v_cvt_pk_bf16_f32 v85, v122, v123
    v_cvt_pk_bf16_f32 v86, v124, v125
    v_cvt_pk_bf16_f32 v87, v126, v127
    s_waitcnt lgkmcnt(4)
    v_mfma_f32_32x32x16_bf16 v[176:191], v[32:35], v[232:235], v[176:191]
    v_add_u32 v8, 98304, v8
    ds_read_b64_tr_b16 v[24:25], v8 offset:24576
    ds_read_b64_tr_b16 v[26:27], v8 offset:25088
    v_pk_max_i16 v84, v84, 0
    v_pk_max_i16 v85, v85, 0
    v_pk_max_i16 v86, v86, 0
    v_pk_max_i16 v87, v87, 0
    v_mfma_f32_32x32x16_bf16 v[144:159], v[36:39], v[236:239], v[144:159]
    ds_read_b64_tr_b16 v[28:29], v8 offset:30720
    ds_read_b64_tr_b16 v[30:31], v8 offset:31232
    buffer_load_dwordx4 v5, s[12:15], s35 offen offset:0 lds
    v_permlane16_swap_b32 v84, v86
    v_permlane16_swap_b32 v85, v87
    v_cvt_pk_bf16_f32 v88, v128, v129
    s_waitcnt lgkmcnt(4)
    v_mfma_f32_32x32x16_bf16 v[160:175], v[40:43], v[236:239], v[160:175]
    ds_read_b64_tr_b16 v[32:33], v8 offset:36864
    ds_read_b64_tr_b16 v[34:35], v8 offset:37376
    v_cvt_pk_bf16_f32 v89, v130, v131
    v_cvt_pk_bf16_f32 v90, v132, v133
    v_cvt_pk_bf16_f32 v91, v134, v135
    v_pk_max_i16 v88, v88, 0
    v_mfma_f32_32x32x16_bf16 v[176:191], v[44:47], v[236:239], v[176:191]
    ds_read_b64_tr_b16 v[36:37], v8 offset:43008
    ds_read_b64_tr_b16 v[38:39], v8 offset:43520
    v_pk_max_i16 v89, v89, 0
    v_pk_max_i16 v90, v90, 0
    v_pk_max_i16 v91, v91, 0
    s_nop 0
    v_permlane16_swap_b32 v88, v90
    s_waitcnt lgkmcnt(4)
    v_mfma_f32_32x32x16_bf16 v[96:111], v[24:27], v[224:227], 0
    v_add_u32 v9, 98304, v9
    ds_read_b64_tr_b16 v[40:41], v9 offset:24576
    ds_read_b64_tr_b16 v[42:43], v9 offset:25088
    v_permlane16_swap_b32 v89, v91
    v_cvt_pk_bf16_f32 v92, v136, v137
    v_cvt_pk_bf16_f32 v93, v138, v139
    v_cvt_pk_bf16_f32 v94, v140, v141
    v_mfma_f32_32x32x16_bf16 v[96:111], v[28:31], v[228:231], v[96:111]
    ds_read_b64_tr_b16 v[44:45], v9 offset:30720
    ds_read_b64_tr_b16 v[46:47], v9 offset:31232
    buffer_load_dwordx4 v6, s[12:15], s35 offen offset:1024 lds
    v_cvt_pk_bf16_f32 v95, v142, v143
    v_pk_max_i16 v92, v92, 0
    v_pk_max_i16 v93, v93, 0
    s_waitcnt lgkmcnt(4)
    v_mfma_f32_32x32x16_bf16 v[96:111], v[32:35], v[232:235], v[96:111]
    ds_read_b64_tr_b16 v[24:25], v9 offset:36864
    ds_read_b64_tr_b16 v[26:27], v9 offset:37376
    v_pk_max_i16 v94, v94, 0
    v_pk_max_i16 v95, v95, 0
    s_nop 0
    v_permlane16_swap_b32 v92, v94
    v_permlane16_swap_b32 v93, v95
    v_mfma_f32_32x32x16_bf16 v[96:111], v[36:39], v[236:239], v[96:111]
    ds_read_b64_tr_b16 v[28:29], v9 offset:43008
    ds_read_b64_tr_b16 v[30:31], v9 offset:43520
    buffer_store_dwordx4 v[76:79], v1, s[16:19], s34 offen offset:3072 sc1
    s_waitcnt lgkmcnt(4)
    v_mfma_f32_32x32x16_bf16 v[112:127], v[40:43], v[224:227], 0
    v_add_u32 v10, 98304, v10
    ds_read_b64_tr_b16 v[32:33], v10 offset:24576
    ds_read_b64_tr_b16 v[34:35], v10 offset:25088
    v_mfma_f32_32x32x16_bf16 v[112:127], v[44:47], v[228:231], v[112:127]
    ds_read_b64_tr_b16 v[36:37], v10 offset:30720
    ds_read_b64_tr_b16 v[38:39], v10 offset:31232
    buffer_load_dwordx4 v7, s[12:15], s35 offen offset:2048 lds
    s_waitcnt lgkmcnt(4)
    v_mfma_f32_32x32x16_bf16 v[112:127], v[24:27], v[232:235], v[112:127]
    ds_read_b64_tr_b16 v[40:41], v10 offset:36864
    ds_read_b64_tr_b16 v[42:43], v10 offset:37376
    v_mfma_f32_32x32x16_bf16 v[112:127], v[28:31], v[236:239], v[112:127]
    ds_read_b64_tr_b16 v[44:45], v10 offset:43008
    ds_read_b64_tr_b16 v[46:47], v10 offset:43520
    s_waitcnt vmcnt(29)
    s_barrier
    buffer_load_dwordx4 v[20:23], v240, s[16:19], s94 offen sc1
    s_waitcnt lgkmcnt(4)
    v_mfma_f32_32x32x16_bf16 v[128:143], v[32:35], v[224:227], 0
    v_subrev_u32 v8, 49152, v8
    ds_read_b64_tr_b16 v[24:25], v8 offset:24576
    ds_read_b64_tr_b16 v[26:27], v8 offset:25088
    s_add_u32 m0, s73, 49152
    s_add_u32 s35, s40, 221184
    v_mfma_f32_32x32x16_bf16 v[128:143], v[36:39], v[228:231], v[128:143]
    v_subrev_u32 v9, 49152, v9
    ds_read_b64_tr_b16 v[28:29], v9 offset:24576
    ds_read_b64_tr_b16 v[30:31], v9 offset:25088
    buffer_load_dwordx4 v5, s[12:15], s35 offen offset:0 lds
    s_waitcnt lgkmcnt(4)
    v_mfma_f32_32x32x16_bf16 v[128:143], v[40:43], v[232:235], v[128:143]
    v_subrev_u32 v10, 49152, v10
    ds_read_b64_tr_b16 v[32:33], v10 offset:24576
    ds_read_b64_tr_b16 v[34:35], v10 offset:25088
    v_mfma_f32_32x32x16_bf16 v[128:143], v[44:47], v[236:239], v[128:143]
    v_subrev_u32 v11, 49152, v11
    ds_read_b64_tr_b16 v[36:37], v11 offset:24576
    ds_read_b64_tr_b16 v[38:39], v11 offset:25088
    s_add_u32 s34, s91, 20480
    buffer_store_dwordx4 v[80:83], v1, s[16:19], s34 offen offset:0 sc1
    s_waitcnt lgkmcnt(4)
    v_mfma_f32_32x32x16_bf16 v[96:111], v[24:27], v[208:211], v[96:111]
    v_subrev_u32 v16, 49152, v16
    ds_read_b64_tr_b16 v[40:41], v16 offset:24576
    ds_read_b64_tr_b16 v[42:43], v16 offset:25088
    v_mfma_f32_32x32x16_bf16 v[112:127], v[28:31], v[208:211], v[112:127]
    v_subrev_u32 v17, 49152, v17
    ds_read_b64_tr_b16 v[44:45], v17 offset:24576
    ds_read_b64_tr_b16 v[46:47], v17 offset:25088
    buffer_load_dwordx4 v6, s[12:15], s35 offen offset:1024 lds
    s_waitcnt lgkmcnt(4)
    v_mfma_f32_32x32x16_bf16 v[128:143], v[32:35], v[208:211], v[128:143]
    ds_read_b64_tr_b16 v[24:25], v8 offset:30720
    ds_read_b64_tr_b16 v[26:27], v8 offset:31232
    v_mfma_f32_32x32x16_bf16 v[144:159], v[36:39], v[208:211], v[144:159]
    ds_read_b64_tr_b16 v[28:29], v9 offset:30720
    ds_read_b64_tr_b16 v[30:31], v9 offset:31232
    s_waitcnt lgkmcnt(4)
    v_mfma_f32_32x32x16_bf16 v[160:175], v[40:43], v[208:211], v[160:175]
    ds_read_b64_tr_b16 v[32:33], v10 offset:30720
    ds_read_b64_tr_b16 v[34:35], v10 offset:31232
    v_mfma_f32_32x32x16_bf16 v[176:191], v[44:47], v[208:211], v[176:191]
    ds_read_b64_tr_b16 v[36:37], v11 offset:30720
    ds_read_b64_tr_b16 v[38:39], v11 offset:31232
    buffer_load_dwordx4 v7, s[12:15], s35 offen offset:2048 lds
    s_add_u32 m0, s73, 52224
    s_add_u32 s35, s40, 230400
    s_waitcnt lgkmcnt(4)
    v_mfma_f32_32x32x16_bf16 v[96:111], v[24:27], v[212:215], v[96:111]
    ds_read_b64_tr_b16 v[40:41], v16 offset:30720
    ds_read_b64_tr_b16 v[42:43], v16 offset:31232
    v_mfma_f32_32x32x16_bf16 v[112:127], v[28:31], v[212:215], v[112:127]
    ds_read_b64_tr_b16 v[44:45], v17 offset:30720
    ds_read_b64_tr_b16 v[46:47], v17 offset:31232
    buffer_store_dwordx4 v[84:87], v1, s[16:19], s34 offen offset:1024 sc1
    s_waitcnt lgkmcnt(4)
    v_mfma_f32_32x32x16_bf16 v[128:143], v[32:35], v[212:215], v[128:143]
    ds_read_b64_tr_b16 v[24:25], v8 offset:36864
    ds_read_b64_tr_b16 v[26:27], v8 offset:37376
    v_mfma_f32_32x32x16_bf16 v[144:159], v[36:39], v[212:215], v[144:159]
    ds_read_b64_tr_b16 v[28:29], v9 offset:36864
    ds_read_b64_tr_b16 v[30:31], v9 offset:37376
    buffer_load_dwordx4 v5, s[12:15], s35 offen offset:0 lds
    s_waitcnt lgkmcnt(4)
    v_mfma_f32_32x32x16_bf16 v[160:175], v[40:43], v[212:215], v[160:175]
    ds_read_b64_tr_b16 v[32:33], v10 offset:36864
    ds_read_b64_tr_b16 v[34:35], v10 offset:37376
    v_mfma_f32_32x32x16_bf16 v[176:191], v[44:47], v[212:215], v[176:191]
    ds_read_b64_tr_b16 v[36:37], v11 offset:36864
    ds_read_b64_tr_b16 v[38:39], v11 offset:37376
    s_waitcnt lgkmcnt(4)
    v_mfma_f32_32x32x16_bf16 v[96:111], v[24:27], v[216:219], v[96:111]
    ds_read_b64_tr_b16 v[40:41], v16 offset:36864
    ds_read_b64_tr_b16 v[42:43], v16 offset:37376
    v_mfma_f32_32x32x16_bf16 v[112:127], v[28:31], v[216:219], v[112:127]
    ds_read_b64_tr_b16 v[44:45], v17 offset:36864
    ds_read_b64_tr_b16 v[46:47], v17 offset:37376
    buffer_load_dwordx4 v6, s[12:15], s35 offen offset:1024 lds
    s_waitcnt lgkmcnt(4)
    v_mfma_f32_32x32x16_bf16 v[128:143], v[32:35], v[216:219], v[128:143]
    ds_read_b64_tr_b16 v[24:25], v8 offset:43008
    ds_read_b64_tr_b16 v[26:27], v8 offset:43520
    v_mfma_f32_32x32x16_bf16 v[144:159], v[36:39], v[216:219], v[144:159]
    ds_read_b64_tr_b16 v[28:29], v9 offset:43008
    ds_read_b64_tr_b16 v[30:31], v9 offset:43520
    buffer_store_dwordx4 v[88:91], v1, s[16:19], s34 offen offset:2048 sc1
    s_waitcnt lgkmcnt(4)
    v_mfma_f32_32x32x16_bf16 v[160:175], v[40:43], v[216:219], v[160:175]
    ds_read_b64_tr_b16 v[32:33], v10 offset:43008
    ds_read_b64_tr_b16 v[34:35], v10 offset:43520
    v_mfma_f32_32x32x16_bf16 v[176:191], v[44:47], v[216:219], v[176:191]
    ds_read_b64_tr_b16 v[36:37], v11 offset:43008
    ds_read_b64_tr_b16 v[38:39], v11 offset:43520
    buffer_load_dwordx4 v7, s[12:15], s35 offen offset:2048 lds
    s_waitcnt lgkmcnt(4)
    v_mfma_f32_32x32x16_bf16 v[96:111], v[24:27], v[220:223], v[96:111]
    ds_read_b64_tr_b16 v[40:41], v16 offset:43008
    ds_read_b64_tr_b16 v[42:43], v16 offset:43520
    v_mfma_f32_32x32x16_bf16 v[112:127], v[28:31], v[220:223], v[112:127]
    ds_read_b64_tr_b16 v[44:45], v17 offset:43008
    ds_read_b64_tr_b16 v[46:47], v17 offset:43520
    s_waitcnt vmcnt(30)
    s_waitcnt vmcnt(9)
    v_min_u32 v20, v20, v21
    v_min_u32 v20, v20, v22
    v_cmp_gt_u32 vcc, 1, v20
    s_cbranch_vccnz L_slow_8
L_ok_6:
    s_barrier
    s_waitcnt lgkmcnt(4)
    v_mfma_f32_32x32x16_bf16 v[128:143], v[32:35], v[220:223], v[128:143]
    v_subrev_u32 v8, 49152, v8
    ds_read_b64_tr_b16 v[24:25], v8 offset:0
    ds_read_b64_tr_b16 v[26:27], v8 offset:512
    s_add_u32 m0, s73, 122880
    s_add_u32 s35, s41, 0
    v_mfma_f32_32x32x16_bf16 v[144:159], v[36:39], v[220:223], v[144:159]
    v_subrev_u32 v9, 49152, v9
    ds_read_b64_tr_b16 v[28:29], v9 offset:0
    ds_read_b64_tr_b16 v[30:31], v9 offset:512
    buffer_load_dwordx4 v5, s[12:15], s35 offen offset:0 lds
    s_waitcnt lgkmcnt(4)
    v_mfma_f32_32x32x16_bf16 v[160:175], v[40:43], v[220:223], v[160:175]
    v_subrev_u32 v10, 49152, v10
    ds_read_b64_tr_b16 v[32:33], v10 offset:0
    ds_read_b64_tr_b16 v[34:35], v10 offset:512
    v_mfma_f32_32x32x16_bf16 v[176:191], v[44:47], v[220:223], v[176:191]
    v_subrev_u32 v11, 49152, v11
    ds_read_b64_tr_b16 v[36:37], v11 offset:0
    ds_read_b64_tr_b16 v[38:39], v11 offset:512
    buffer_store_dwordx4 v[92:95], v1, s[16:19], s34 offen offset:3072 sc1
    s_waitcnt lgkmcnt(4)
    v_mfma_f32_32x32x16_bf16 v[96:111], v[24:27], v[192:195], v[96:111]
    v_subrev_u32 v16, 49152, v16
    ds_read_b64_tr_b16 v[40:41], v16 offset:0
    ds_read_b64_tr_b16 v[42:43], v16 offset:512
    v_mfma_f32_32x32x16_bf16 v[112:127], v[28:31], v[192:195], v[112:127]
    v_subrev_u32 v17, 49152, v17
    ds_read_b64_tr_b16 v[44:45], v17 offset:0
    ds_read_b64_tr_b16 v[46:47], v17 offset:512
    buffer_load_dwordx4 v6, s[12:15], s35 offen offset:1024 lds
L_pg5:
    s_cbranch_execz L_pgret
    s_waitcnt lgkmcnt(4)
    v_mfma_f32_32x32x16_bf16 v[128:143], v[32:35], v[192:195], v[128:143]
    ds_read_b64_tr_b16 v[24:25], v8 offset:6144
    ds_read_b64_tr_b16 v[26:27], v8 offset:6656
    v_mfma_f32_32x32x16_bf16 v[144:159], v[36:39], v[192:195], v[144:159]
    ds_read_b64_tr_b16 v[28:29], v9 offset:6144
    ds_read_b64_tr_b16 v[30:31], v9 offset:6656
    s_waitcnt lgkmcnt(4)
    v_mfma_f32_32x32x16_bf16 v[160:175], v[40:43], v[192:195], v[160:175]
    ds_read_b64_tr_b16 v[32:33], v10 offset:6144
    ds_read_b64_tr_b16 v[34:35], v10 offset:6656
    v_mfma_f32_32x32x16_bf16 v[176:191], v[44:47], v[192:195], v[176:191]
    ds_read_b64_tr_b16 v[36:37], v11 offset:6144
    ds_read_b64_tr_b16 v[38:39], v11 offset:6656
    buffer_load_dwordx4 v7, s[12:15], s35 offen offset:2048 lds
    s_add_u32 m0, s73, 125952
    s_add_u32 s35, s41, 9216
    s_waitcnt lgkmcnt(4)
    v_mfma_f32_32x32x16_bf16 v[96:111], v[24:27], v[196:199], v[96:111]
    ds_read_b64_tr_b16 v[40:41], v16 offset:6144
    ds_read_b64_tr_b16 v[42:43], v16 offset:6656
    v_mfma_f32_32x32x16_bf16 v[112:127], v[28:31], v[196:199], v[112:127]
    ds_read_b64_tr_b16 v[44:45], v17 offset:6144
    ds_read_b64_tr_b16 v[46:47], v17 offset:6656
    buffer_store_dwordx4 a[252:255], v1, s[16:19], s57 offen offset:0 sc1
    s_waitcnt lgkmcnt(4)
    v_mfma_f32_32x32x16_bf16 v[128:143], v[32:35], v[196:199], v[128:143]
    ds_read_b64_tr_b16 v[24:25], v8 offset:12288
    ds_read_b64_tr_b16 v[26:27], v8 offset:12800
    v_mfma_f32_32x32x16_bf16 v[144:159], v[36:39], v[196:199], v[144:159]
    ds_read_b64_tr_b16 v[28:29], v9 offset:12288
    ds_read_b64_tr_b16 v[30:31], v9 offset:12800
    buffer_load_dwordx4 v5, s[12:15], s35 offen offset:0 lds
    s_waitcnt lgkmcnt(4)
    v_mfma_f32_32x32x16_bf16 v[160:175], v[40:43], v[196:199], v[160:175]
    ds_read_b64_tr_b16 v[32:33], v10 offset:12288
    ds_read_b64_tr_b16 v[34:35], v10 offset:12800
    v_mfma_f32_32x32x16_bf16 v[176:191], v[44:47], v[196:199], v[176:191]
    ds_read_b64_tr_b16 v[36:37], v11 offset:12288
    ds_read_b64_tr_b16 v[38:39], v11 offset:12800
    s_waitcnt lgkmcnt(4)
    v_mfma_f32_32x32x16_bf16 v[96:111], v[24:27], v[200:203], v[96:111]
    ds_read_b64_tr_b16 v[40:41], v16 offset:12288
    ds_read_b64_tr_b16 v[42:43], v16 offset:12800
    v_mfma_f32_32x32x16_bf16 v[112:127], v[28:31], v[200:203], v[112:127]
    ds_read_b64_tr_b16 v[44:45], v17 offset:12288
    ds_read_b64_tr_b16 v[46:47], v17 offset:12800
    buffer_load_dwordx4 v6, s[12:15], s35 offen offset:1024 lds
    s_waitcnt lgkmcnt(4)
    v_mfma_f32_32x32x16_bf16 v[128:143], v[32:35], v[200:203], v[128:143]
    ds_read_b64_tr_b16 v[24:25], v8 offset:18432
    ds_read_b64_tr_b16 v[26:27], v8 offset:18944
    v_mfma_f32_32x32x16_bf16 v[144:159], v[36:39], v[200:203], v[144:159]
    ds_read_b64_tr_b16 v[28:29], v9 offset:18432
    ds_read_b64_tr_b16 v[30:31], v9 offset:18944
    buffer_store_dwordx4 a[252:255], v1, s[16:19], s57 offen offset:1024 sc1
    s_waitcnt lgkmcnt(4)
    v_mfma_f32_32x32x16_bf16 v[160:175], v[40:43], v[200:203], v[160:175]
    ds_read_b64_tr_b16 v[32:33], v10 offset:18432
    ds_read_b64_tr_b16 v[34:35], v10 offset:18944
    v_mfma_f32_32x32x16_bf16 v[176:191], v[44:47], v[200:203], v[176:191]
    ds_read_b64_tr_b16 v[36:37], v11 offset:18432
    ds_read_b64_tr_b16 v[38:39], v11 offset:18944
    buffer_load_dwordx4 v7, s[12:15], s35 offen offset:2048 lds
    s_waitcnt lgkmcnt(4)
    v_mfma_f32_32x32x16_bf16 v[96:111], v[24:27], v[204:207], v[96:111]
    ds_read_b64_tr_b16 v[40:41], v16 offset:18432
    ds_read_b64_tr_b16 v[42:43], v16 offset:18944
    v_mfma_f32_32x32x16_bf16 v[112:127], v[28:31], v[204:207], v[112:127]
    ds_read_b64_tr_b16 v[44:45], v17 offset:18432
    ds_read_b64_tr_b16 v[46:47], v17 offset:18944
    s_barrier
    s_waitcnt lgkmcnt(4)
    v_mfma_f32_32x32x16_bf16 v[128:143], v[32:35], v[204:207], v[128:143]
    ds_read_b64_tr_b16 v[24:25], v8 offset:24576
    ds_read_b64_tr_b16 v[26:27], v8 offset:25088
    s_add_u32 m0, s73, 73728
    s_add_u32 s35, s42, 0
    v_mfma_f32_32x32x16_bf16 v[144:159], v[36:39], v[204:207], v[144:159]
    ds_read_b64_tr_b16 v[28:29], v9 offset:24576
    ds_read_b64_tr_b16 v[30:31], v9 offset:25088
    buffer_load_dwordx4 v5, s[12:15], s35 offen offset:0 lds
    s_waitcnt lgkmcnt(4)
    v_mfma_f32_32x32x16_bf16 v[160:175], v[40:43], v[204:207], v[160:175]
    ds_read_b64_tr_b16 v[32:33], v10 offset:24576
    ds_read_b64_tr_b16 v[34:35], v10 offset:25088
    v_mfma_f32_32x32x16_bf16 v[176:191], v[44:47], v[204:207], v[176:191]
    ds_read_b64_tr_b16 v[36:37], v11 offset:24576
    ds_read_b64_tr_b16 v[38:39], v11 offset:25088
    buffer_store_dwordx4 a[252:255], v1, s[16:19], s57 offen offset:2048 sc1
    s_waitcnt lgkmcnt(4)
    v_mfma_f32_32x32x16_bf16 v[96:111], v[24:27], v[48:51], v[96:111]
    ds_read_b64_tr_b16 v[40:41], v16 offset:24576
    ds_read_b64_tr_b16 v[42:43], v16 offset:25088
    v_mfma_f32_32x32x16_bf16 v[112:127], v[28:31], v[48:51], v[112:127]
    ds_read_b64_tr_b16 v[44:45], v17 offset:24576
    ds_read_b64_tr_b16 v[46:47], v17 offset:25088
    buffer_load_dwordx4 v6, s[12:15], s35 offen offset:1024 lds
    s_waitcnt lgkmcnt(4)
    v_mfma_f32_32x32x16_bf16 v[128:143], v[32:35], v[48:51], v[128:143]
    ds_read_b64_tr_b16 v[24:25], v8 offset:30720
    ds_read_b64_tr_b16 v[26:27], v8 offset:31232
    v_mfma_f32_32x32x16_bf16 v[144:159], v[36:39], v[48:51], v[144:159]
    ds_read_b64_tr_b16 v[28:29], v9 offset:30720
    ds_read_b64_tr_b16 v[30:31], v9 offset:31232
    s_add_u32 s33, s92, 0
    buffer_load_dwordx4 a[144:147], v1, s[16:19], s33 offen offset:0 sc1
    s_waitcnt lgkmcnt(4)
    v_mfma_f32_32x32x16_bf16 v[160:175], v[40:43], v[48:51], v[160:175]
    ds_read_b64_tr_b16 v[32:33], v10 offset:30720
    ds_read_b64_tr_b16 v[34:35], v10 offset:31232
    v_mfma_f32_32x32x16_bf16 v[176:191], v[44:47], v[48:51], v[176:191]
    ds_read_b64_tr_b16 v[36:37], v11 offset:30720
    ds_read_b64_tr_b16 v[38:39], v11 offset:31232
    buffer_load_dwordx4 v7, s[12:15], s35 offen offset:2048 lds
    s_add_u32 m0, s73, 76800
    s_add_u32 s35, s42, 9216
    s_waitcnt lgkmcnt(4)
    v_mfma_f32_32x32x16_bf16 v[96:111], v[24:27], v[52:55], v[96:111]
    ds_read_b64_tr_b16 v[40:41], v16 offset:30720
    ds_read_b64_tr_b16 v[42:43], v16 offset:31232
    v_mfma_f32_32x32x16_bf16 v[112:127], v[28:31], v[52:55], v[112:127]
    ds_read_b64_tr_b16 v[44:45], v17 offset:30720
    ds_read_b64_tr_b16 v[46:47], v17 offset:31232
    buffer_load_dwordx4 a[148:151], v1, s[16:19], s33 offen offset:1024 sc1
    s_waitcnt lgkmcnt(4)
    v_mfma_f32_32x32x16_bf16 v[128:143], v[32:35], v[52:55], v[128:143]
    ds_read_b64_tr_b16 v[24:25], v8 offset:36864
    ds_read_b64_tr_b16 v[26:27], v8 offset:37376
    v_mfma_f32_32x32x16_bf16 v[144:159], v[36:39], v[52:55], v[144:159]
    ds_read_b64_tr_b16 v[28:29], v9 offset:36864
    ds_read_b64_tr_b16 v[30:31], v9 offset:37376
    buffer_load_dwordx4 v5, s[12:15], s35 offen offset:0 lds
    s_waitcnt lgkmcnt(4)
    v_mfma_f32_32x32x16_bf16 v[160:175], v[40:43], v[52:55], v[160:175]
    ds_read_b64_tr_b16 v[32:33], v10 offset:36864
    ds_read_b64_tr_b16 v[34:35], v10 offset:37376
    v_mfma_f32_32x32x16_bf16 v[176:191], v[44:47], v[52:55], v[176:191]
    ds_read_b64_tr_b16 v[36:37], v11 offset:36864
    ds_read_b64_tr_b16 v[38:39], v11 offset:37376
    buffer_load_dwordx4 a[152:155], v1, s[16:19], s33 offen offset:2048 sc1
    s_waitcnt lgkmcnt(4)
    v_mfma_f32_32x32x16_bf16 v[96:111], v[24:27], v[56:59], v[96:111]
    ds_read_b64_tr_b16 v[40:41], v16 offset:36864
    ds_read_b64_tr_b16 v[42:43], v16 offset:37376
    v_mfma_f32_32x32x16_bf16 v[112:127], v[28:31], v[56:59], v[112:127]
    ds_read_b64_tr_b16 v[44:45], v17 offset:36864
    ds_read_b64_tr_b16 v[46:47], v17 offset:37376
    buffer_load_dwordx4 v6, s[12:15], s35 offen offset:1024 lds
    s_waitcnt lgkmcnt(4)
    v_mfma_f32_32x32x16_bf16 v[128:143], v[32:35], v[56:59], v[128:143]
    ds_read_b64_tr_b16 v[24:25], v8 offset:43008
    ds_read_b64_tr_b16 v[26:27], v8 offset:43520
    v_mfma_f32_32x32x16_bf16 v[144:159], v[36:39], v[56:59], v[144:159]
    ds_read_b64_tr_b16 v[28:29], v9 offset:43008
    ds_read_b64_tr_b16 v[30:31], v9 offset:43520
    buffer_load_dwordx4 a[156:159], v1, s[16:19], s33 offen offset:3072 sc1
    s_waitcnt lgkmcnt(4)
    v_mfma_f32_32x32x16_bf16 v[160:175], v[40:43], v[56:59], v[160:175]
    ds_read_b64_tr_b16 v[32:33], v10 offset:43008
    ds_read_b64_tr_b16 v[34:35], v10 offset:43520
    v_mfma_f32_32x32x16_bf16 v[176:191], v[44:47], v[56:59], v[176:191]
    ds_read_b64_tr_b16 v[36:37], v11 offset:43008
    ds_read_b64_tr_b16 v[38:39], v11 offset:43520
    buffer_load_dwordx4 v7, s[12:15], s35 offen offset:2048 lds
    s_waitcnt lgkmcnt(4)
    v_mfma_f32_32x32x16_bf16 v[96:111], v[24:27], v[60:63], v[96:111]
    ds_read_b64_tr_b16 v[40:41], v16 offset:43008
    ds_read_b64_tr_b16 v[42:43], v16 offset:43520
    v_mfma_f32_32x32x16_bf16 v[112:127], v[28:31], v[60:63], v[112:127]
    ds_read_b64_tr_b16 v[44:45], v17 offset:43008
    ds_read_b64_tr_b16 v[46:47], v17 offset:43520
    s_add_u32 s33, s92, 4096
    buffer_load_dwordx4 a[160:163], v1, s[16:19], s33 offen offset:0 sc1
    s_waitcnt vmcnt(19)
    v_mov_b32 v243, 2
    buffer_store_dword v243, v240, s[16:19], s95 offen sc1
    s_barrier
    s_waitcnt vmcnt(11)
    buffer_store_dword v243, v241, s[16:19], 0 offen sc1
    s_waitcnt lgkmcnt(4)
    v_mfma_f32_32x32x16_bf16 v[128:143], v[32:35], v[60:63], v[128:143]
    v_add_u32 v8, 98304, v8
    ds_read_b64_tr_b16 v[24:25], v8 offset:0
    ds_read_b64_tr_b16 v[26:27], v8 offset:512
    buffer_load_dwordx4 a[164:167], v1, s[16:19], s33 offen offset:1024 sc1
    s_add_u32 m0, s73, 0
    s_add_u32 s35, s43, 0
    v_mfma_f32_32x32x16_bf16 v[144:159], v[36:39], v[60:63], v[144:159]
    v_add_u32 v9, 98304, v9
    ds_read_b64_tr_b16 v[28:29], v9 offset:0
    ds_read_b64_tr_b16 v[30:31], v9 offset:512
    v_lshrrev_b32 v2, 4, v0
    v_lshlrev_b32 v4, 2, v2
    v_xor_b32 v4, v4, v0
    s_waitcnt lgkmcnt(4)
    v_mfma_f32_32x32x16_bf16 v[160:175], v[40:43], v[60:63], v[160:175]
    v_add_u32 v10, 98304, v10
    ds_read_b64_tr_b16 v[32:33], v10 offset:0
    ds_read_b64_tr_b16 v[34:35], v10 offset:512
    buffer_load_dwordx4 v5, s[12:15], s35 offen offset:0 lds
    v_lshlrev_b32 v2, 12, v2
    v_and_b32 v3, 1, v4
    v_mfma_f32_32x32x16_bf16 v[176:191], v[44:47], v[60:63], v[176:191]
    v_add_u32 v11, 98304, v11
    ds_read_b64_tr_b16 v[36:37], v11 offset:0
    ds_read_b64_tr_b16 v[38:39], v11 offset:512
    v_lshl_add_u32 v2, v3, 9, v2
    v_bfe_u32 v4, v4, 1, 3
    v_lshl_add_u32 v2, v4, 4, v2
    s_waitcnt lgkmcnt(4)
    v_mfma_f32_32x32x16_bf16 v[96:111], v[24:27], v[64:67], v[96:111]
    v_add_u32 v16, 98304, v16
    ds_read_b64_tr_b16 v[40:41], v16 offset:0
    ds_read_b64_tr_b16 v[42:43], v16 offset:512
    buffer_load_dwordx4 a[168:171], v1, s[16:19], s33 offen offset:2048 sc1
    v_bfe_u32 v4, v0, 2, 2
    v_xor_b32 v3, s3, v4
    v_mfma_f32_32x32x16_bf16 v[112:127], v[28:31], v[64:67], v[112:127]
    v_add_u32 v17, 98304, v17
    ds_read_b64_tr_b16 v[44:45], v17 offset:0
    ds_read_b64_tr_b16 v[46:47], v17 offset:512
    v_lshlrev_b32 v3, 6, v3
    v_lshl_add_u32 v3, v4, 8, v3
    v_lshrrev_b32 v4, 5, v0
    s_waitcnt lgkmcnt(4)
    v_mfma_f32_32x32x16_bf16 v[128:143], v[32:35], v[64:67], v[128:143]
    ds_read_b64_tr_b16 v[24:25], v8 offset:6144
    ds_read_b64_tr_b16 v[26:27], v8 offset:6656
    buffer_load_dwordx4 v6, s[12:15], s35 offen offset:1024 lds
    v_lshl_add_u32 v3, v4, 10, v3
    v_bfe_u32 v4, v0, 4, 1
    v_mfma_f32_32x32x16_bf16 v[144:159], v[36:39], v[64:67], v[144:159]
    ds_read_b64_tr_b16 v[28:29], v9 offset:6144
    ds_read_b64_tr_b16 v[30:31], v9 offset:6656
    v_lshl_add_u32 v3, v4, 5, v3
    v_and_b32 v4, 3, v0
    v_lshl_add_u32 v3, v4, 3, v3
    s_waitcnt lgkmcnt(4)
    v_mfma_f32_32x32x16_bf16 v[160:175], v[40:43], v[64:67], v[160:175]
    ds_read_b64_tr_b16 v[32:33], v10 offset:6144
    ds_read_b64_tr_b16 v[34:35], v10 offset:6656
    buffer_load_dwordx4 a[172:175], v1, s[16:19], s33 offen offset:3072 sc1
    v_add_u32 v3, 147456, v3
    v_mfma_f32_32x32x16_bf16 v[176:191], v[44:47], v[64:67], v[176:191]
    ds_read_b64_tr_b16 v[36:37], v11 offset:6144
    ds_read_b64_tr_b16 v[38:39], v11 offset:6656
    s_waitcnt lgkmcnt(4)
    v_mfma_f32_32x32x16_bf16 v[96:111], v[24:27], v[68:71], v[96:111]
    ds_read_b64_tr_b16 v[40:41], v16 offset:6144
    ds_read_b64_tr_b16 v[42:43], v16 offset:6656
    buffer_load_dwordx4 v7, s[12:15], s35 offen offset:2048 lds
    s_add_u32 m0, s73, 3072
    s_add_u32 s35, s43, 9216
    v_mfma_f32_32x32x16_bf16 v[112:127], v[28:31], v[68:71], v[112:127]
    ds_read_b64_tr_b16 v[44:45], v17 offset:6144
    ds_read_b64_tr_b16 v[46:47], v17 offset:6656
    s_waitcnt lgkmcnt(4)
    v_mfma_f32_32x32x16_bf16 v[128:143], v[32:35], v[68:71], v[128:143]
    ds_read_b64_tr_b16 v[24:25], v8 offset:12288
    ds_read_b64_tr_b16 v[26:27], v8 offset:12800
    s_add_u32 s33, s92, 8192
    buffer_load_dwordx4 a[176:179], v1, s[16:19], s33 offen offset:0 sc1
    v_mfma_f32_32x32x16_bf16 v[144:159], v[36:39], v[68:71], v[144:159]
    ds_read_b64_tr_b16 v[28:29], v9 offset:12288
    ds_read_b64_tr_b16 v[30:31], v9 offset:12800
    s_waitcnt lgkmcnt(4)
    v_mfma_f32_32x32x16_bf16 v[160:175], v[40:43], v[68:71], v[160:175]
    ds_read_b64_tr_b16 v[32:33], v10 offset:12288
    ds_read_b64_tr_b16 v[34:35], v10 offset:12800
    buffer_load_dwordx4 v5, s[12:15], s35 offen offset:0 lds
    v_mfma_f32_32x32x16_bf16 v[176:191], v[44:47], v[68:71], v[176:191]
    ds_read_b64_tr_b16 v[36:37], v11 offset:12288
    ds_read_b64_tr_b16 v[38:39], v11 offset:12800
    s_waitcnt lgkmcnt(4)
    v_mfma_f32_32x32x16_bf16 v[96:111], v[24:27], v[72:75], v[96:111]
    ds_read_b64_tr_b16 v[40:41], v16 offset:12288
    ds_read_b64_tr_b16 v[42:43], v16 offset:12800
    buffer_load_dwordx4 a[180:183], v1, s[16:19], s33 offen offset:1024 sc1
    v_mfma_f32_32x32x16_bf16 v[112:127], v[28:31], v[72:75], v[112:127]
    ds_read_b64_tr_b16 v[44:45], v17 offset:12288
    ds_read_b64_tr_b16 v[46:47], v17 offset:12800
    s_waitcnt lgkmcnt(4)
    v_mfma_f32_32x32x16_bf16 v[128:143], v[32:35], v[72:75], v[128:143]
    ds_read_b64_tr_b16 v[24:25], v8 offset:18432
    ds_read_b64_tr_b16 v[26:27], v8 offset:18944
    buffer_load_dwordx4 v6, s[12:15], s35 offen offset:1024 lds
    v_mfma_f32_32x32x16_bf16 v[144:159], v[36:39], v[72:75], v[144:159]
    ds_read_b64_tr_b16 v[28:29], v9 offset:18432
    ds_read_b64_tr_b16 v[30:31], v9 offset:18944
    s_waitcnt lgkmcnt(4)
    v_mfma_f32_32x32x16_bf16 v[160:175], v[40:43], v[72:75], v[160:175]
    ds_read_b64_tr_b16 v[32:33], v10 offset:18432
    ds_read_b64_tr_b16 v[34:35], v10 offset:18944
    buffer_load_dwordx4 a[184:187], v1, s[16:19], s33 offen offset:2048 sc1
    v_mfma_f32_32x32x16_bf16 v[176:191], v[44:47], v[72:75], v[176:191]
    ds_read_b64_tr_b16 v[36:37], v11 offset:18432
    ds_read_b64_tr_b16 v[38:39], v11 offset:18944
    s_waitcnt lgkmcnt(4)
    v_mfma_f32_32x32x16_bf16 v[96:111], v[24:27], v[76:79], v[96:111]
    ds_read_b64_tr_b16 v[40:41], v16 offset:18432
    ds_read_b64_tr_b16 v[42:43], v16 offset:18944
    buffer_load_dwordx4 v7, s[12:15], s35 offen offset:2048 lds
    v_mfma_f32_32x32x16_bf16 v[112:127], v[28:31], v[76:79], v[112:127]
    ds_read_b64_tr_b16 v[44:45], v17 offset:18432
    ds_read_b64_tr_b16 v[46:47], v17 offset:18944
    s_barrier
    s_waitcnt lgkmcnt(4)
    v_mfma_f32_32x32x16_bf16 v[128:143], v[32:35], v[76:79], v[128:143]
    v_subrev_u32 v8, 49152, v8
    ds_read_b64_tr_b16 v[24:25], v8 offset:0
    ds_read_b64_tr_b16 v[26:27], v8 offset:512
    buffer_load_dwordx4 a[188:191], v1, s[16:19], s33 offen offset:3072 sc1
    s_add_u32 m0, s73, 24576
    s_add_u32 s35, s44, 0
    v_mfma_f32_32x32x16_bf16 v[144:159], v[36:39], v[76:79], v[144:159]
    v_subrev_u32 v9, 49152, v9
    ds_read_b64_tr_b16 v[28:29], v9 offset:0
    ds_read_b64_tr_b16 v[30:31], v9 offset:512
    s_waitcnt lgkmcnt(4)
    v_mfma_f32_32x32x16_bf16 v[160:175], v[40:43], v[76:79], v[160:175]
    v_subrev_u32 v10, 49152, v10
    ds_read_b64_tr_b16 v[32:33], v10 offset:0
    ds_read_b64_tr_b16 v[34:35], v10 offset:512
    buffer_load_dwordx4 v5, s[12:15], s35 offen offset:0 lds
    v_mfma_f32_32x32x16_bf16 v[176:191], v[44:47], v[76:79], v[176:191]
    v_subrev_u32 v11, 49152, v11
    ds_read_b64_tr_b16 v[36:37], v11 offset:0
    ds_read_b64_tr_b16 v[38:39], v11 offset:512
    s_waitcnt lgkmcnt(4)
    v_mfma_f32_32x32x16_bf16 v[96:111], v[24:27], v[80:83], v[96:111]
    v_subrev_u32 v16, 49152, v16
    ds_read_b64_tr_b16 v[40:41], v16 offset:0
    ds_read_b64_tr_b16 v[42:43], v16 offset:512
    s_add_u32 s33, s93, 0
    buffer_load_dwordx4 a[192:195], v1, s[16:19], s33 offen offset:0 sc1
    v_mfma_f32_32x32x16_bf16 v[112:127], v[28:31], v[80:83], v[112:127]
    v_subrev_u32 v17, 49152, v17
    ds_read_b64_tr_b16 v[44:45], v17 offset:0
    ds_read_b64_tr_b16 v[46:47], v17 offset:512
    s_waitcnt lgkmcnt(4)
    v_mfma_f32_32x32x16_bf16 v[128:143], v[32:35], v[80:83], v[128:143]
    ds_read_b64_tr_b16 v[24:25], v8 offset:6144
    ds_read_b64_tr_b16 v[26:27], v8 offset:6656
    buffer_load_dwordx4 v6, s[12:15], s35 offen offset:1024 lds
    v_mfma_f32_32x32x16_bf16 v[144:159], v[36:39], v[80:83], v[144:159]
    ds_read_b64_tr_b16 v[28:29], v9 offset:6144
    ds_read_b64_tr_b16 v[30:31], v9 offset:6656
    buffer_load_dwordx4 a[196:199], v1, s[16:19], s33 offen offset:1024 sc1
    s_waitcnt lgkmcnt(4)
    v_mfma_f32_32x32x16_bf16 v[160:175], v[40:43], v[80:83], v[160:175]
    ds_read_b64_tr_b16 v[32:33], v10 offset:6144
    ds_read_b64_tr_b16 v[34:35], v10 offset:6656
    v_mfma_f32_32x32x16_bf16 v[176:191], v[44:47], v[80:83], v[176:191]
    ds_read_b64_tr_b16 v[36:37], v11 offset:6144
    ds_read_b64_tr_b16 v[38:39], v11 offset:6656
    buffer_load_dwordx4 v7, s[12:15], s35 offen offset:2048 lds
    s_add_u32 m0, s73, 27648
    s_add_u32 s35, s44, 9216
    s_waitcnt lgkmcnt(4)
    v_mfma_f32_32x32x16_bf16 v[96:111], v[24:27], v[84:87], v[96:111]
    ds_read_b64_tr_b16 v[40:41], v16 offset:6144
    ds_read_b64_tr_b16 v[42:43], v16 offset:6656
    v_mfma_f32_32x32x16_bf16 v[112:127], v[28:31], v[84:87], v[112:127]
    ds_read_b64_tr_b16 v[44:45], v17 offset:6144
    ds_read_b64_tr_b16 v[46:47], v17 offset:6656
    buffer_load_dwordx4 a[200:203], v1, s[16:19], s33 offen offset:2048 sc1
    s_waitcnt lgkmcnt(4)
    v_mfma_f32_32x32x16_bf16 v[128:143], v[32:35], v[84:87], v[128:143]
    ds_read_b64_tr_b16 v[24:25], v8 offset:12288
    ds_read_b64_tr_b16 v[26:27], v8 offset:12800
    v_mfma_f32_32x32x16_bf16 v[144:159], v[36:39], v[84:87], v[144:159]
    ds_read_b64_tr_b16 v[28:29], v9 offset:12288
    ds_read_b64_tr_b16 v[30:31], v9 offset:12800
    buffer_load_dwordx4 v5, s[12:15], s35 offen offset:0 lds
    s_waitcnt lgkmcnt(4)
    v_mfma_f32_32x32x16_bf16 v[160:175], v[40:43], v[84:87], v[160:175]
    ds_read_b64_tr_b16 v[32:33], v10 offset:12288
    ds_read_b64_tr_b16 v[34:35], v10 offset:12800
    v_mfma_f32_32x32x16_bf16 v[176:191], v[44:47], v[84:87], v[176:191]
    ds_read_b64_tr_b16 v[36:37], v11 offset:12288
    ds_read_b64_tr_b16 v[38:39], v11 offset:12800
    buffer_load_dwordx4 a[204:207], v1, s[16:19], s33 offen offset:3072 sc1
    s_waitcnt lgkmcnt(4)
    v_mfma_f32_32x32x16_bf16 v[96:111], v[24:27], v[88:91], v[96:111]
    ds_read_b64_tr_b16 v[40:41], v16 offset:12288
    ds_read_b64_tr_b16 v[42:43], v16 offset:12800
    v_mfma_f32_32x32x16_bf16 v[112:127], v[28:31], v[88:91], v[112:127]
    ds_read_b64_tr_b16 v[44:45], v17 offset:12288
    ds_read_b64_tr_b16 v[46:47], v17 offset:12800
    buffer_load_dwordx4 v6, s[12:15], s35 offen offset:1024 lds
    s_waitcnt lgkmcnt(4)
    v_mfma_f32_32x32x16_bf16 v[128:143], v[32:35], v[88:91], v[128:143]
    ds_read_b64_tr_b16 v[24:25], v8 offset:18432
    ds_read_b64_tr_b16 v[26:27], v8 offset:18944
    v_mfma_f32_32x32x16_bf16 v[144:159], v[36:39], v[88:91], v[144:159]
    ds_read_b64_tr_b16 v[28:29], v9 offset:18432
    ds_read_b64_tr_b16 v[30:31], v9 offset:18944
    s_add_u32 s33, s93, 4096
    buffer_load_dwordx4 a[208:211], v1, s[16:19], s33 offen offset:0 sc1
    s_waitcnt lgkmcnt(4)
    v_mfma_f32_32x32x16_bf16 v[160:175], v[40:43], v[88:91], v[160:175]
    ds_read_b64_tr_b16 v[32:33], v10 offset:18432
    ds_read_b64_tr_b16 v[34:35], v10 offset:18944
    v_mfma_f32_32x32x16_bf16 v[176:191], v[44:47], v[88:91], v[176:191]
    ds_read_b64_tr_b16 v[36:37], v11 offset:18432
    ds_read_b64_tr_b16 v[38:39], v11 offset:18944
    buffer_load_dwordx4 v7, s[12:15], s35 offen offset:2048 lds
    s_waitcnt lgkmcnt(4)
    v_mfma_f32_32x32x16_bf16 v[96:111], v[24:27], v[92:95], v[96:111]
    ds_read_b64_tr_b16 v[40:41], v16 offset:18432
    ds_read_b64_tr_b16 v[42:43], v16 offset:18944
    v_mfma_f32_32x32x16_bf16 v[112:127], v[28:31], v[92:95], v[112:127]
    ds_read_b64_tr_b16 v[44:45], v17 offset:18432
    ds_read_b64_tr_b16 v[46:47], v17 offset:18944
    buffer_load_dwordx4 a[212:215], v1, s[16:19], s33 offen offset:1024 sc1
    s_waitcnt vmcnt(29)
    s_barrier
    buffer_load_dwordx4 v[20:23], v240, s[16:19], s94 offen sc1
    s_waitcnt lgkmcnt(4)
    v_mfma_f32_32x32x16_bf16 v[128:143], v[32:35], v[92:95], v[128:143]
    v_add_u32 v8, 49152, v8
    ds_read_b64_tr_b16 v[24:25], v8 offset:24576
    ds_read_b64_tr_b16 v[26:27], v8 offset:25088
    s_add_u32 m0, s73, 98304
    s_add_u32 s35, s45, 0
    v_mfma_f32_32x32x16_bf16 v[144:159], v[36:39], v[92:95], v[144:159]
    v_add_u32 v9, 49152, v9
    ds_read_b64_tr_b16 v[28:29], v9 offset:24576
    ds_read_b64_tr_b16 v[30:31], v9 offset:25088
    buffer_load_dwordx4 v5, s[12:15], s35 offen offset:0 lds
    s_waitcnt lgkmcnt(4)
    v_mfma_f32_32x32x16_bf16 v[160:175], v[40:43], v[92:95], v[160:175]
    v_add_u32 v10, 49152, v10
    ds_read_b64_tr_b16 v[32:33], v10 offset:24576
    ds_read_b64_tr_b16 v[34:35], v10 offset:25088
    v_mfma_f32_32x32x16_bf16 v[176:191], v[44:47], v[92:95], v[176:191]
    v_add_u32 v11, 49152, v11
    ds_read_b64_tr_b16 v[36:37], v11 offset:24576
    ds_read_b64_tr_b16 v[38:39], v11 offset:25088
    buffer_load_dwordx4 a[216:219], v1, s[16:19], s33 offen offset:2048 sc1
    s_waitcnt lgkmcnt(4)
    v_mfma_f32_32x32x16_bf16 v[96:111], v[24:27], a[144:147], v[96:111]
    v_add_u32 v16, 49152, v16
    ds_read_b64_tr_b16 v[40:41], v16 offset:24576
    ds_read_b64_tr_b16 v[42:43], v16 offset:25088
    v_mfma_f32_32x32x16_bf16 v[112:127], v[28:31], a[144:147], v[112:127]
    ds_read_b64_tr_b16 v[44:45], v8 offset:30720
    ds_read_b64_tr_b16 v[46:47], v8 offset:31232
    buffer_load_dwordx4 v6, s[12:15], s35 offen offset:1024 lds
    v_add_u32 v17, 49152, v17
    ds_read_b64_tr_b16 a[96:97], v17 offset:24576
    s_waitcnt lgkmcnt(5)
    v_mfma_f32_32x32x16_bf16 v[128:143], v[32:35], a[144:147], v[128:143]
    ds_read_b64_tr_b16 v[24:25], v9 offset:30720
    ds_read_b64_tr_b16 v[26:27], v9 offset:31232
    ds_read_b64_tr_b16 a[98:99], v17 offset:25088
    v_mfma_f32_32x32x16_bf16 v[144:159], v[36:39], a[144:147], v[144:159]
    ds_read_b64_tr_b16 v[28:29], v10 offset:30720
    ds_read_b64_tr_b16 v[30:31], v10 offset:31232
    buffer_load_dwordx4 a[220:223], v1, s[16:19], s33 offen offset:3072 sc1
    ds_read_b64_tr_b16 a[100:101], v17 offset:30720
    s_waitcnt lgkmcnt(7)
    v_mfma_f32_32x32x16_bf16 v[160:175], v[40:43], a[144:147], v[160:175]
    ds_read_b64_tr_b16 v[32:33], v11 offset:30720
    ds_read_b64_tr_b16 v[34:35], v11 offset:31232
    ds_read_b64_tr_b16 a[102:103], v17 offset:31232
    v_mfma_f32_32x32x16_bf16 v[96:111], v[44:47], a[148:151], v[96:111]
    ds_read_b64_tr_b16 v[36:37], v16 offset:30720
    ds_read_b64_tr_b16 v[38:39], v16 offset:31232
    buffer_load_dwordx4 v7, s[12:15], s35 offen offset:2048 lds
    s_add_u32 m0, s73, 101376
    s_add_u32 s35, s45, 9216
    s_waitcnt lgkmcnt(6)
    v_mfma_f32_32x32x16_bf16 v[112:127], v[24:27], a[148:151], v[112:127]
    ds_read_b64_tr_b16 v[40:41], v8 offset:36864
    ds_read_b64_tr_b16 v[42:43], v8 offset:37376
    ds_read_b64_tr_b16 a[104:105], v17 offset:36864
    v_mfma_f32_32x32x16_bf16 v[128:143], v[28:31], a[148:151], v[128:143]
    ds_read_b64_tr_b16 v[44:45], v9 offset:36864
    ds_read_b64_tr_b16 v[46:47], v9 offset:37376
    s_add_u32 s33, s93, 8192
    buffer_load_dwordx4 a[224:227], v1, s[16:19], s33 offen offset:0 sc1
    ds_read_b64_tr_b16 a[106:107], v17 offset:37376
    s_waitcnt lgkmcnt(6)
    v_mfma_f32_32x32x16_bf16 v[144:159], v[32:35], a[148:151], v[144:159]
    ds_read_b64_tr_b16 v[24:25], v10 offset:36864
    ds_read_b64_tr_b16 v[26:27], v10 offset:37376
    ds_read_b64_tr_b16 a[108:109], v17 offset:43008
    v_mfma_f32_32x32x16_bf16 v[160:175], v[36:39], a[148:151], v[160:175]
    ds_read_b64_tr_b16 v[28:29], v11 offset:36864
    ds_read_b64_tr_b16 v[30:31], v11 offset:37376
    buffer_load_dwordx4 v5, s[12:15], s35 offen offset:0 lds
    ds_read_b64_tr_b16 a[110:111], v17 offset:43520
    s_waitcnt lgkmcnt(7)
    v_mfma_f32_32x32x16_bf16 v[96:111], v[40:43], a[152:155], v[96:111]
    ds_read_b64_tr_b16 v[32:33], v16 offset:36864
    ds_read_b64_tr_b16 v[34:35], v16 offset:37376
    v_mfma_f32_32x32x16_bf16 v[112:127], v[44:47], a[152:155], v[112:127]
    ds_read_b64_tr_b16 v[36:37], v8 offset:43008
    ds_read_b64_tr_b16 v[38:39], v8 offset:43520
    buffer_load_dwordx4 a[228:231], v1, s[16:19], s33 offen offset:1024 sc1
    s_waitcnt lgkmcnt(5)
    v_mfma_f32_32x32x16_bf16 v[128:143], v[24:27], a[152:155], v[128:143]
    ds_read_b64_tr_b16 v[40:41], v9 offset:43008
    ds_read_b64_tr_b16 v[42:43], v9 offset:43520
    buffer_load_dwordx4 v6, s[12:15], s35 offen offset:1024 lds
    v_mfma_f32_32x32x16_bf16 v[144:159], v[28:31], a[152:155], v[144:159]
    ds_read_b64_tr_b16 v[44:45], v10 offset:43008
    ds_read_b64_tr_b16 v[46:47], v10 offset:43520
    s_waitcnt lgkmcnt(4)
    v_mfma_f32_32x32x16_bf16 v[160:175], v[32:35], a[152:155], v[160:175]
    ds_read_b64_tr_b16 v[24:25], v11 offset:43008
    ds_read_b64_tr_b16 v[26:27], v11 offset:43520
    buffer_load_dwordx4 a[232:235], v1, s[16:19], s33 offen offset:2048 sc1
    v_mfma_f32_32x32x16_bf16 v[96:111], v[36:39], a[156:159], v[96:111]
    ds_read_b64_tr_b16 v[28:29], v16 offset:43008
    ds_read_b64_tr_b16 v[30:31], v16 offset:43520
    s_waitcnt vmcnt(39)
    s_waitcnt vmcnt(31)
    s_waitcnt vmcnt(10)
    v_min_u32 v20, v20, v21
    v_min_u32 v20, v20, v22
    v_cmp_gt_u32 vcc, 2, v20
    s_cbranch_vccnz L_slow_11
L_ok_9:
    s_barrier
    s_waitcnt lgkmcnt(4)
    v_mfma_f32_32x32x16_bf16 v[112:127], v[40:43], a[156:159], v[112:127]
    v_subrev_u32 v8, 49152, v8
    ds_read_b64_tr_b16 v[32:33], v8 offset:24576
    ds_read_b64_tr_b16 v[34:35], v8 offset:25088
    buffer_load_dwordx4 v7, s[12:15], s35 offen offset:2048 lds
    s_add_u32 m0, s73, 49152
    s_add_u32 s35, s46, 0
    v_mfma_f32_32x32x16_bf16 v[128:143], v[44:47], a[156:159], v[128:143]
    v_subrev_u32 v9, 49152, v9
    ds_read_b64_tr_b16 v[36:37], v9 offset:24576
    ds_read_b64_tr_b16 v[38:39], v9 offset:25088
    s_waitcnt lgkmcnt(4)
    v_mfma_f32_32x32x16_bf16 v[144:159], v[24:27], a[156:159], v[144:159]
    v_subrev_u32 v10, 49152, v10
    ds_read_b64_tr_b16 v[40:41], v10 offset:24576
    ds_read_b64_tr_b16 v[42:43], v10 offset:25088
    buffer_load_dwordx4 a[236:239], v1, s[16:19], s33 offen offset:3072 sc1
    v_mfma_f32_32x32x16_bf16 v[160:175], v[28:31], a[156:159], v[160:175]
    v_subrev_u32 v11, 49152, v11
    ds_read_b64_tr_b16 v[44:45], v11 offset:24576
    ds_read_b64_tr_b16 v[46:47], v11 offset:25088
    s_waitcnt lgkmcnt(4)
    v_mfma_f32_32x32x16_bf16 v[96:111], v[32:35], a[160:163], v[96:111]
    v_subrev_u32 v16, 49152, v16
    ds_read_b64_tr_b16 v[24:25], v16 offset:24576
    ds_read_b64_tr_b16 v[26:27], v16 offset:25088
    buffer_load_dwordx4 v5, s[12:15], s35 offen offset:0 lds
    v_mfma_f32_32x32x16_bf16 v[112:127], v[36:39], a[160:163], v[112:127]
    ds_read_b64_tr_b16 v[28:29], v8 offset:30720
    ds_read_b64_tr_b16 v[30:31], v8 offset:31232
L_pg6:
    s_cbranch_execz L_pgret
    v_subrev_u32 v17, 49152, v17
    ds_read_b64_tr_b16 a[112:113], v17 offset:24576
    s_waitcnt lgkmcnt(5)
    v_mfma_f32_32x32x16_bf16 v[128:143], v[40:43], a[160:163], v[128:143]
    ds_read_b64_tr_b16 v[32:33], v9 offset:30720
    ds_read_b64_tr_b16 v[34:35], v9 offset:31232
    s_add_u32 s33, s92, 12288
    buffer_load_dwordx4 a[0:3], v1, s[16:19], s33 offen offset:0 sc1
    ds_read_b64_tr_b16 a[114:115], v17 offset:25088
    v_mfma_f32_32x32x16_bf16 v[144:159], v[44:47], a[160:163], v[144:159]
    ds_read_b64_tr_b16 v[36:37], v10 offset:30720
    ds_read_b64_tr_b16 v[38:39], v10 offset:31232
    ds_read_b64_tr_b16 a[116:117], v17 offset:30720
    s_waitcnt lgkmcnt(7)
    v_mfma_f32_32x32x16_bf16 v[160:175], v[24:27], a[160:163], v[160:175]
    ds_read_b64_tr_b16 v[40:41], v11 offset:30720
    ds_read_b64_tr_b16 v[42:43], v11 offset:31232
    buffer_load_dwordx4 v6, s[12:15], s35 offen offset:1024 lds
    ds_read_b64_tr_b16 a[118:119], v17 offset:31232
    v_mfma_f32_32x32x16_bf16 v[96:111], v[28:31], a[164:167], v[96:111]
    ds_read_b64_tr_b16 v[44:45], v16 offset:30720
    ds_read_b64_tr_b16 v[46:47], v16 offset:31232
    ds_read_b64_tr_b16 a[120:121], v17 offset:36864
    s_waitcnt lgkmcnt(7)
    v_mfma_f32_32x32x16_bf16 v[112:127], v[32:35], a[164:167], v[112:127]
    ds_read_b64_tr_b16 v[24:25], v8 offset:36864
    ds_read_b64_tr_b16 v[26:27], v8 offset:37376
    buffer_load_dwordx4 a[4:7], v1, s[16:19], s33 offen offset:1024 sc1
    ds_read_b64_tr_b16 a[122:123], v17 offset:37376
    v_mfma_f32_32x32x16_bf16 v[128:143], v[36:39], a[164:167], v[128:143]
    ds_read_b64_tr_b16 v[28:29], v9 offset:36864
    ds_read_b64_tr_b16 v[30:31], v9 offset:37376
    ds_read_b64_tr_b16 a[124:125], v17 offset:43008
    s_waitcnt lgkmcnt(7)
    v_mfma_f32_32x32x16_bf16 v[144:159], v[40:43], a[164:167], v[144:159]
    ds_read_b64_tr_b16 v[32:33], v10 offset:36864
    ds_read_b64_tr_b16 v[34:35], v10 offset:37376
    buffer_load_dwordx4 v7, s[12:15], s35 offen offset:2048 lds
    s_add_u32 m0, s73, 52224
    s_add_u32 s35, s46, 9216
    v_mfma_f32_32x32x16_bf16 v[160:175], v[44:47], a[164:167], v[160:175]
    ds_read_b64_tr_b16 v[36:37], v11 offset:36864
    ds_read_b64_tr_b16 v[38:39], v11 offset:37376
    ds_read_b64_tr_b16 a[126:127], v17 offset:43520
    s_waitcnt lgkmcnt(6)
    v_mfma_f32_32x32x16_bf16 v[96:111], v[24:27], a[168:171], v[96:111]
    ds_read_b64_tr_b16 v[40:41], v16 offset:36864
    ds_read_b64_tr_b16 v[42:43], v16 offset:37376
    buffer_load_dwordx4 a[8:11], v1, s[16:19], s33 offen offset:2048 sc1
    v_mfma_f32_32x32x16_bf16 v[112:127], v[28:31], a[168:171], v[112:127]
    ds_read_b64_tr_b16 v[44:45], v8 offset:43008
    ds_read_b64_tr_b16 v[46:47], v8 offset:43520
    s_waitcnt lgkmcnt(5)
    v_mfma_f32_32x32x16_bf16 v[128:143], v[32:35], a[168:171], v[128:143]
    ds_read_b64_tr_b16 v[24:25], v9 offset:43008
    ds_read_b64_tr_b16 v[26:27], v9 offset:43520
    buffer_load_dwordx4 v5, s[12:15], s35 offen offset:0 lds
    v_mfma_f32_32x32x16_bf16 v[144:159], v[36:39], a[168:171], v[144:159]
    ds_read_b64_tr_b16 v[28:29], v10 offset:43008
    ds_read_b64_tr_b16 v[30:31], v10 offset:43520
    s_waitcnt lgkmcnt(4)
    v_mfma_f32_32x32x16_bf16 v[160:175], v[40:43], a[168:171], v[160:175]
    ds_read_b64_tr_b16 v[32:33], v11 offset:43008
    ds_read_b64_tr_b16 v[34:35], v11 offset:43520
    buffer_load_dwordx4 a[12:15], v1, s[16:19], s33 offen offset:3072 sc1
    v_mfma_f32_32x32x16_bf16 v[96:111], v[44:47], a[172:175], v[96:111]
    ds_read_b64_tr_b16 v[36:37], v16 offset:43008
    ds_read_b64_tr_b16 v[38:39], v16 offset:43520
    s_barrier
    buffer_load_dwordx4 v[20:23], v240, s[16:19], s48 offen sc1
    s_waitcnt lgkmcnt(4)
    v_mfma_f32_32x32x16_bf16 v[112:127], v[24:27], a[172:175], v[112:127]
    v_subrev_u32 v8, 49152, v8
    ds_read_b64_tr_b16 v[40:41], v8 offset:0
    ds_read_b64_tr_b16 v[42:43], v8 offset:512
    buffer_load_dwordx4 v6, s[12:15], s35 offen offset:1024 lds
    v_mfma_f32_32x32x16_bf16 v[128:143], v[28:31], a[172:175], v[128:143]
    v_subrev_u32 v9, 49152, v9
    ds_read_b64_tr_b16 v[44:45], v9 offset:0
    ds_read_b64_tr_b16 v[46:47], v9 offset:512
    s_waitcnt lgkmcnt(4)
    v_mfma_f32_32x32x16_bf16 v[144:159], v[32:35], a[172:175], v[144:159]
    v_subrev_u32 v10, 49152, v10
    ds_read_b64_tr_b16 v[24:25], v10 offset:0
    ds_read_b64_tr_b16 v[26:27], v10 offset:512
    s_add_u32 s33, s92, 16384
    buffer_load_dwordx4 a[16:19], v1, s[16:19], s33 offen offset:0 sc1
    v_mfma_f32_32x32x16_bf16 v[160:175], v[36:39], a[172:175], v[160:175]
    v_subrev_u32 v11, 49152, v11
    ds_read_b64_tr_b16 v[28:29], v11 offset:0
    ds_read_b64_tr_b16 v[30:31], v11 offset:512
    s_waitcnt lgkmcnt(4)
    v_mfma_f32_32x32x16_bf16 v[96:111], v[40:43], a[176:179], v[96:111]
    v_subrev_u32 v16, 49152, v16
    ds_read_b64_tr_b16 v[32:33], v16 offset:0
    ds_read_b64_tr_b16 v[34:35], v16 offset:512
    buffer_load_dwordx4 v7, s[12:15], s35 offen offset:2048 lds
    s_add_u32 m0, s73, 122880
    s_add_u32 s35, s41, 221184
    v_mfma_f32_32x32x16_bf16 v[112:127], v[44:47], a[176:179], v[112:127]
    ds_read_b64_tr_b16 v[36:37], v8 offset:6144
    ds_read_b64_tr_b16 v[38:39], v8 offset:6656
    v_subrev_u32 v17, 49152, v17
    ds_read_b64_tr_b16 a[128:129], v17 offset:0
    s_waitcnt lgkmcnt(5)
    v_mfma_f32_32x32x16_bf16 v[128:143], v[24:27], a[176:179], v[128:143]
    ds_read_b64_tr_b16 v[40:41], v9 offset:6144
    ds_read_b64_tr_b16 v[42:43], v9 offset:6656
    buffer_load_dwordx4 a[20:23], v1, s[16:19], s33 offen offset:1024 sc1
    ds_read_b64_tr_b16 a[130:131], v17 offset:512
    v_mfma_f32_32x32x16_bf16 v[144:159], v[28:31], a[176:179], v[144:159]
    ds_read_b64_tr_b16 v[44:45], v10 offset:6144
    ds_read_b64_tr_b16 v[46:47], v10 offset:6656
    buffer_load_dwordx4 v5, s[12:15], s35 offen offset:0 lds
    ds_read_b64_tr_b16 a[132:133], v17 offset:6144
    s_waitcnt lgkmcnt(7)
    v_mfma_f32_32x32x16_bf16 v[160:175], v[32:35], a[176:179], v[160:175]
    ds_read_b64_tr_b16 v[24:25], v11 offset:6144
    ds_read_b64_tr_b16 v[26:27], v11 offset:6656
    ds_read_b64_tr_b16 a[134:135], v17 offset:6656
    v_mfma_f32_32x32x16_bf16 v[96:111], v[36:39], a[180:183], v[96:111]
    ds_read_b64_tr_b16 v[28:29], v16 offset:6144
    ds_read_b64_tr_b16 v[30:31], v16 offset:6656
    buffer_load_dwordx4 a[24:27], v1, s[16:19], s33 offen offset:2048 sc1
    ds_read_b64_tr_b16 a[136:137], v17 offset:12288
    s_waitcnt lgkmcnt(7)
    v_mfma_f32_32x32x16_bf16 v[112:127], v[40:43], a[180:183], v[112:127]
    ds_read_b64_tr_b16 v[32:33], v8 offset:12288
    ds_read_b64_tr_b16 v[34:35], v8 offset:12800
    ds_read_b64_tr_b16 a[138:139], v17 offset:12800
    v_mfma_f32_32x32x16_bf16 v[128:143], v[44:47], a[180:183], v[128:143]
    ds_read_b64_tr_b16 v[36:37], v9 offset:12288
    ds_read_b64_tr_b16 v[38:39], v9 offset:12800
    buffer_load_dwordx4 v6, s[12:15], s35 offen offset:1024 lds
    ds_read_b64_tr_b16 a[140:141], v17 offset:18432
    s_waitcnt lgkmcnt(7)
    v_mfma_f32_32x32x16_bf16 v[144:159], v[24:27], a[180:183], v[144:159]
    ds_read_b64_tr_b16 v[40:41], v10 offset:12288
    ds_read_b64_tr_b16 v[42:43], v10 offset:12800
    ds_read_b64_tr_b16 a[142:143], v17 offset:18944
    v_mfma_f32_32x32x16_bf16 v[160:175], v[28:31], a[180:183], v[160:175]
    ds_read_b64_tr_b16 v[44:45], v11 offset:12288
    ds_read_b64_tr_b16 v[46:47], v11 offset:12800
    buffer_load_dwordx4 a[28:31], v1, s[16:19], s33 offen offset:3072 sc1
    s_waitcnt lgkmcnt(6)
    v_mfma_f32_32x32x16_bf16 v[96:111], v[32:35], a[184:187], v[96:111]
    ds_read_b64_tr_b16 v[24:25], v16 offset:12288
    ds_read_b64_tr_b16 v[26:27], v16 offset:12800
    v_mfma_f32_32x32x16_bf16 v[112:127], v[36:39], a[184:187], v[112:127]
    ds_read_b64_tr_b16 v[28:29], v8 offset:18432
    ds_read_b64_tr_b16 v[30:31], v8 offset:18944
    buffer_load_dwordx4 v7, s[12:15], s35 offen offset:2048 lds
    s_add_u32 m0, s73, 125952
    s_add_u32 s35, s41, 230400
    s_waitcnt lgkmcnt(4)
    v_mfma_f32_32x32x16_bf16 v[128:143], v[40:43], a[184:187], v[128:143]
    ds_read_b64_tr_b16 v[32:33], v9 offset:18432
    ds_read_b64_tr_b16 v[34:35], v9 offset:18944
    v_mfma_f32_32x32x16_bf16 v[144:159], v[44:47], a[184:187], v[144:159]
    ds_read_b64_tr_b16 v[36:37], v10 offset:18432
    ds_read_b64_tr_b16 v[38:39], v10 offset:18944
    s_add_u32 s33, s92, 20480
    buffer_load_dwordx4 a[32:35], v1, s[16:19], s33 offen offset:0 sc1
    s_waitcnt lgkmcnt(4)
    v_mfma_f32_32x32x16_bf16 v[160:175], v[24:27], a[184:187], v[160:175]
    ds_read_b64_tr_b16 v[40:41], v11 offset:18432
    ds_read_b64_tr_b16 v[42:43], v11 offset:18944
    v_mfma_f32_32x32x16_bf16 v[96:111], v[28:31], a[188:191], v[96:111]
    ds_read_b64_tr_b16 v[44:45], v16 offset:18432
    ds_read_b64_tr_b16 v[46:47], v16 offset:18944
    buffer_load_dwordx4 v5, s[12:15], s35 offen offset:0 lds
    s_waitcnt vmcnt(11)
    v_min3_u32 v20, v20, v21, v22
    v_cmp_eq_u32 vcc, 0, v20
    s_cbranch_vccnz L_slow_14
L_ok_12:
    s_barrier
    s_waitcnt lgkmcnt(4)
    v_mfma_f32_32x32x16_bf16 v[112:127], v[32:35], a[188:191], v[112:127]
    ds_read_b64_tr_b16 v[24:25], v8 offset:24576
    ds_read_b64_tr_b16 v[26:27], v8 offset:25088
    v_mfma_f32_32x32x16_bf16 v[128:143], v[36:39], a[188:191], v[128:143]
    ds_read_b64_tr_b16 v[28:29], v9 offset:24576
    ds_read_b64_tr_b16 v[30:31], v9 offset:25088
    buffer_load_dwordx4 a[36:39], v1, s[16:19], s33 offen offset:1024 sc1
    s_waitcnt lgkmcnt(4)
    v_mfma_f32_32x32x16_bf16 v[144:159], v[40:43], a[188:191], v[144:159]
    ds_read_b64_tr_b16 v[32:33], v10 offset:24576
    ds_read_b64_tr_b16 v[34:35], v10 offset:25088
    v_mfma_f32_32x32x16_bf16 v[160:175], v[44:47], a[188:191], v[160:175]
    ds_read_b64_tr_b16 v[36:37], v11 offset:24576
    ds_read_b64_tr_b16 v[38:39], v11 offset:25088
    buffer_load_dwordx4 v6, s[12:15], s35 offen offset:1024 lds
    s_waitcnt lgkmcnt(4)
    v_mfma_f32_32x32x16_bf16 v[96:111], v[24:27], a[192:195], v[96:111]
    ds_read_b64_tr_b16 v[40:41], v16 offset:24576
    ds_read_b64_tr_b16 v[42:43], v16 offset:25088
    v_mfma_f32_32x32x16_bf16 v[112:127], v[28:31], a[192:195], v[112:127]
    ds_read_b64_tr_b16 v[44:45], v8 offset:30720
    ds_read_b64_tr_b16 v[46:47], v8 offset:31232
    buffer_load_dwordx4 a[40:43], v1, s[16:19], s33 offen offset:2048 sc1
    ds_read_b64_tr_b16 a[240:241], v17 offset:24576
    s_waitcnt lgkmcnt(5)
    v_mfma_f32_32x32x16_bf16 v[128:143], v[32:35], a[192:195], v[128:143]
    ds_read_b64_tr_b16 v[24:25], v9 offset:30720
    ds_read_b64_tr_b16 v[26:27], v9 offset:31232
    ds_read_b64_tr_b16 a[242:243], v17 offset:25088
    v_mfma_f32_32x32x16_bf16 v[144:159], v[36:39], a[192:195], v[144:159]
    ds_read_b64_tr_b16 v[28:29], v10 offset:30720
    ds_read_b64_tr_b16 v[30:31], v10 offset:31232
    buffer_load_dwordx4 v7, s[12:15], s35 offen offset:2048 lds
    s_add_u32 m0, s73, 73728
    s_add_u32 s35, s42, 221184
    s_waitcnt lgkmcnt(6)
    v_mfma_f32_32x32x16_bf16 v[160:175], v[40:43], a[192:195], v[160:175]
    ds_read_b64_tr_b16 v[32:33], v11 offset:30720
    ds_read_b64_tr_b16 v[34:35], v11 offset:31232
    ds_read_b64_tr_b16 a[244:245], v17 offset:30720
    v_mfma_f32_32x32x16_bf16 v[96:111], v[44:47], a[196:199], v[96:111]
    ds_read_b64_tr_b16 v[36:37], v16 offset:30720
    ds_read_b64_tr_b16 v[38:39], v16 offset:31232
    buffer_load_dwordx4 a[44:47], v1, s[16:19], s33 offen offset:3072 sc1
    ds_read_b64_tr_b16 a[246:247], v17 offset:31232
    s_waitcnt lgkmcnt(6)
    v_mfma_f32_32x32x16_bf16 v[112:127], v[24:27], a[196:199], v[112:127]
    ds_read_b64_tr_b16 v[40:41], v8 offset:36864
    ds_read_b64_tr_b16 v[42:43], v8 offset:37376
    ds_read_b64_tr_b16 a[248:249], v17 offset:36864
    v_mfma_f32_32x32x16_bf16 v[128:143], v[28:31], a[196:199], v[128:143]
    ds_read_b64_tr_b16 v[44:45], v9 offset:36864
    ds_read_b64_tr_b16 v[46:47], v9 offset:37376
    buffer_load_dwordx4 v5, s[12:15], s35 offen offset:0 lds
    ds_read_b64_tr_b16 a[250:251], v17 offset:37376
    s_waitcnt lgkmcnt(7)
    v_mfma_f32_32x32x16_bf16 v[144:159], v[32:35], a[196:199], v[144:159]
    ds_read_b64_tr_b16 v[24:25], v10 offset:36864
    ds_read_b64_tr_b16 v[26:27], v10 offset:37376
    ds_read_b64_tr_b16 a[252:253], v17 offset:43008
    v_mfma_f32_32x32x16_bf16 v[160:175], v[36:39], a[196:199], v[160:175]
    ds_read_b64_tr_b16 v[28:29], v11 offset:36864
    ds_read_b64_tr_b16 v[30:31], v11 offset:37376
    s_add_u32 s33, s93, 12288
    buffer_load_dwordx4 a[48:51], v1, s[16:19], s33 offen offset:0 sc1
    ds_read_b64_tr_b16 a[254:255], v17 offset:43520
    s_waitcnt lgkmcnt(7)
    v_mfma_f32_32x32x16_bf16 v[96:111], v[40:43], a[200:203], v[96:111]
    ds_read_b64_tr_b16 v[32:33], v16 offset:36864
    ds_read_b64_tr_b16 v[34:35], v16 offset:37376
    v_mfma_f32_32x32x16_bf16 v[112:127], v[44:47], a[200:203], v[112:127]
    ds_read_b64_tr_b16 v[36:37], v8 offset:43008
    ds_read_b64_tr_b16 v[38:39], v8 offset:43520
    buffer_load_dwordx4 v6, s[12:15], s35 offen offset:1024 lds
    s_waitcnt lgkmcnt(5)
    v_mfma_f32_32x32x16_bf16 v[128:143], v[24:27], a[200:203], v[128:143]
    ds_read_b64_tr_b16 v[40:41], v9 offset:43008
    ds_read_b64_tr_b16 v[42:43], v9 offset:43520
    v_mfma_f32_32x32x16_bf16 v[144:159], v[28:31], a[200:203], v[144:159]
    ds_read_b64_tr_b16 v[44:45], v10 offset:43008
    ds_read_b64_tr_b16 v[46:47], v10 offset:43520
    buffer_load_dwordx4 a[52:55], v1, s[16:19], s33 offen offset:1024 sc1
    s_waitcnt lgkmcnt(4)
    v_mfma_f32_32x32x16_bf16 v[160:175], v[32:35], a[200:203], v[160:175]
    ds_read_b64_tr_b16 v[24:25], v11 offset:43008
    ds_read_b64_tr_b16 v[26:27], v11 offset:43520
    v_mfma_f32_32x32x16_bf16 v[96:111], v[36:39], a[204:207], v[96:111]
    ds_read_b64_tr_b16 v[28:29], v16 offset:43008
    ds_read_b64_tr_b16 v[30:31], v16 offset:43520
    buffer_load_dwordx4 v7, s[12:15], s35 offen offset:2048 lds
    s_add_u32 m0, s73, 76800
    s_add_u32 s35, s42, 230400
    s_barrier
    s_waitcnt lgkmcnt(4)
    v_mfma_f32_32x32x16_bf16 v[112:127], v[40:43], a[204:207], v[112:127]
    v_add_u32 v8, 98304, v8
    ds_read_b64_tr_b16 v[32:33], v8 offset:0
    ds_read_b64_tr_b16 v[34:35], v8 offset:512
    buffer_load_dwordx4 a[56:59], v1, s[16:19], s33 offen offset:2048 sc1
    v_mfma_f32_32x32x16_bf16 v[128:143], v[44:47], a[204:207], v[128:143]
    v_add_u32 v9, 98304, v9
    ds_read_b64_tr_b16 v[36:37], v9 offset:0
    ds_read_b64_tr_b16 v[38:39], v9 offset:512
    s_waitcnt lgkmcnt(4)
    v_mfma_f32_32x32x16_bf16 v[144:159], v[24:27], a[204:207], v[144:159]
    v_add_u32 v10, 98304, v10
    ds_read_b64_tr_b16 v[40:41], v10 offset:0
    ds_read_b64_tr_b16 v[42:43], v10 offset:512
    buffer_load_dwordx4 v5, s[12:15], s35 offen offset:0 lds
    v_mfma_f32_32x32x16_bf16 v[160:175], v[28:31], a[204:207], v[160:175]
    v_add_u32 v11, 98304, v11
    ds_read_b64_tr_b16 v[44:45], v11 offset:0
    ds_read_b64_tr_b16 v[46:47], v11 offset:512
    s_waitcnt lgkmcnt(4)
    v_mfma_f32_32x32x16_bf16 v[96:111], v[32:35], a[208:211], v[96:111]
    v_add_u32 v16, 98304, v16
    ds_read_b64_tr_b16 v[24:25], v16 offset:0
    ds_read_b64_tr_b16 v[26:27], v16 offset:512
    buffer_load_dwordx4 a[60:63], v1, s[16:19], s33 offen offset:3072 sc1
    v_mfma_f32_32x32x16_bf16 v[112:127], v[36:39], a[208:211], v[112:127]
    ds_read_b64_tr_b16 v[28:29], v8 offset:6144
    ds_read_b64_tr_b16 v[30:31], v8 offset:6656
    v_add_u32 v17, 98304, v17
    ds_read_b64_tr_b16 v[64:65], v17 offset:0
    s_waitcnt lgkmcnt(5)
    v_mfma_f32_32x32x16_bf16 v[128:143], v[40:43], a[208:211], v[128:143]
    ds_read_b64_tr_b16 v[32:33], v9 offset:6144
    ds_read_b64_tr_b16 v[34:35], v9 offset:6656
    buffer_load_dwordx4 v6, s[12:15], s35 offen offset:1024 lds
    ds_read_b64_tr_b16 v[66:67], v17 offset:512
    v_mfma_f32_32x32x16_bf16 v[144:159], v[44:47], a[208:211], v[144:159]
    ds_read_b64_tr_b16 v[36:37], v10 offset:6144
    ds_read_b64_tr_b16 v[38:39], v10 offset:6656
    ds_read_b64_tr_b16 v[68:69], v17 offset:6144
    s_waitcnt lgkmcnt(7)
    v_mfma_f32_32x32x16_bf16 v[160:175], v[24:27], a[208:211], v[160:175]
    ds_read_b64_tr_b16 v[40:41], v11 offset:6144
    ds_read_b64_tr_b16 v[42:43], v11 offset:6656
    s_add_u32 s33, s93, 16384
    buffer_load_dwordx4 a[64:67], v1, s[16:19], s33 offen offset:0 sc1
    ds_read_b64_tr_b16 v[70:71], v17 offset:6656
    v_mfma_f32_32x32x16_bf16 v[96:111], v[28:31], a[212:215], v[96:111]
    ds_read_b64_tr_b16 v[44:45], v16 offset:6144
    ds_read_b64_tr_b16 v[46:47], v16 offset:6656
    ds_read_b64_tr_b16 v[72:73], v17 offset:12288
    s_waitcnt lgkmcnt(7)
    v_mfma_f32_32x32x16_bf16 v[112:127], v[32:35], a[212:215], v[112:127]
    ds_read_b64_tr_b16 v[24:25], v8 offset:12288
    ds_read_b64_tr_b16 v[26:27], v8 offset:12800
    buffer_load_dwordx4 v7, s[12:15], s35 offen offset:2048 lds
    s_add_u32 m0, s73, 0
    s_add_u32 s35, s43, 221184
    v_mfma_f32_32x32x16_bf16 v[128:143], v[36:39], a[212:215], v[128:143]
    ds_read_b64_tr_b16 v[28:29], v9 offset:12288
    ds_read_b64_tr_b16 v[30:31], v9 offset:12800
    ds_read_b64_tr_b16 v[74:75], v17 offset:12800
    s_waitcnt lgkmcnt(6)
    v_mfma_f32_32x32x16_bf16 v[144:159], v[40:43], a[212:215], v[144:159]
    ds_read_b64_tr_b16 v[32:33], v10 offset:12288
    ds_read_b64_tr_b16 v[34:35], v10 offset:12800
    buffer_load_dwordx4 a[68:71], v1, s[16:19], s33 offen offset:1024 sc1
    ds_read_b64_tr_b16 v[76:77], v17 offset:18432
    v_mfma_f32_32x32x16_bf16 v[160:175], v[44:47], a[212:215], v[160:175]
    ds_read_b64_tr_b16 v[36:37], v11 offset:12288
    ds_read_b64_tr_b16 v[38:39], v11 offset:12800
    ds_read_b64_tr_b16 v[78:79], v17 offset:18944
    s_waitcnt lgkmcnt(7)
    v_mfma_f32_32x32x16_bf16 v[96:111], v[24:27], a[216:219], v[96:111]
    ds_read_b64_tr_b16 v[40:41], v16 offset:12288
    ds_read_b64_tr_b16 v[42:43], v16 offset:12800
    buffer_load_dwordx4 v5, s[12:15], s35 offen offset:0 lds
    v_mfma_f32_32x32x16_bf16 v[112:127], v[28:31], a[216:219], v[112:127]
    ds_read_b64_tr_b16 v[44:45], v8 offset:18432
    ds_read_b64_tr_b16 v[46:47], v8 offset:18944
    s_waitcnt lgkmcnt(5)
    v_mfma_f32_32x32x16_bf16 v[128:143], v[32:35], a[216:219], v[128:143]
    ds_read_b64_tr_b16 v[24:25], v9 offset:18432
    ds_read_b64_tr_b16 v[26:27], v9 offset:18944
    buffer_load_dwordx4 a[72:75], v1, s[16:19], s33 offen offset:2048 sc1
    v_mfma_f32_32x32x16_bf16 v[144:159], v[36:39], a[216:219], v[144:159]
    ds_read_b64_tr_b16 v[28:29], v10 offset:18432
    ds_read_b64_tr_b16 v[30:31], v10 offset:18944
    s_waitcnt lgkmcnt(4)
    v_mfma_f32_32x32x16_bf16 v[160:175], v[40:43], a[216:219], v[160:175]
    ds_read_b64_tr_b16 v[32:33], v11 offset:18432
    ds_read_b64_tr_b16 v[34:35], v11 offset:18944
    buffer_load_dwordx4 v6, s[12:15], s35 offen offset:1024 lds
    v_mfma_f32_32x32x16_bf16 v[96:111], v[44:47], a[220:223], v[96:111]
    ds_read_b64_tr_b16 v[36:37], v16 offset:18432
    ds_read_b64_tr_b16 v[38:39], v16 offset:18944
    s_waitcnt vmcnt(28)
    s_barrier
    s_waitcnt lgkmcnt(4)
    v_mfma_f32_32x32x16_bf16 v[112:127], v[24:27], a[220:223], v[112:127]
    v_subrev_u32 v8, 49152, v8
    ds_read_b64_tr_b16 v[40:41], v8 offset:0
    ds_read_b64_tr_b16 v[42:43], v8 offset:512
    buffer_load_dwordx4 v7, s[12:15], s35 offen offset:2048 lds
    s_add_u32 m0, s73, 3072
    s_add_u32 s35, s43, 230400
    v_mfma_f32_32x32x16_bf16 v[128:143], v[28:31], a[220:223], v[128:143]
    v_subrev_u32 v9, 49152, v9
    ds_read_b64_tr_b16 v[44:45], v9 offset:0
    ds_read_b64_tr_b16 v[46:47], v9 offset:512
    s_waitcnt lgkmcnt(4)
    v_mfma_f32_32x32x16_bf16 v[144:159], v[32:35], a[220:223], v[144:159]
    v_subrev_u32 v10, 49152, v10
    ds_read_b64_tr_b16 v[24:25], v10 offset:0
    ds_read_b64_tr_b16 v[26:27], v10 offset:512
    buffer_load_dwordx4 v5, s[12:15], s35 offen offset:0 lds
    v_mfma_f32_32x32x16_bf16 v[160:175], v[36:39], a[220:223], v[160:175]
    v_subrev_u32 v11, 49152, v11
    ds_read_b64_tr_b16 v[28:29], v11 offset:0
    ds_read_b64_tr_b16 v[30:31], v11 offset:512
    s_waitcnt lgkmcnt(4)
    v_mfma_f32_32x32x16_bf16 v[96:111], v[40:43], a[224:227], v[96:111]
    v_subrev_u32 v16, 49152, v16
    ds_read_b64_tr_b16 v[32:33], v16 offset:0
    ds_read_b64_tr_b16 v[34:35], v16 offset:512
    buffer_load_dwordx4 v6, s[12:15], s35 offen offset:1024 lds
    v_mfma_f32_32x32x16_bf16 v[112:127], v[44:47], a[224:227], v[112:127]
    ds_read_b64_tr_b16 v[36:37], v8 offset:6144
    ds_read_b64_tr_b16 v[38:39], v8 offset:6656
    v_subrev_u32 v17, 49152, v17
    ds_read_b64_tr_b16 v[80:81], v17 offset:0
    s_waitcnt lgkmcnt(5)
    v_mfma_f32_32x32x16_bf16 v[128:143], v[24:27], a[224:227], v[128:143]
    ds_read_b64_tr_b16 v[40:41], v9 offset:6144
    ds_read_b64_tr_b16 v[42:43], v9 offset:6656
    buffer_load_dwordx4 v7, s[12:15], s35 offen offset:2048 lds
    s_add_u32 m0, s73, 24576
    s_add_u32 s35, s44, 221184
    v_mfma_f32_32x32x16_bf16 v[144:159], v[28:31], a[224:227], v[144:159]
    ds_read_b64_tr_b16 v[44:45], v10 offset:6144
    ds_read_b64_tr_b16 v[46:47], v10 offset:6656
    ds_read_b64_tr_b16 v[82:83], v17 offset:512
    s_waitcnt lgkmcnt(6)
    v_mfma_f32_32x32x16_bf16 v[160:175], v[32:35], a[224:227], v[160:175]
    ds_read_b64_tr_b16 v[24:25], v11 offset:6144
    ds_read_b64_tr_b16 v[26:27], v11 offset:6656
    buffer_load_dwordx4 v5, s[12:15], s35 offen offset:0 lds
    ds_read_b64_tr_b16 v[84:85], v17 offset:6144
    v_mfma_f32_32x32x16_bf16 v[96:111], v[36:39], a[228:231], v[96:111]
    ds_read_b64_tr_b16 v[28:29], v16 offset:6144
    ds_read_b64_tr_b16 v[30:31], v16 offset:6656
    ds_read_b64_tr_b16 v[86:87], v17 offset:6656
    s_waitcnt lgkmcnt(7)
    v_mfma_f32_32x32x16_bf16 v[112:127], v[40:43], a[228:231], v[112:127]
    ds_read_b64_tr_b16 v[32:33], v8 offset:12288
    ds_read_b64_tr_b16 v[34:35], v8 offset:12800
    buffer_load_dwordx4 v6, s[12:15], s35 offen offset:1024 lds
    ds_read_b64_tr_b16 v[88:89], v17 offset:12288
    v_mfma_f32_32x32x16_bf16 v[128:143], v[44:47], a[228:231], v[128:143]
    ds_read_b64_tr_b16 v[36:37], v9 offset:12288
    ds_read_b64_tr_b16 v[38:39], v9 offset:12800
    buffer_load_dwordx4 a[76:79], v1, s[16:19], s33 offen offset:3072 sc1
    ds_read_b64_tr_b16 v[90:91], v17 offset:12800
    s_waitcnt lgkmcnt(7)
    v_mfma_f32_32x32x16_bf16 v[144:159], v[24:27], a[228:231], v[144:159]
    ds_read_b64_tr_b16 v[40:41], v10 offset:12288
    ds_read_b64_tr_b16 v[42:43], v10 offset:12800
    ds_read_b64_tr_b16 v[92:93], v17 offset:18432
    v_mfma_f32_32x32x16_bf16 v[160:175], v[28:31], a[228:231], v[160:175]
    ds_read_b64_tr_b16 v[44:45], v11 offset:12288
    ds_read_b64_tr_b16 v[46:47], v11 offset:12800
    buffer_load_dwordx4 v7, s[12:15], s35 offen offset:2048 lds
    s_add_u32 m0, s73, 27648
    s_add_u32 s35, s44, 230400
    s_waitcnt lgkmcnt(6)
    v_mfma_f32_32x32x16_bf16 v[96:111], v[32:35], a[232:235], v[96:111]
    ds_read_b64_tr_b16 v[24:25], v16 offset:12288
    ds_read_b64_tr_b16 v[26:27], v16 offset:12800
    ds_read_b64_tr_b16 v[94:95], v17 offset:18944
    v_mfma_f32_32x32x16_bf16 v[112:127], v[36:39], a[232:235], v[112:127]
    ds_read_b64_tr_b16 v[28:29], v8 offset:18432
    ds_read_b64_tr_b16 v[30:31], v8 offset:18944
    buffer_load_dwordx4 v5, s[12:15], s35 offen offset:0 lds
    s_waitcnt lgkmcnt(5)
    v_mfma_f32_32x32x16_bf16 v[128:143], v[40:43], a[232:235], v[128:143]
    ds_read_b64_tr_b16 v[32:33], v9 offset:18432
    ds_read_b64_tr_b16 v[34:35], v9 offset:18944
    v_mfma_f32_32x32x16_bf16 v[144:159], v[44:47], a[232:235], v[144:159]
    ds_read_b64_tr_b16 v[36:37], v10 offset:18432
    ds_read_b64_tr_b16 v[38:39], v10 offset:18944
    buffer_load_dwordx4 v6, s[12:15], s35 offen offset:1024 lds
    s_waitcnt lgkmcnt(4)
    v_mfma_f32_32x32x16_bf16 v[160:175], v[24:27], a[232:235], v[160:175]
    ds_read_b64_tr_b16 v[40:41], v11 offset:18432
    ds_read_b64_tr_b16 v[42:43], v11 offset:18944
    v_mfma_f32_32x32x16_bf16 v[96:111], v[28:31], a[236:239], v[96:111]
    ds_read_b64_tr_b16 v[44:45], v16 offset:18432
    ds_read_b64_tr_b16 v[46:47], v16 offset:18944
    buffer_load_dwordx4 v7, s[12:15], s35 offen offset:2048 lds
    s_waitcnt vmcnt(27)
    s_barrier
    s_waitcnt lgkmcnt(4)
    v_mfma_f32_32x32x16_bf16 v[112:127], v[32:35], a[236:239], v[112:127]
    v_add_u32 v8, 49152, v8
    ds_read_b64_tr_b16 v[24:25], v8 offset:24576
    ds_read_b64_tr_b16 v[26:27], v8 offset:25088
    s_add_u32 m0, s73, 98304
    s_add_u32 s35, s45, 221184
    v_mfma_f32_32x32x16_bf16 v[128:143], v[36:39], a[236:239], v[128:143]
    v_add_u32 v9, 49152, v9
    ds_read_b64_tr_b16 v[28:29], v9 offset:24576
    ds_read_b64_tr_b16 v[30:31], v9 offset:25088
    buffer_load_dwordx4 v5, s[12:15], s35 offen offset:0 lds
    s_waitcnt lgkmcnt(4)
    v_mfma_f32_32x32x16_bf16 v[144:159], v[40:43], a[236:239], v[144:159]
    ds_read_b64_tr_b16 v[32:33], v8 offset:30720
    ds_read_b64_tr_b16 v[34:35], v8 offset:31232
    v_mfma_f32_32x32x16_bf16 v[160:175], v[44:47], a[236:239], v[160:175]
    ds_read_b64_tr_b16 v[36:37], v9 offset:30720
    ds_read_b64_tr_b16 v[38:39], v9 offset:31232
    buffer_load_dwordx4 v6, s[12:15], s35 offen offset:1024 lds
    s_waitcnt lgkmcnt(4)
    v_mfma_f32_32x32x16_bf16 v[96:111], v[24:27], a[0:3], v[96:111]
    ds_read_b64_tr_b16 v[40:41], v8 offset:36864
    ds_read_b64_tr_b16 v[42:43], v8 offset:37376
    v_mfma_f32_32x32x16_bf16 v[112:127], v[28:31], a[0:3], v[112:127]
    ds_read_b64_tr_b16 v[44:45], v9 offset:36864
    ds_read_b64_tr_b16 v[46:47], v9 offset:37376
    buffer_load_dwordx4 v7, s[12:15], s35 offen offset:2048 lds
    s_add_u32 m0, s73, 101376
    s_add_u32 s35, s45, 230400
    s_waitcnt lgkmcnt(4)
    v_mfma_f32_32x32x16_bf16 v[96:111], v[32:35], a[4:7], v[96:111]
    ds_read_b64_tr_b16 v[24:25], v8 offset:43008
    ds_read_b64_tr_b16 v[26:27], v8 offset:43520
    v_mfma_f32_32x32x16_bf16 v[112:127], v[36:39], a[4:7], v[112:127]
    ds_read_b64_tr_b16 v[28:29], v9 offset:43008
    ds_read_b64_tr_b16 v[30:31], v9 offset:43520
    buffer_load_dwordx4 v5, s[12:15], s35 offen offset:0 lds
    s_waitcnt vmcnt(19)
    s_barrier
    s_cmp_lg_u32 s3, 0
    s_cbranch_scc1 L_w0_15
    buffer_load_dword v248, v250, s[16:19], s5 offen sc1
L_w0_15:
    s_waitcnt lgkmcnt(4)
    v_mfma_f32_32x32x16_bf16 v[96:111], v[40:43], a[8:11], v[96:111]
    v_subrev_u32 v8, 49152, v8
    ds_read_b64_tr_b16 v[32:33], v8 offset:24576
    ds_read_b64_tr_b16 v[34:35], v8 offset:25088
    v_mfma_f32_32x32x16_bf16 v[112:127], v[44:47], a[8:11], v[112:127]
    v_subrev_u32 v9, 49152, v9
    ds_read_b64_tr_b16 v[36:37], v9 offset:24576
    ds_read_b64_tr_b16 v[38:39], v9 offset:25088
    buffer_load_dwordx4 v6, s[12:15], s35 offen offset:1024 lds
    s_waitcnt lgkmcnt(4)
    v_mfma_f32_32x32x16_bf16 v[96:111], v[24:27], a[12:15], v[96:111]
    ds_read_b64_tr_b16 v[40:41], v8 offset:30720
    ds_read_b64_tr_b16 v[42:43], v8 offset:31232
    v_mfma_f32_32x32x16_bf16 v[112:127], v[28:31], a[12:15], v[112:127]
    ds_read_b64_tr_b16 v[44:45], v9 offset:30720
    ds_read_b64_tr_b16 v[46:47], v9 offset:31232
    buffer_load_dwordx4 v7, s[12:15], s35 offen offset:2048 lds
    s_add_u32 m0, s73, 49152
    s_add_u32 s35, s46, 221184
    s_waitcnt lgkmcnt(4)
    v_mfma_f32_32x32x16_bf16 v[96:111], v[32:35], a[16:19], v[96:111]
    ds_read_b64_tr_b16 v[24:25], v8 offset:36864
    ds_read_b64_tr_b16 v[26:27], v8 offset:37376
    v_mfma_f32_32x32x16_bf16 v[112:127], v[36:39], a[16:19], v[112:127]
    ds_read_b64_tr_b16 v[28:29], v9 offset:36864
    ds_read_b64_tr_b16 v[30:31], v9 offset:37376
    buffer_load_dwordx4 v5, s[12:15], s35 offen offset:0 lds
    s_waitcnt lgkmcnt(4)
    v_mfma_f32_32x32x16_bf16 v[96:111], v[40:43], a[20:23], v[96:111]
    ds_read_b64_tr_b16 v[32:33], v8 offset:43008
    ds_read_b64_tr_b16 v[34:35], v8 offset:43520
L_pg7:
    s_cbranch_execz L_pgret
    v_mfma_f32_32x32x16_bf16 v[112:127], v[44:47], a[20:23], v[112:127]
    ds_read_b64_tr_b16 v[36:37], v9 offset:43008
    ds_read_b64_tr_b16 v[38:39], v9 offset:43520
    buffer_load_dwordx4 v6, s[12:15], s35 offen offset:1024 lds
    s_waitcnt vmcnt(15)
    s_barrier
    s_waitcnt lgkmcnt(4)
    v_mfma_f32_32x32x16_bf16 v[96:111], v[24:27], a[24:27], v[96:111]
    v_subrev_u32 v8, 49152, v8
    ds_read_b64_tr_b16 v[40:41], v8 offset:0
    ds_read_b64_tr_b16 v[42:43], v8 offset:512
    v_mfma_f32_32x32x16_bf16 v[112:127], v[28:31], a[24:27], v[112:127]
    v_subrev_u32 v9, 49152, v9
    ds_read_b64_tr_b16 v[44:45], v9 offset:0
    ds_read_b64_tr_b16 v[46:47], v9 offset:512
    buffer_load_dwordx4 v7, s[12:15], s35 offen offset:2048 lds
    s_add_u32 m0, s73, 52224
    s_add_u32 s35, s46, 230400
    s_waitcnt lgkmcnt(4)
    v_mfma_f32_32x32x16_bf16 v[96:111], v[32:35], a[28:31], v[96:111]
    ds_read_b64_tr_b16 v[24:25], v8 offset:6144
    ds_read_b64_tr_b16 v[26:27], v8 offset:6656
    v_mfma_f32_32x32x16_bf16 v[112:127], v[36:39], a[28:31], v[112:127]
    ds_read_b64_tr_b16 v[28:29], v9 offset:6144
    ds_read_b64_tr_b16 v[30:31], v9 offset:6656
    buffer_load_dwordx4 v5, s[12:15], s35 offen offset:0 lds
    s_waitcnt lgkmcnt(4)
    v_mfma_f32_32x32x16_bf16 v[96:111], v[40:43], a[32:35], v[96:111]
    ds_read_b64_tr_b16 v[32:33], v8 offset:12288
    ds_read_b64_tr_b16 v[34:35], v8 offset:12800
    v_mfma_f32_32x32x16_bf16 v[112:127], v[44:47], a[32:35], v[112:127]
    ds_read_b64_tr_b16 v[36:37], v9 offset:12288
    ds_read_b64_tr_b16 v[38:39], v9 offset:12800
    buffer_load_dwordx4 v6, s[12:15], s35 offen offset:1024 lds
    s_waitcnt lgkmcnt(4)
    v_mfma_f32_32x32x16_bf16 v[96:111], v[24:27], a[36:39], v[96:111]
    ds_read_b64_tr_b16 v[40:41], v8 offset:18432
    ds_read_b64_tr_b16 v[42:43], v8 offset:18944
    v_mfma_f32_32x32x16_bf16 v[112:127], v[28:31], a[36:39], v[112:127]
    ds_read_b64_tr_b16 v[44:45], v9 offset:18432
    ds_read_b64_tr_b16 v[46:47], v9 offset:18944
    buffer_load_dwordx4 v7, s[12:15], s35 offen offset:2048 lds
    s_waitcnt vmcnt(12)
    s_barrier
    s_waitcnt lgkmcnt(4)
    v_mfma_f32_32x32x16_bf16 v[96:111], v[32:35], a[40:43], v[96:111]
    ds_read_b64_tr_b16 v[24:25], v8 offset:24576
    ds_read_b64_tr_b16 v[26:27], v8 offset:25088
    s_add_u32 s33, s93, 20480
    buffer_load_dwordx4 a[80:83], v1, s[16:19], s33 offen offset:0 sc1
    v_mfma_f32_32x32x16_bf16 v[112:127], v[36:39], a[40:43], v[112:127]
    ds_read_b64_tr_b16 v[28:29], v9 offset:24576
    ds_read_b64_tr_b16 v[30:31], v9 offset:25088
    s_waitcnt lgkmcnt(4)
    v_mfma_f32_32x32x16_bf16 v[96:111], v[40:43], a[44:47], v[96:111]
    ds_read_b64_tr_b16 v[32:33], v8 offset:30720
    ds_read_b64_tr_b16 v[34:35], v8 offset:31232
    buffer_load_dwordx4 a[84:87], v1, s[16:19], s33 offen offset:1024 sc1
    v_mfma_f32_32x32x16_bf16 v[112:127], v[44:47], a[44:47], v[112:127]
    ds_read_b64_tr_b16 v[36:37], v9 offset:30720
    ds_read_b64_tr_b16 v[38:39], v9 offset:31232
    s_waitcnt lgkmcnt(4)
    v_mfma_f32_32x32x16_bf16 v[96:111], v[24:27], a[48:51], v[96:111]
    ds_read_b64_tr_b16 v[40:41], v8 offset:36864
    ds_read_b64_tr_b16 v[42:43], v8 offset:37376
    buffer_load_dwordx4 a[88:91], v1, s[16:19], s33 offen offset:2048 sc1
    v_mfma_f32_32x32x16_bf16 v[112:127], v[28:31], a[48:51], v[112:127]
    ds_read_b64_tr_b16 v[44:45], v9 offset:36864
    ds_read_b64_tr_b16 v[46:47], v9 offset:37376
    s_waitcnt lgkmcnt(4)
    v_mfma_f32_32x32x16_bf16 v[96:111], v[32:35], a[52:55], v[96:111]
    ds_read_b64_tr_b16 v[24:25], v8 offset:43008
    ds_read_b64_tr_b16 v[26:27], v8 offset:43520
    buffer_load_dwordx4 a[92:95], v1, s[16:19], s33 offen offset:3072 sc1
    v_mfma_f32_32x32x16_bf16 v[112:127], v[36:39], a[52:55], v[112:127]
    ds_read_b64_tr_b16 v[28:29], v9 offset:43008
    ds_read_b64_tr_b16 v[30:31], v9 offset:43520
    s_waitcnt vmcnt(10)
    s_cmp_lg_u32 s3, 0
    s_cbranch_scc1 L_w0_16
    s_waitcnt vmcnt(12)
    v_cmp_eq_u32 vcc, 0, v248
    s_cbranch_vccnz L_slow_19
L_ok_17:
L_w0_16:
    s_barrier
    s_waitcnt lgkmcnt(4)
    v_mfma_f32_32x32x16_bf16 v[96:111], v[40:43], a[56:59], v[96:111]
    v_add_u32 v8, 98304, v8
    ds_read_b64_tr_b16 v[32:33], v8 offset:0
    ds_read_b64_tr_b16 v[34:35], v8 offset:512
    s_add_u32 m0, s59, 0
    s_add_u32 s35, s60, 0
    buffer_load_dwordx4 v2, s[16:19], s35 offen sc1 lds
    v_mfma_f32_32x32x16_bf16 v[112:127], v[44:47], a[56:59], v[112:127]
    v_add_u32 v9, 98304, v9
    ds_read_b64_tr_b16 v[36:37], v9 offset:0
    ds_read_b64_tr_b16 v[38:39], v9 offset:512
    s_add_u32 m0, s59, 1024
    s_add_u32 s35, s60, 16384
    s_waitcnt lgkmcnt(4)
    v_mfma_f32_32x32x16_bf16 v[96:111], v[24:27], a[60:63], v[96:111]
    ds_read_b64_tr_b16 v[40:41], v8 offset:6144
    ds_read_b64_tr_b16 v[42:43], v8 offset:6656
    buffer_load_dwordx4 v2, s[16:19], s35 offen sc1 lds
    s_add_u32 m0, s59, 2048
    s_add_u32 s35, s60, 32768
    v_mfma_f32_32x32x16_bf16 v[112:127], v[28:31], a[60:63], v[112:127]
    ds_read_b64_tr_b16 v[44:45], v9 offset:6144
    ds_read_b64_tr_b16 v[46:47], v9 offset:6656
    s_waitcnt lgkmcnt(4)
    v_mfma_f32_32x32x16_bf16 v[96:111], v[32:35], a[64:67], v[96:111]
    ds_read_b64_tr_b16 v[24:25], v8 offset:12288
    ds_read_b64_tr_b16 v[26:27], v8 offset:12800
    buffer_load_dwordx4 v2, s[16:19], s35 offen sc1 lds
    v_mfma_f32_32x32x16_bf16 v[112:127], v[36:39], a[64:67], v[112:127]
    ds_read_b64_tr_b16 v[28:29], v9 offset:12288
    ds_read_b64_tr_b16 v[30:31], v9 offset:12800
    s_waitcnt lgkmcnt(4)
    v_mfma_f32_32x32x16_bf16 v[96:111], v[40:43], a[68:71], v[96:111]
    ds_read_b64_tr_b16 v[32:33], v8 offset:18432
    ds_read_b64_tr_b16 v[34:35], v8 offset:18944
    v_mfma_f32_32x32x16_bf16 v[112:127], v[44:47], a[68:71], v[112:127]
    ds_read_b64_tr_b16 v[36:37], v9 offset:18432
    ds_read_b64_tr_b16 v[38:39], v9 offset:18944
    s_waitcnt vmcnt(7)
    s_waitcnt vmcnt(3)
    s_barrier
    s_waitcnt lgkmcnt(4)
    v_mfma_f32_32x32x16_bf16 v[96:111], v[24:27], a[72:75], v[96:111]
    v_subrev_u32 v8, 49152, v8
    ds_read_b64_tr_b16 v[40:41], v8 offset:0
    ds_read_b64_tr_b16 v[42:43], v8 offset:512
    buffer_load_dwordx4 v[48:51], v242, s[20:23], s47 offen offset:0
    v_mfma_f32_32x32x16_bf16 v[112:127], v[28:31], a[72:75], v[112:127]
    v_subrev_u32 v9, 49152, v9
    ds_read_b64_tr_b16 v[44:45], v9 offset:0
    ds_read_b64_tr_b16 v[46:47], v9 offset:512
    buffer_load_dwordx4 v[52:55], v242, s[20:23], s47 offen offset:32
    s_waitcnt lgkmcnt(4)
    v_mfma_f32_32x32x16_bf16 v[96:111], v[32:35], a[76:79], v[96:111]
    ds_read_b64_tr_b16 v[24:25], v8 offset:6144
    ds_read_b64_tr_b16 v[26:27], v8 offset:6656
    buffer_load_dwordx4 v[56:59], v242, s[20:23], s47 offen offset:64
    v_mfma_f32_32x32x16_bf16 v[112:127], v[36:39], a[76:79], v[112:127]
    ds_read_b64_tr_b16 v[28:29], v9 offset:6144
    ds_read_b64_tr_b16 v[30:31], v9 offset:6656
    s_waitcnt lgkmcnt(4)
    v_mfma_f32_32x32x16_bf16 v[96:111], v[40:43], a[80:83], v[96:111]
    ds_read_b64_tr_b16 v[32:33], v8 offset:12288
    ds_read_b64_tr_b16 v[34:35], v8 offset:12800
    v_mfma_f32_32x32x16_bf16 v[112:127], v[44:47], a[80:83], v[112:127]
    ds_read_b64_tr_b16 v[36:37], v9 offset:12288
    ds_read_b64_tr_b16 v[38:39], v9 offset:12800
    s_waitcnt lgkmcnt(4)
    v_mfma_f32_32x32x16_bf16 v[96:111], v[24:27], a[84:87], v[96:111]
    ds_read_b64_tr_b16 v[40:41], v8 offset:18432
    ds_read_b64_tr_b16 v[42:43], v8 offset:18944
    v_mfma_f32_32x32x16_bf16 v[112:127], v[28:31], a[84:87], v[112:127]
    ds_read_b64_tr_b16 v[44:45], v9 offset:18432
    ds_read_b64_tr_b16 v[46:47], v9 offset:18944
    s_waitcnt lgkmcnt(4)
    v_mfma_f32_32x32x16_bf16 v[96:111], v[32:35], a[88:91], v[96:111]
    v_add_u32 v10, 49152, v10
    ds_read_b64_tr_b16 v[24:25], v10 offset:24576
    ds_read_b64_tr_b16 v[26:27], v10 offset:25088
    v_mfma_f32_32x32x16_bf16 v[112:127], v[36:39], a[88:91], v[112:127]
    ds_read_b64_tr_b16 v[28:29], v10 offset:30720
    ds_read_b64_tr_b16 v[30:31], v10 offset:31232
    s_waitcnt lgkmcnt(4)
    v_mfma_f32_32x32x16_bf16 v[96:111], v[40:43], a[92:95], v[96:111]
    ds_read_b64_tr_b16 v[32:33], v10 offset:36864
    ds_read_b64_tr_b16 v[34:35], v10 offset:37376
    v_mfma_f32_32x32x16_bf16 v[112:127], v[44:47], a[92:95], v[112:127]
    ds_read_b64_tr_b16 v[36:37], v10 offset:43008
    ds_read_b64_tr_b16 v[38:39], v10 offset:43520
    s_waitcnt lgkmcnt(4)
    v_mfma_f32_32x32x16_bf16 v[128:143], v[24:27], a[0:3], v[128:143]
    v_subrev_u32 v10, 49152, v10
    ds_read_b64_tr_b16 v[40:41], v10 offset:24576
    ds_read_b64_tr_b16 v[42:43], v10 offset:25088
    v_mfma_f32_32x32x16_bf16 v[128:143], v[28:31], a[4:7], v[128:143]
    ds_read_b64_tr_b16 v[44:45], v10 offset:30720
    ds_read_b64_tr_b16 v[46:47], v10 offset:31232
    s_waitcnt lgkmcnt(4)
    v_mfma_f32_32x32x16_bf16 v[128:143], v[32:35], a[8:11], v[128:143]
    ds_read_b64_tr_b16 v[24:25], v10 offset:36864
    ds_read_b64_tr_b16 v[26:27], v10 offset:37376
    v_cvt_pk_bf16_f32 v96, v96, v97
    v_cvt_pk_bf16_f32 v97, v98, v99
    v_cvt_pk_bf16_f32 v98, v100, v101
    v_mfma_f32_32x32x16_bf16 v[128:143], v[36:39], a[12:15], v[128:143]
    ds_read_b64_tr_b16 v[28:29], v10 offset:43008
    ds_read_b64_tr_b16 v[30:31], v10 offset:43520
    v_cvt_pk_bf16_f32 v99, v102, v103
    v_cvt_pk_bf16_f32 v100, v104, v105
    v_cvt_pk_bf16_f32 v101, v106, v107
    s_waitcnt lgkmcnt(4)
    v_mfma_f32_32x32x16_bf16 v[128:143], v[40:43], a[16:19], v[128:143]
    v_subrev_u32 v10, 49152, v10
    ds_read_b64_tr_b16 v[32:33], v10 offset:0
    ds_read_b64_tr_b16 v[34:35], v10 offset:512
    buffer_store_dwordx4 v[96:99], v1, s[16:19], s55 offen offset:0 sc1
    v_cvt_pk_bf16_f32 v102, v108, v109
    v_cvt_pk_bf16_f32 v103, v110, v111
    v_mfma_f32_32x32x16_bf16 v[128:143], v[44:47], a[20:23], v[128:143]
    ds_read_b64_tr_b16 v[36:37], v10 offset:6144
    ds_read_b64_tr_b16 v[38:39], v10 offset:6656
    v_cvt_pk_bf16_f32 v104, v112, v113
    v_cvt_pk_bf16_f32 v105, v114, v115
    v_cvt_pk_bf16_f32 v106, v116, v117
    s_waitcnt lgkmcnt(4)
    v_mfma_f32_32x32x16_bf16 v[128:143], v[24:27], a[24:27], v[128:143]
    ds_read_b64_tr_b16 v[40:41], v10 offset:12288
    ds_read_b64_tr_b16 v[42:43], v10 offset:12800
    v_cvt_pk_bf16_f32 v107, v118, v119
    v_mfma_f32_32x32x16_bf16 v[128:143], v[28:31], a[28:31], v[128:143]
    ds_read_b64_tr_b16 v[44:45], v10 offset:18432
    ds_read_b64_tr_b16 v[46:47], v10 offset:18944
    s_waitcnt lgkmcnt(4)
    v_mfma_f32_32x32x16_bf16 v[128:143], v[32:35], a[32:35], v[128:143]
    ds_read_b64_tr_b16 v[24:25], v10 offset:24576
    ds_read_b64_tr_b16 v[26:27], v10 offset:25088
    v_mfma_f32_32x32x16_bf16 v[128:143], v[36:39], a[36:39], v[128:143]
    ds_read_b64_tr_b16 v[28:29], v10 offset:30720
    ds_read_b64_tr_b16 v[30:31], v10 offset:31232
    buffer_store_dwordx4 v[100:103], v1, s[16:19], s55 offen offset:1024 sc1
    s_waitcnt lgkmcnt(4)
    v_mfma_f32_32x32x16_bf16 v[128:143], v[40:43], a[40:43], v[128:143]
    ds_read_b64_tr_b16 v[32:33], v10 offset:36864
    ds_read_b64_tr_b16 v[34:35], v10 offset:37376
    v_mfma_f32_32x32x16_bf16 v[128:143], v[44:47], a[44:47], v[128:143]
    ds_read_b64_tr_b16 v[36:37], v10 offset:43008
    ds_read_b64_tr_b16 v[38:39], v10 offset:43520
    s_waitcnt lgkmcnt(4)
    v_mfma_f32_32x32x16_bf16 v[128:143], v[24:27], a[48:51], v[128:143]
    v_add_u32 v10, 98304, v10
    ds_read_b64_tr_b16 v[40:41], v10 offset:0
    ds_read_b64_tr_b16 v[42:43], v10 offset:512
    v_mfma_f32_32x32x16_bf16 v[128:143], v[28:31], a[52:55], v[128:143]
    ds_read_b64_tr_b16 v[44:45], v10 offset:6144
    ds_read_b64_tr_b16 v[46:47], v10 offset:6656
    s_waitcnt lgkmcnt(4)
    v_mfma_f32_32x32x16_bf16 v[128:143], v[32:35], a[56:59], v[128:143]
    ds_read_b64_tr_b16 v[24:25], v10 offset:12288
    ds_read_b64_tr_b16 v[26:27], v10 offset:12800
    buffer_store_dwordx4 v[104:107], v1, s[16:19], s55 offen offset:2048 sc1
    v_mfma_f32_32x32x16_bf16 v[128:143], v[36:39], a[60:63], v[128:143]
    ds_read_b64_tr_b16 v[28:29], v10 offset:18432
    ds_read_b64_tr_b16 v[30:31], v10 offset:18944
    s_waitcnt vmcnt(6)
    s_barrier
    s_waitcnt lgkmcnt(4)
    v_mfma_f32_32x32x16_bf16 v[128:143], v[40:43], a[64:67], v[128:143]
    v_subrev_u32 v10, 49152, v10
    ds_read_b64_tr_b16 v[32:33], v10 offset:0
    ds_read_b64_tr_b16 v[34:35], v10 offset:512
    ds_read_b64_tr_b16 v[200:201], v3 offset:8192
    v_mfma_f32_32x32x16_bf16 v[128:143], v[44:47], a[68:71], v[128:143]
    ds_read_b64_tr_b16 v[36:37], v10 offset:6144
    ds_read_b64_tr_b16 v[38:39], v10 offset:6656
    ds_read_b64_tr_b16 v[202:203], v3 offset:10240
    s_waitcnt lgkmcnt(6)
    v_mfma_f32_32x32x16_bf16 v[128:143], v[24:27], a[72:75], v[128:143]
    ds_read_b64_tr_b16 v[40:41], v10 offset:12288
    ds_read_b64_tr_b16 v[42:43], v10 offset:12800
    ds_read_b64_tr_b16 v[196:197], v3 offset:4096
    v_mfma_f32_32x32x16_bf16 v[128:143], v[28:31], a[76:79], v[128:143]
    ds_read_b64_tr_b16 v[44:45], v10 offset:18432
    ds_read_b64_tr_b16 v[46:47], v10 offset:18944
    ds_read_b64_tr_b16 v[198:199], v3 offset:6144
    s_waitcnt lgkmcnt(7)
    v_mfma_f32_32x32x16_bf16 v[128:143], v[32:35], a[80:83], v[128:143]
    v_add_u32 v11, 49152, v11
    ds_read_b64_tr_b16 v[24:25], v11 offset:24576
    ds_read_b64_tr_b16 v[26:27], v11 offset:25088
    ds_read_b64_tr_b16 v[192:193], v3 offset:0
    v_mfma_f32_32x32x16_bf16 v[128:143], v[36:39], a[84:87], v[128:143]
    v_add_u32 v16, 49152, v16
    ds_read_b64_tr_b16 v[28:29], v16 offset:24576
    ds_read_b64_tr_b16 v[30:31], v16 offset:25088
    ds_read_b64_tr_b16 v[194:195], v3 offset:2048
    s_waitcnt lgkmcnt(7)
    v_mfma_f32_32x32x16_bf16 v[128:143], v[40:43], a[88:91], v[128:143]
    ds_read_b64_tr_b16 v[32:33], v11 offset:30720
    ds_read_b64_tr_b16 v[34:35], v11 offset:31232
    s_waitcnt lgkmcnt(2)
    v_lshlrev_b32 v204, 16, v192
    v_and_b32 v205, 0xffff0000, v192
    v_mfma_f32_32x32x16_bf16 v[128:143], v[44:47], a[92:95], v[128:143]
    ds_read_b64_tr_b16 v[36:37], v16 offset:30720
    ds_read_b64_tr_b16 v[38:39], v16 offset:31232
    v_lshlrev_b32 v206, 16, v193
    v_and_b32 v207, 0xffff0000, v193
    v_lshlrev_b32 v208, 16, v194
    v_mfma_f32_32x32x16_bf16 v[144:159], v[24:27], a[0:3], v[144:159]
    ds_read_b64_tr_b16 v[40:41], v11 offset:36864
    ds_read_b64_tr_b16 v[42:43], v11 offset:37376
    v_and_b32 v209, 0xffff0000, v194
    v_lshlrev_b32 v210, 16, v195
    v_and_b32 v211, 0xffff0000, v195
    v_mfma_f32_32x32x16_bf16 v[160:175], v[28:31], a[0:3], v[160:175]
    ds_read_b64_tr_b16 v[44:45], v16 offset:36864
    ds_read_b64_tr_b16 v[46:47], v16 offset:37376
    v_lshlrev_b32 v212, 16, v196
    v_and_b32 v213, 0xffff0000, v196
    v_lshlrev_b32 v214, 16, v197
    s_waitcnt lgkmcnt(4)
    v_mfma_f32_32x32x16_bf16 v[144:159], v[32:35], a[4:7], v[144:159]
    ds_read_b64_tr_b16 v[24:25], v11 offset:43008
    ds_read_b64_tr_b16 v[26:27], v11 offset:43520
    v_cvt_pk_bf16_f32 v108, v120, v121
    v_cvt_pk_bf16_f32 v109, v122, v123
    v_cvt_pk_bf16_f32 v110, v124, v125
    v_mfma_f32_32x32x16_bf16 v[160:175], v[36:39], a[4:7], v[160:175]
    ds_read_b64_tr_b16 v[28:29], v16 offset:43008
    ds_read_b64_tr_b16 v[30:31], v16 offset:43520
    v_cvt_pk_bf16_f32 v111, v126, v127
    v_cvt_pk_bf16_f32 v112, v128, v129
    v_cvt_pk_bf16_f32 v113, v130, v131
    s_waitcnt lgkmcnt(4)
    v_mfma_f32_32x32x16_bf16 v[144:159], v[40:43], a[8:11], v[144:159]
    v_subrev_u32 v11, 49152, v11
    ds_read_b64_tr_b16 v[32:33], v11 offset:24576
    ds_read_b64_tr_b16 v[34:35], v11 offset:25088
    buffer_store_dwordx4 v[108:111], v1, s[16:19], s56 offen offset:0 sc1
    v_cvt_pk_bf16_f32 v114, v132, v133
    v_cvt_pk_bf16_f32 v115, v134, v135
    v_mfma_f32_32x32x16_bf16 v[160:175], v[44:47], a[8:11], v[160:175]
    v_subrev_u32 v16, 49152, v16
    ds_read_b64_tr_b16 v[36:37], v16 offset:24576
    ds_read_b64_tr_b16 v[38:39], v16 offset:25088
    v_cvt_pk_bf16_f32 v116, v136, v137
    v_cvt_pk_bf16_f32 v117, v138, v139
    v_cvt_pk_bf16_f32 v118, v140, v141
    s_waitcnt lgkmcnt(4)
    v_mfma_f32_32x32x16_bf16 v[144:159], v[24:27], a[12:15], v[144:159]
    ds_read_b64_tr_b16 v[40:41], v11 offset:30720
    ds_read_b64_tr_b16 v[42:43], v11 offset:31232
    v_cvt_pk_bf16_f32 v119, v142, v143
    v_and_b32 v215, 0xffff0000, v197
    v_lshlrev_b32 v216, 16, v198
    v_mfma_f32_32x32x16_bf16 v[160:175], v[28:31], a[12:15], v[160:175]
    ds_read_b64_tr_b16 v[44:45], v16 offset:30720
    ds_read_b64_tr_b16 v[46:47], v16 offset:31232
    v_and_b32 v217, 0xffff0000, v198
    v_lshlrev_b32 v218, 16, v199
    v_and_b32 v219, 0xffff0000, v199
    s_waitcnt lgkmcnt(4)
    v_mfma_f32_32x32x16_bf16 v[144:159], v[32:35], a[16:19], v[144:159]
    ds_read_b64_tr_b16 v[24:25], v11 offset:36864
    ds_read_b64_tr_b16 v[26:27], v11 offset:37376
    v_lshlrev_b32 v220, 16, v200
    v_and_b32 v221, 0xffff0000, v200
    v_lshlrev_b32 v222, 16, v201
    v_mfma_f32_32x32x16_bf16 v[160:175], v[36:39], a[16:19], v[160:175]
    ds_read_b64_tr_b16 v[28:29], v16 offset:36864
    ds_read_b64_tr_b16 v[30:31], v16 offset:37376
    buffer_store_dwordx4 v[112:115], v1, s[16:19], s56 offen offset:1024 sc1
    v_and_b32 v223, 0xffff0000, v201
    v_lshlrev_b32 v224, 16, v202
    s_waitcnt lgkmcnt(4)
    v_mfma_f32_32x32x16_bf16 v[144:159], v[40:43], a[20:23], v[144:159]
    ds_read_b64_tr_b16 v[32:33], v11 offset:43008
    ds_read_b64_tr_b16 v[34:35], v11 offset:43520
    v_and_b32 v225, 0xffff0000, v202
    v_lshlrev_b32 v226, 16, v203
    v_and_b32 v227, 0xffff0000, v203
    v_mfma_f32_32x32x16_bf16 v[160:175], v[44:47], a[20:23], v[160:175]
    ds_read_b64_tr_b16 v[36:37], v16 offset:43008
    ds_read_b64_tr_b16 v[38:39], v16 offset:43520
    s_waitcnt lgkmcnt(4)
    v_mfma_f32_32x32x16_bf16 v[144:159], v[24:27], a[24:27], v[144:159]
    v_subrev_u32 v11, 49152, v11
    ds_read_b64_tr_b16 v[40:41], v11 offset:0
    ds_read_b64_tr_b16 v[42:43], v11 offset:512
    v_mfma_f32_32x32x16_bf16 v[160:175], v[28:31], a[24:27], v[160:175]
    v_subrev_u32 v16, 49152, v16
    ds_read_b64_tr_b16 v[44:45], v16 offset:0
    ds_read_b64_tr_b16 v[46:47], v16 offset:512
    s_waitcnt vmcnt(5)
    s_waitcnt lgkmcnt(4)
    v_mfma_f32_32x32x16_bf16 v[144:159], v[32:35], a[28:31], v[144:159]
    ds_read_b64_tr_b16 v[24:25], v11 offset:6144
    ds_read_b64_tr_b16 v[26:27], v11 offset:6656
    buffer_store_dwordx4 v[116:119], v1, s[16:19], s56 offen offset:2048 sc1
    v_permlane32_swap_b32 v48, v50
    v_permlane32_swap_b32 v49, v51
    v_mfma_f32_32x32x16_bf16 v[160:175], v[36:39], a[28:31], v[160:175]
    ds_read_b64_tr_b16 v[28:29], v16 offset:6144
    ds_read_b64_tr_b16 v[30:31], v16 offset:6656
    v_permlane32_swap_b32 v52, v54
    v_permlane32_swap_b32 v53, v55
    v_permlane32_swap_b32 v56, v58
    s_waitcnt lgkmcnt(4)
    v_mfma_f32_32x32x16_bf16 v[144:159], v[40:43], a[32:35], v[144:159]
    ds_read_b64_tr_b16 v[32:33], v11 offset:12288
    ds_read_b64_tr_b16 v[34:35], v11 offset:12800
    v_permlane32_swap_b32 v57, v59
    v_lshlrev_b32 v4, 16, v48
    v_and_b32 v48, 0xffff0000, v48
    v_mfma_f32_32x32x16_bf16 v[160:175], v[44:47], a[32:35], v[160:175]
    ds_read_b64_tr_b16 v[36:37], v16 offset:12288
    ds_read_b64_tr_b16 v[38:39], v16 offset:12800
    v_add_f32 v204, v204, v4
    v_add_f32 v205, v205, v48
    v_lshlrev_b32 v4, 16, v49
    s_waitcnt lgkmcnt(4)
    v_mfma_f32_32x32x16_bf16 v[144:159], v[24:27], a[36:39], v[144:159]
    ds_read_b64_tr_b16 v[40:41], v11 offset:18432
    ds_read_b64_tr_b16 v[42:43], v11 offset:18944
    v_and_b32 v49, 0xffff0000, v49
    v_add_f32 v206, v206, v4
    v_add_f32 v207, v207, v49
    v_mfma_f32_32x32x16_bf16 v[160:175], v[28:31], a[36:39], v[160:175]
    ds_read_b64_tr_b16 v[44:45], v16 offset:18432
    ds_read_b64_tr_b16 v[46:47], v16 offset:18944
    v_lshlrev_b32 v4, 16, v50
    v_and_b32 v50, 0xffff0000, v50
    v_add_f32 v208, v208, v4
    s_waitcnt lgkmcnt(4)
    v_mfma_f32_32x32x16_bf16 v[144:159], v[32:35], a[40:43], v[144:159]
    ds_read_b64_tr_b16 v[24:25], v11 offset:24576
    ds_read_b64_tr_b16 v[26:27], v11 offset:25088
    v_add_f32 v209, v209, v50
    v_lshlrev_b32 v4, 16, v51
    v_and_b32 v51, 0xffff0000, v51
    v_mfma_f32_32x32x16_bf16 v[160:175], v[36:39], a[40:43], v[160:175]
    ds_read_b64_tr_b16 v[28:29], v16 offset:24576
    ds_read_b64_tr_b16 v[30:31], v16 offset:25088
    v_add_f32 v210, v210, v4
    v_add_f32 v211, v211, v51
    v_lshlrev_b32 v4, 16, v52
    s_waitcnt lgkmcnt(4)
    v_mfma_f32_32x32x16_bf16 v[144:159], v[40:43], a[44:47], v[144:159]
    ds_read_b64_tr_b16 v[32:33], v11 offset:30720
    ds_read_b64_tr_b16 v[34:35], v11 offset:31232
    v_and_b32 v52, 0xffff0000, v52
    v_add_f32 v212, v212, v4
    v_add_f32 v213, v213, v52
    v_mfma_f32_32x32x16_bf16 v[160:175], v[44:47], a[44:47], v[160:175]
    ds_read_b64_tr_b16 v[36:37], v16 offset:30720
    ds_read_b64_tr_b16 v[38:39], v16 offset:31232
    v_lshlrev_b32 v4, 16, v53
    v_and_b32 v53, 0xffff0000, v53
    v_add_f32 v214, v214, v4
    s_waitcnt lgkmcnt(4)
    v_mfma_f32_32x32x16_bf16 v[144:159], v[24:27], a[48:51], v[144:159]
    ds_read_b64_tr_b16 v[40:41], v11 offset:36864
    ds_read_b64_tr_b16 v[42:43], v11 offset:37376
    v_add_f32 v215, v215, v53
    v_lshlrev_b32 v4, 16, v54
    v_and_b32 v54, 0xffff0000, v54
    v_mfma_f32_32x32x16_bf16 v[160:175], v[28:31], a[48:51], v[160:175]
    ds_read_b64_tr_b16 v[44:45], v16 offset:36864
    ds_read_b64_tr_b16 v[46:47], v16 offset:37376
    v_add_f32 v216, v216, v4
    v_add_f32 v217, v217, v54
    v_lshlrev_b32 v4, 16, v55
    s_waitcnt lgkmcnt(4)
    v_mfma_f32_32x32x16_bf16 v[144:159], v[32:35], a[52:55], v[144:159]
    ds_read_b64_tr_b16 v[24:25], v11 offset:43008
    ds_read_b64_tr_b16 v[26:27], v11 offset:43520
    v_and_b32 v55, 0xffff0000, v55
    v_add_f32 v218, v218, v4
    v_add_f32 v219, v219, v55
    v_mfma_f32_32x32x16_bf16 v[160:175], v[36:39], a[52:55], v[160:175]
    ds_read_b64_tr_b16 v[28:29], v16 offset:43008
    ds_read_b64_tr_b16 v[30:31], v16 offset:43520
    v_lshlrev_b32 v4, 16, v56
    v_and_b32 v56, 0xffff0000, v56
    v_add_f32 v220, v220, v4
    s_waitcnt lgkmcnt(4)
    v_mfma_f32_32x32x16_bf16 v[144:159], v[40:43], a[56:59], v[144:159]
    v_add_u32 v11, 98304, v11
    ds_read_b64_tr_b16 v[32:33], v11 offset:0
    ds_read_b64_tr_b16 v[34:35], v11 offset:512
    v_add_f32 v221, v221, v56
    v_lshlrev_b32 v4, 16, v57
    v_and_b32 v57, 0xffff0000, v57
    v_mfma_f32_32x32x16_bf16 v[160:175], v[44:47], a[56:59], v[160:175]
    v_add_u32 v16, 98304, v16
    ds_read_b64_tr_b16 v[36:37], v16 offset:0
    ds_read_b64_tr_b16 v[38:39], v16 offset:512
    v_add_f32 v222, v222, v4
    v_add_f32 v223, v223, v57
    v_lshlrev_b32 v4, 16, v58
    s_waitcnt lgkmcnt(4)
    v_mfma_f32_32x32x16_bf16 v[144:159], v[24:27], a[60:63], v[144:159]
    ds_read_b64_tr_b16 v[40:41], v11 offset:6144
    ds_read_b64_tr_b16 v[42:43], v11 offset:6656
    v_and_b32 v58, 0xffff0000, v58
    v_add_f32 v224, v224, v4
    v_add_f32 v225, v225, v58
    v_mfma_f32_32x32x16_bf16 v[160:175], v[28:31], a[60:63], v[160:175]
    ds_read_b64_tr_b16 v[44:45], v16 offset:6144
    ds_read_b64_tr_b16 v[46:47], v16 offset:6656
    v_lshlrev_b32 v4, 16, v59
    v_and_b32 v59, 0xffff0000, v59
    v_add_f32 v226, v226, v4
    s_waitcnt lgkmcnt(4)
    v_mfma_f32_32x32x16_bf16 v[144:159], v[32:35], a[64:67], v[144:159]
    ds_read_b64_tr_b16 v[24:25], v11 offset:12288
    ds_read_b64_tr_b16 v[26:27], v11 offset:12800
    v_add_f32 v227, v227, v59
    v_mfma_f32_32x32x16_bf16 v[160:175], v[36:39], a[64:67], v[160:175]
    ds_read_b64_tr_b16 v[28:29], v16 offset:12288
    ds_read_b64_tr_b16 v[30:31], v16 offset:12800
    s_waitcnt lgkmcnt(4)
    v_mfma_f32_32x32x16_bf16 v[144:159], v[40:43], a[68:71], v[144:159]
    ds_read_b64_tr_b16 v[32:33], v11 offset:18432
    ds_read_b64_tr_b16 v[34:35], v11 offset:18944
    v_mfma_f32_32x32x16_bf16 v[160:175], v[44:47], a[68:71], v[160:175]
    ds_read_b64_tr_b16 v[36:37], v16 offset:18432
    ds_read_b64_tr_b16 v[38:39], v16 offset:18944
    s_waitcnt lgkmcnt(4)
    v_mfma_f32_32x32x16_bf16 v[144:159], v[24:27], a[72:75], v[144:159]
    v_subrev_u32 v11, 49152, v11
    ds_read_b64_tr_b16 v[40:41], v11 offset:0
    ds_read_b64_tr_b16 v[42:43], v11 offset:512
    s_add_u32 s33, s58, 0
    buffer_load_dwordx4 v[120:123], v1, s[16:19], s33 offen offset:0 sc1
    v_mfma_f32_32x32x16_bf16 v[160:175], v[28:31], a[72:75], v[160:175]
    v_subrev_u32 v16, 49152, v16
    ds_read_b64_tr_b16 v[44:45], v16 offset:0
    ds_read_b64_tr_b16 v[46:47], v16 offset:512
    buffer_load_dwordx4 v[124:127], v1, s[16:19], s33 offen offset:1024 sc1
    s_waitcnt lgkmcnt(4)
    v_mfma_f32_32x32x16_bf16 v[144:159], v[32:35], a[76:79], v[144:159]
    ds_read_b64_tr_b16 v[24:25], v11 offset:6144
    ds_read_b64_tr_b16 v[26:27], v11 offset:6656
    buffer_load_dwordx4 v[128:131], v1, s[16:19], s33 offen offset:2048 sc1
    v_mfma_f32_32x32x16_bf16 v[160:175], v[36:39], a[76:79], v[160:175]
    ds_read_b64_tr_b16 v[28:29], v16 offset:6144
    ds_read_b64_tr_b16 v[30:31], v16 offset:6656
    s_waitcnt lgkmcnt(4)
    v_mfma_f32_32x32x16_bf16 v[144:159], v[40:43], a[80:83], v[144:159]
    ds_read_b64_tr_b16 v[32:33], v11 offset:12288
    ds_read_b64_tr_b16 v[34:35], v11 offset:12800
    s_add_u32 s33, s58, 3072
    buffer_load_dwordx4 v[132:135], v1, s[16:19], s33 offen offset:0 sc1
    v_mfma_f32_32x32x16_bf16 v[160:175], v[44:47], a[80:83], v[160:175]
    ds_read_b64_tr_b16 v[36:37], v16 offset:12288
    ds_read_b64_tr_b16 v[38:39], v16 offset:12800
    s_waitcnt lgkmcnt(4)
    v_mfma_f32_32x32x16_bf16 v[144:159], v[24:27], a[84:87], v[144:159]
    ds_read_b64_tr_b16 v[40:41], v11 offset:18432
    ds_read_b64_tr_b16 v[42:43], v11 offset:18944
    buffer_load_dwordx4 v[136:139], v1, s[16:19], s33 offen offset:1024 sc1
    v_mfma_f32_32x32x16_bf16 v[160:175], v[28:31], a[84:87], v[160:175]
    ds_read_b64_tr_b16 v[44:45], v16 offset:18432
    ds_read_b64_tr_b16 v[46:47], v16 offset:18944
    s_waitcnt lgkmcnt(4)
    v_mfma_f32_32x32x16_bf16 v[144:159], v[32:35], a[88:91], v[144:159]
    v_add_u32 v17, 49152, v17
    ds_read_b64_tr_b16 v[24:25], v17 offset:24576
    ds_read_b64_tr_b16 v[26:27], v17 offset:25088
    buffer_load_dwordx4 v[140:143], v1, s[16:19], s33 offen offset:2048 sc1
    v_mfma_f32_32x32x16_bf16 v[160:175], v[36:39], a[88:91], v[160:175]
    ds_read_b64_tr_b16 v[28:29], v17 offset:30720
    ds_read_b64_tr_b16 v[30:31], v17 offset:31232
    s_waitcnt lgkmcnt(4)
    v_mfma_f32_32x32x16_bf16 v[144:159], v[40:43], a[92:95], v[144:159]
    ds_read_b64_tr_b16 v[32:33], v17 offset:36864
    ds_read_b64_tr_b16 v[34:35], v17 offset:37376
    v_mfma_f32_32x32x16_bf16 v[160:175], v[44:47], a[92:95], v[160:175]
    ds_read_b64_tr_b16 v[36:37], v17 offset:43008
    ds_read_b64_tr_b16 v[38:39], v17 offset:43520
    s_waitcnt lgkmcnt(4)
    v_mfma_f32_32x32x16_bf16 v[176:191], v[24:27], a[0:3], v[176:191]
    v_subrev_u32 v17, 49152, v17
    ds_read_b64_tr_b16 v[40:41], v17 offset:24576
    ds_read_b64_tr_b16 v[42:43], v17 offset:25088
    v_mfma_f32_32x32x16_bf16 v[176:191], v[28:31], a[4:7], v[176:191]
    ds_read_b64_tr_b16 v[44:45], v17 offset:30720
    ds_read_b64_tr_b16 v[46:47], v17 offset:31232
    v_cvt_pk_bf16_f32 v144, v144, v145
    v_cvt_pk_bf16_f32 v145, v146, v147
L_pg8:
    s_cbranch_execz L_pgret
    v_cvt_pk_bf16_f32 v146, v148, v149
    s_waitcnt lgkmcnt(4)
    v_mfma_f32_32x32x16_bf16 v[176:191], v[32:35], a[8:11], v[176:191]
    ds_read_b64_tr_b16 v[24:25], v17 offset:36864
    ds_read_b64_tr_b16 v[26:27], v17 offset:37376
    v_cvt_pk_bf16_f32 v147, v150, v151
    v_cvt_pk_bf16_f32 v148, v152, v153
    v_cvt_pk_bf16_f32 v149, v154, v155
    v_mfma_f32_32x32x16_bf16 v[176:191], v[36:39], a[12:15], v[176:191]
    ds_read_b64_tr_b16 v[28:29], v17 offset:43008
    ds_read_b64_tr_b16 v[30:31], v17 offset:43520
    buffer_store_dwordx4 v[144:147], v1, s[16:19], s57 offen offset:0 sc1
    v_cvt_pk_bf16_f32 v150, v156, v157
    v_cvt_pk_bf16_f32 v151, v158, v159
    s_waitcnt lgkmcnt(4)
    v_mfma_f32_32x32x16_bf16 v[176:191], v[40:43], a[16:19], v[176:191]
    v_subrev_u32 v17, 49152, v17
    ds_read_b64_tr_b16 v[32:33], v17 offset:0
    ds_read_b64_tr_b16 v[34:35], v17 offset:512
    v_cvt_pk_bf16_f32 v152, v160, v161
    v_cvt_pk_bf16_f32 v153, v162, v163
    v_cvt_pk_bf16_f32 v154, v164, v165
    v_mfma_f32_32x32x16_bf16 v[176:191], v[44:47], a[20:23], v[176:191]
    ds_read_b64_tr_b16 v[36:37], v17 offset:6144
    ds_read_b64_tr_b16 v[38:39], v17 offset:6656
    buffer_store_dwordx4 v[148:151], v1, s[16:19], s57 offen offset:1024 sc1
    v_cvt_pk_bf16_f32 v155, v166, v167
    v_fma_f32 v204, v168, v252, v204
    s_waitcnt lgkmcnt(4)
    v_mfma_f32_32x32x16_bf16 v[176:191], v[24:27], a[24:27], v[176:191]
    ds_read_b64_tr_b16 v[40:41], v17 offset:12288
    ds_read_b64_tr_b16 v[42:43], v17 offset:12800
    v_fma_f32 v205, v169, v252, v205
    v_fma_f32 v206, v170, v252, v206
    v_fma_f32 v207, v171, v252, v207
    v_mfma_f32_32x32x16_bf16 v[176:191], v[28:31], a[28:31], v[176:191]
    ds_read_b64_tr_b16 v[44:45], v17 offset:18432
    ds_read_b64_tr_b16 v[46:47], v17 offset:18944
    buffer_store_dwordx4 v[152:155], v1, s[16:19], s57 offen offset:2048 sc1
    v_fma_f32 v208, v172, v252, v208
    v_fma_f32 v209, v173, v252, v209
    s_waitcnt lgkmcnt(4)
    v_mfma_f32_32x32x16_bf16 v[176:191], v[32:35], a[32:35], v[176:191]
    ds_read_b64_tr_b16 v[24:25], v17 offset:24576
    ds_read_b64_tr_b16 v[26:27], v17 offset:25088
    v_fma_f32 v210, v174, v252, v210
    v_fma_f32 v211, v175, v252, v211
    v_mfma_f32_32x32x16_bf16 v[176:191], v[36:39], a[36:39], v[176:191]
    ds_read_b64_tr_b16 v[28:29], v17 offset:30720
    ds_read_b64_tr_b16 v[30:31], v17 offset:31232
    s_waitcnt lgkmcnt(4)
    v_mfma_f32_32x32x16_bf16 v[176:191], v[40:43], a[40:43], v[176:191]
    ds_read_b64_tr_b16 v[32:33], v17 offset:36864
    ds_read_b64_tr_b16 v[34:35], v17 offset:37376
    v_mfma_f32_32x32x16_bf16 v[176:191], v[44:47], a[44:47], v[176:191]
    ds_read_b64_tr_b16 v[36:37], v17 offset:43008
    ds_read_b64_tr_b16 v[38:39], v17 offset:43520
    s_waitcnt lgkmcnt(4)
    v_mfma_f32_32x32x16_bf16 v[176:191], v[24:27], a[48:51], v[176:191]
    v_add_u32 v17, 98304, v17
    ds_read_b64_tr_b16 v[40:41], v17 offset:0
    ds_read_b64_tr_b16 v[42:43], v17 offset:512
    v_mfma_f32_32x32x16_bf16 v[176:191], v[28:31], a[52:55], v[176:191]
    ds_read_b64_tr_b16 v[44:45], v17 offset:6144
    ds_read_b64_tr_b16 v[46:47], v17 offset:6656
    s_waitcnt lgkmcnt(4)
    v_mfma_f32_32x32x16_bf16 v[176:191], v[32:35], a[56:59], v[176:191]
    ds_read_b64_tr_b16 v[24:25], v17 offset:12288
    ds_read_b64_tr_b16 v[26:27], v17 offset:12800
    v_mfma_f32_32x32x16_bf16 v[176:191], v[36:39], a[60:63], v[176:191]
    ds_read_b64_tr_b16 v[28:29], v17 offset:18432
    ds_read_b64_tr_b16 v[30:31], v17 offset:18944
    s_waitcnt lgkmcnt(4)
    v_mfma_f32_32x32x16_bf16 v[176:191], v[40:43], a[64:67], v[176:191]
    v_subrev_u32 v17, 49152, v17
    ds_read_b64_tr_b16 v[32:33], v17 offset:0
    ds_read_b64_tr_b16 v[34:35], v17 offset:512
    v_mfma_f32_32x32x16_bf16 v[176:191], v[44:47], a[68:71], v[176:191]
    ds_read_b64_tr_b16 v[36:37], v17 offset:6144
    ds_read_b64_tr_b16 v[38:39], v17 offset:6656
    s_waitcnt lgkmcnt(4)
    v_mfma_f32_32x32x16_bf16 v[176:191], v[24:27], a[72:75], v[176:191]
    ds_read_b64_tr_b16 v[40:41], v17 offset:12288
    ds_read_b64_tr_b16 v[42:43], v17 offset:12800
    v_mfma_f32_32x32x16_bf16 v[176:191], v[28:31], a[76:79], v[176:191]
    ds_read_b64_tr_b16 v[44:45], v17 offset:18432
    ds_read_b64_tr_b16 v[46:47], v17 offset:18944
    s_waitcnt lgkmcnt(4)
    v_mfma_f32_32x32x16_bf16 v[176:191], v[32:35], a[80:83], v[176:191]
    v_mfma_f32_32x32x16_bf16 v[176:191], v[36:39], a[84:87], v[176:191]
    s_waitcnt vmcnt(3)
    v_max3_u32 v20, v120, v124, v128
    v_max3_u32 v21, v132, v136, v140
    v_max_u32 v20, v20, v21
    v_cmp_eq_u32 vcc, -1, v20
    s_cbranch_vccnz L_slow_22
L_ok_20:
    s_waitcnt lgkmcnt(0)
    v_mfma_f32_32x32x16_bf16 v[176:191], v[40:43], a[88:91], v[176:191]
    v_lshlrev_b32 v4, 16, v120
    v_and_b32 v120, 0xffff0000, v120
    v_fma_f32 v204, v4, v252, v204
    v_fma_f32 v205, v120, v252, v205
    v_lshlrev_b32 v4, 16, v121
    v_mfma_f32_32x32x16_bf16 v[176:191], v[44:47], a[92:95], v[176:191]
    v_and_b32 v121, 0xffff0000, v121
    v_fma_f32 v206, v4, v252, v206
    v_fma_f32 v207, v121, v252, v207
    v_lshlrev_b32 v4, 16, v122
    v_and_b32 v122, 0xffff0000, v122
    v_mfma_f32_32x32x16_bf16 v[176:191], a[96:99], a[144:147], v[176:191]
    v_fma_f32 v208, v4, v252, v208
    v_fma_f32 v209, v122, v252, v209
    v_lshlrev_b32 v4, 16, v123
    v_and_b32 v123, 0xffff0000, v123
    v_fma_f32 v210, v4, v252, v210
    v_mfma_f32_32x32x16_bf16 v[176:191], a[100:103], a[148:151], v[176:191]
    v_fma_f32 v211, v123, v252, v211
    v_lshlrev_b32 v4, 16, v124
    v_and_b32 v124, 0xffff0000, v124
    v_fma_f32 v212, v4, v252, v212
    v_fma_f32 v213, v124, v252, v213
    v_mfma_f32_32x32x16_bf16 v[176:191], a[104:107], a[152:155], v[176:191]
    s_add_u32 s34, s58, 6144
    buffer_load_dwordx4 v[228:231], v1, s[16:19], s34 offen offset:0 sc1
    v_lshlrev_b32 v4, 16, v125
    v_and_b32 v125, 0xffff0000, v125
    v_fma_f32 v214, v4, v252, v214
    v_mfma_f32_32x32x16_bf16 v[176:191], a[108:111], a[156:159], v[176:191]
    buffer_load_dwordx4 v[232:235], v1, s[16:19], s34 offen offset:1024 sc1
    v_fma_f32 v215, v125, v252, v215
    v_lshlrev_b32 v4, 16, v126
    v_and_b32 v126, 0xffff0000, v126
    v_fma_f32 v216, v4, v252, v216
    v_mfma_f32_32x32x16_bf16 v[176:191], a[112:115], a[160:163], v[176:191]
    buffer_load_dwordx4 v[236:239], v1, s[16:19], s34 offen offset:2048 sc1
    v_fma_f32 v217, v126, v252, v217
    v_lshlrev_b32 v4, 16, v127
    v_and_b32 v127, 0xffff0000, v127
    v_fma_f32 v218, v4, v252, v218
    v_mfma_f32_32x32x16_bf16 v[176:191], a[116:119], a[164:167], v[176:191]
    v_fma_f32 v219, v127, v252, v219
    v_lshlrev_b32 v4, 16, v128
    v_and_b32 v128, 0xffff0000, v128
    v_fma_f32 v220, v4, v252, v220
    v_fma_f32 v221, v128, v252, v221
    v_mfma_f32_32x32x16_bf16 v[176:191], a[120:123], a[168:171], v[176:191]
    v_lshlrev_b32 v4, 16, v129
    v_and_b32 v129, 0xffff0000, v129
    v_fma_f32 v222, v4, v252, v222
    v_fma_f32 v223, v129, v252, v223
    v_lshlrev_b32 v4, 16, v130
    v_mfma_f32_32x32x16_bf16 v[176:191], a[124:127], a[172:175], v[176:191]
    v_and_b32 v130, 0xffff0000, v130
    v_fma_f32 v224, v4, v252, v224
    v_fma_f32 v225, v130, v252, v225
    v_lshlrev_b32 v4, 16, v131
    v_and_b32 v131, 0xffff0000, v131
    v_mfma_f32_32x32x16_bf16 v[176:191], a[128:131], a[176:179], v[176:191]
    v_fma_f32 v226, v4, v252, v226
    v_fma_f32 v227, v131, v252, v227
    v_lshlrev_b32 v4, 16, v132
    v_and_b32 v132, 0xffff0000, v132
    v_fma_f32 v204, v4, v252, v204
    v_mfma_f32_32x32x16_bf16 v[176:191], a[132:135], a[180:183], v[176:191]
    v_fma_f32 v205, v132, v252, v205
    v_lshlrev_b32 v4, 16, v133
    v_and_b32 v133, 0xffff0000, v133
    v_fma_f32 v206, v4, v252, v206
    v_fma_f32 v207, v133, v252, v207
    v_mfma_f32_32x32x16_bf16 v[176:191], a[136:139], a[184:187], v[176:191]
    v_lshlrev_b32 v4, 16, v134
    v_and_b32 v134, 0xffff0000, v134
    v_fma_f32 v208, v4, v252, v208
    v_fma_f32 v209, v134, v252, v209
    v_lshlrev_b32 v4, 16, v135
    v_mfma_f32_32x32x16_bf16 v[176:191], a[140:143], a[188:191], v[176:191]
    v_and_b32 v135, 0xffff0000, v135
    v_fma_f32 v210, v4, v252, v210
    v_fma_f32 v211, v135, v252, v211
    v_lshlrev_b32 v4, 16, v136
    v_and_b32 v136, 0xffff0000, v136
    v_mfma_f32_32x32x16_bf16 v[176:191], a[240:243], a[192:195], v[176:191]
    v_fma_f32 v212, v4, v252, v212
    v_fma_f32 v213, v136, v252, v213
    v_lshlrev_b32 v4, 16, v137
    v_and_b32 v137, 0xffff0000, v137
    v_fma_f32 v214, v4, v252, v214
    v_mfma_f32_32x32x16_bf16 v[176:191], a[244:247], a[196:199], v[176:191]
    v_fma_f32 v215, v137, v252, v215
    v_lshlrev_b32 v4, 16, v138
    v_and_b32 v138, 0xffff0000, v138
    v_fma_f32 v216, v4, v252, v216
    v_fma_f32 v217, v138, v252, v217
    v_mfma_f32_32x32x16_bf16 v[176:191], a[248:251], a[200:203], v[176:191]
    v_lshlrev_b32 v4, 16, v139
    v_and_b32 v139, 0xffff0000, v139
    v_fma_f32 v218, v4, v252, v218
    v_fma_f32 v219, v139, v252, v219
    v_lshlrev_b32 v4, 16, v140
    v_mfma_f32_32x32x16_bf16 v[176:191], a[252:255], a[204:207], v[176:191]
    v_and_b32 v140, 0xffff0000, v140
    v_fma_f32 v220, v4, v252, v220
    v_fma_f32 v221, v140, v252, v221
    v_lshlrev_b32 v4, 16, v141
    v_and_b32 v141, 0xffff0000, v141
    v_mfma_f32_32x32x16_bf16 v[176:191], v[64:67], a[208:211], v[176:191]
    v_fma_f32 v222, v4, v252, v222
    v_fma_f32 v223, v141, v252, v223
    v_lshlrev_b32 v4, 16, v142
    v_and_b32 v142, 0xffff0000, v142
    v_fma_f32 v224, v4, v252, v224
    v_mfma_f32_32x32x16_bf16 v[176:191], v[68:71], a[212:215], v[176:191]
    v_fma_f32 v225, v142, v252, v225
    v_lshlrev_b32 v4, 16, v143
    v_and_b32 v143, 0xffff0000, v143
    v_fma_f32 v226, v4, v252, v226
    v_fma_f32 v227, v143, v252, v227
    v_mfma_f32_32x32x16_bf16 v[176:191], v[72:75], a[216:219], v[176:191]
    v_mfma_f32_32x32x16_bf16 v[176:191], v[76:79], a[220:223], v[176:191]
    v_mfma_f32_32x32x16_bf16 v[176:191], v[80:83], a[224:227], v[176:191]
    v_mfma_f32_32x32x16_bf16 v[176:191], v[84:87], a[228:231], v[176:191]
    v_mfma_f32_32x32x16_bf16 v[176:191], v[88:91], a[232:235], v[176:191]
    v_mfma_f32_32x32x16_bf16 v[176:191], v[92:95], a[236:239], v[176:191]
    s_waitcnt vmcnt(0)
    v_max3_u32 v22, v228, v232, v236
    v_cmp_eq_u32 vcc, -1, v22
    s_cbranch_vccnz L_slow_25
L_ok_23:
    v_lshlrev_b32 v24, 16, v228
    v_and_b32 v25, 0xffff0000, v228
    v_lshlrev_b32 v26, 16, v229
    v_and_b32 v27, 0xffff0000, v229
    v_lshlrev_b32 v28, 16, v230
    v_and_b32 v29, 0xffff0000, v230
    v_lshlrev_b32 v30, 16, v231
    v_and_b32 v31, 0xffff0000, v231
    v_pk_fma_f32 v[24:25], v[24:25], v[252:253], v[204:205] op_sel_hi:[1,0,1]
    v_pk_fma_f32 v[26:27], v[26:27], v[252:253], v[206:207] op_sel_hi:[1,0,1]
    v_pk_fma_f32 v[28:29], v[28:29], v[252:253], v[208:209] op_sel_hi:[1,0,1]
    v_pk_fma_f32 v[30:31], v[30:31], v[252:253], v[210:211] op_sel_hi:[1,0,1]
    v_cvt_pk_bf16_f32 v228, v24, v25
    v_cvt_pk_bf16_f32 v230, v28, v29
    v_cvt_pk_bf16_f32 v229, v26, v27
    v_cvt_pk_bf16_f32 v231, v30, v31
    v_permlane32_swap_b32 v228, v230
    s_nop 0
    v_permlane32_swap_b32 v229, v231
    buffer_store_dwordx4 v[228:231], v242, s[24:27], s47 offen offset:0 nt
    v_pk_fma_f32 v[212:213], v[176:177], v[252:253], v[212:213] op_sel_hi:[1,0,1]
    v_pk_fma_f32 v[214:215], v[178:179], v[252:253], v[214:215] op_sel_hi:[1,0,1]
    v_pk_fma_f32 v[216:217], v[180:181], v[252:253], v[216:217] op_sel_hi:[1,0,1]
    v_pk_fma_f32 v[218:219], v[182:183], v[252:253], v[218:219] op_sel_hi:[1,0,1]
    v_lshlrev_b32 v24, 16, v232
    v_and_b32 v25, 0xffff0000, v232
    v_lshlrev_b32 v26, 16, v233
    v_and_b32 v27, 0xffff0000, v233
    v_lshlrev_b32 v28, 16, v234
    v_and_b32 v29, 0xffff0000, v234
    v_lshlrev_b32 v30, 16, v235
    v_and_b32 v31, 0xffff0000, v235
    v_pk_fma_f32 v[24:25], v[24:25], v[252:253], v[212:213] op_sel_hi:[1,0,1]
    v_pk_fma_f32 v[26:27], v[26:27], v[252:253], v[214:215] op_sel_hi:[1,0,1]
    v_pk_fma_f32 v[28:29], v[28:29], v[252:253], v[216:217] op_sel_hi:[1,0,1]
    v_pk_fma_f32 v[30:31], v[30:31], v[252:253], v[218:219] op_sel_hi:[1,0,1]
    v_cvt_pk_bf16_f32 v232, v24, v25
    v_cvt_pk_bf16_f32 v234, v28, v29
    v_cvt_pk_bf16_f32 v233, v26, v27
    v_cvt_pk_bf16_f32 v235, v30, v31
    v_permlane32_swap_b32 v232, v234
    s_nop 0
    v_permlane32_swap_b32 v233, v235
    buffer_store_dwordx4 v[232:235], v242, s[24:27], s47 offen offset:32 nt
    v_pk_fma_f32 v[220:221], v[184:185], v[252:253], v[220:221] op_sel_hi:[1,0,1]
    v_pk_fma_f32 v[222:223], v[186:187], v[252:253], v[222:223] op_sel_hi:[1,0,1]
    v_pk_fma_f32 v[224:225], v[188:189], v[252:253], v[224:225] op_sel_hi:[1,0,1]
    v_pk_fma_f32 v[226:227], v[190:191], v[252:253], v[226:227] op_sel_hi:[1,0,1]
    v_lshlrev_b32 v24, 16, v236
    v_and_b32 v25, 0xffff0000, v236
    v_lshlrev_b32 v26, 16, v237
    v_and_b32 v27, 0xffff0000, v237
    v_lshlrev_b32 v28, 16, v238
    v_and_b32 v29, 0xffff0000, v238
    v_lshlrev_b32 v30, 16, v239
    v_and_b32 v31, 0xffff0000, v239
    v_pk_fma_f32 v[24:25], v[24:25], v[252:253], v[220:221] op_sel_hi:[1,0,1]
    v_pk_fma_f32 v[26:27], v[26:27], v[252:253], v[222:223] op_sel_hi:[1,0,1]
    v_pk_fma_f32 v[28:29], v[28:29], v[252:253], v[224:225] op_sel_hi:[1,0,1]
    v_pk_fma_f32 v[30:31], v[30:31], v[252:253], v[226:227] op_sel_hi:[1,0,1]
    v_cvt_pk_bf16_f32 v236, v24, v25
    v_cvt_pk_bf16_f32 v238, v28, v29
    v_cvt_pk_bf16_f32 v237, v26, v27
    v_cvt_pk_bf16_f32 v239, v30, v31
    v_permlane32_swap_b32 v236, v238
    s_nop 0
    v_permlane32_swap_b32 v237, v239
    buffer_store_dwordx4 v[236:239], v242, s[24:27], s47 offen offset:64 nt
    s_endpgm
L_exit:
    s_endpgm
L_ssm:
    s_mov_b32 s83, s24
    s_add_u32 s2, s2, 192
    s_mov_b32 s84, s23
    s_lshl_b32 s66, s83, 3
    s_add_u32 s66, s66, s23
    v_lshrrev_b32 v28, 3, v0
    v_and_b32 v29, 7, v0
    s_and_b32 s68, s84, 1
    s_lshl_b32 s68, s68, 3
    s_add_u32 s68, s68, s83
    s_lshl_b32 s68, s68, 2
    s_lshr_b32 s33, s84, 1
    s_add_u32 s68, s68, s33
    v_mul_u32_u24 v30, 1152, v28
    v_lshl_add_u32 v30, v29, 4, v30
    s_mul_i32 s69, s68, 36864
    s_mul_i32 s33, s3, 9216
    s_add_u32 s69, s69, s33
    s_mov_b32 s24, s12
    s_mov_b32 s25, s13
    s_mov_b32 s26, s14
    s_mov_b32 s27, s15
    s_waitcnt lgkmcnt(0)
    s_mov_b32 s20, s36
    s_mov_b32 s21, s37
    s_mov_b32 s22, 0x240000
    s_mov_b32 s23, 0x00020000
    buffer_load_dwordx4 v[128:131], v30, s[20:23], s69 offen offset:0
    buffer_load_dwordx4 v[132:135], v30, s[20:23], s69 offen offset:128
    buffer_load_dwordx4 v[136:139], v30, s[20:23], s69 offen offset:256
    buffer_load_dwordx4 v[140:143], v30, s[20:23], s69 offen offset:384
    buffer_load_dwordx4 v[144:147], v30, s[20:23], s69 offen offset:512
    buffer_load_dwordx4 v[148:151], v30, s[20:23], s69 offen offset:640
    buffer_load_dwordx4 v[152:155], v30, s[20:23], s69 offen offset:768
    buffer_load_dwordx4 v[156:159], v30, s[20:23], s69 offen offset:896
    buffer_load_dwordx4 v[160:163], v30, s[20:23], s69 offen offset:1024
    s_mov_b32 s16, s64
    s_mov_b32 s17, s65
    s_mov_b32 s18, 0x2000000
    s_mov_b32 s19, 0x00020000
    s_mov_b32 s28, s62
    s_mov_b32 s29, s63
    s_mov_b32 s30, 0x100
    s_mov_b32 s31, 0x00020000
    s_mov_b32 s8, s56
    s_mov_b32 s9, s57
    s_mov_b32 s10, 0x510000
    s_mov_b32 s11, 0x00020000
    v_lshlrev_b32 v254, 2, v0
    v_lshlrev_b32 v33, 3, v0
    v_lshlrev_b32 v1, 4, v0
    v_mov_b32 v24, 0
    v_mov_b32 v25, 0
    v_mov_b32 v26, 0
    v_mov_b32 v27, 0
    s_lshl_b32 s70, s66, 2
    s_add_u32 s70, s70, s3
    s_lshl_b32 s70, s70, 1
    s_add_u32 s71, s70, 1
    s_lshl_b32 s72, s84, 3
    s_add_u32 s72, s72, s83
    s_add_u32 s72, s72, 512
    s_lshl_b32 s90, s66, 3
    s_add_u32 s90, s90, s3
    s_add_u32 s90, s90, 6
    s_cmp_ge_u32 s3, 2
    s_cselect_b32 s90, s72, s90
    s_mov_b32 s91, s70
    s_mov_b32 s92, s71
    s_lshl_b32 s88, s68, 11
    s_add_u32 s88, s88, 33030144
    s_lshl_b32 s4, s2, 8
    s_add_u32 s4, s4, 33423360
    s_mov_b32 s5, 33423360
    s_cmp_lg_u32 s3, 3
    s_cbranch_scc1 L_nclr
    buffer_store_dword v24, v254, s[16:19], s4 offen sc1
    buffer_store_dwordx4 v[24:27], v1, s[16:19], s88 offen sc1
    buffer_store_dwordx4 v[24:27], v1, s[16:19], s88 offen offset:1024 sc1
L_nclr:
    s_lshl_b32 s33, s90, 1
    s_and_b32 s33, s33, 0xfffffffc
    s_add_u32 s34, s50, s33
    s_addc_u32 s35, s51, 0
    s_load_dword s74, s[34:35], 0
    s_add_u32 s34, s52, s33
    s_addc_u32 s35, s53, 0
    s_load_dword s77, s[34:35], 0
    s_lshl_b32 s33, s91, 1
    s_and_b32 s33, s33, 0xfffffffc
    s_add_u32 s34, s50, s33
    s_addc_u32 s35, s51, 0
    s_load_dword s75, s[34:35], 0
    s_add_u32 s34, s52, s33
    s_addc_u32 s35, s53, 0
    s_load_dword s78, s[34:35], 0
    s_lshl_b32 s33, s92, 1
    s_and_b32 s33, s33, 0xfffffffc
    s_add_u32 s34, s50, s33
    s_addc_u32 s35, s51, 0
    s_load_dword s76, s[34:35], 0
    s_add_u32 s34, s52, s33
    s_addc_u32 s35, s53, 0
    s_load_dword s79, s[34:35], 0
    s_mul_i32 s67, s3, 5376
    s_add_u32 s67, s67, 67712
    s_mul_i32 s73, s3, 16896
    s_add_u32 s73, s73, 128
    v_and_b32 v20, 15, v0
    v_lshrrev_b32 v21, 4, v0
    s_mul_i32 s33, s3, 2688
    s_add_u32 s33, s33, 83840
    s_sub_u32 s93, s67, s33
    v_lshl_add_u32 v7, v20, 1, s33
    v_and_b32 v4, 1, v21
    v_lshrrev_b32 v5, 1, v21
    v_mul_u32_u24 v12, 1056, v4
    v_lshl_add_u32 v6, v5, 5, v7
    v_add_u32 v12, v12, v6
    v_mul_u32_u24 v3, 1056, v4
    v_sub_u32 v3, 1848, v3
    v_add_u32 v3, v3, v6
    v_lshlrev_b32 v8, 5, v21
    v_add_u32 v8, 64, v8
    v_lshlrev_b32 v9, 6, v21
    v_cmp_gt_u32 vcc, 2, v21
    s_nop 1
    v_cndmask_b32 v8, v9, v8, vcc
    v_add_u32 v8, v8, v7
    v_add_u32 v13, 1848, v8
    v_mov_b32 v9, 264
    v_mov_b32 v10, 792
    v_cndmask_b32 v6, v10, v9, vcc
    v_add_u32 v14, v6, v8
    v_mov_b32 v9, 1880
    v_cndmask_b32 v6, v9, v10, vcc
    v_add_u32 v15, v6, v8
    v_mov_b32 v9, 824
    v_mov_b32 v10, 1320
    v_cndmask_b32 v6, v9, v10, vcc
    v_add_u32 v16, v6, v8
    v_lshl_add_u32 v17, v21, 7, v7
    v_mov_b32 v9, s33
    v_cndmask_b32 v10, -1, v24, vcc
    v_mul_u32_u24 v11, 528, v20
    v_lshl_add_u32 v11, v4, 8, v11
    v_lshl_add_u32 v11, v5, 7, v11
    v_add_u32 v11, s73, v11
    v_add_u32 v18, s73, v1
    v_lshlrev_b32 v6, 3, v4
    v_sub_u32 v6, v6, v20
    v_add_u32 v6, 15, v6
    v_and_b32 v7, 3, v6
    v_mul_u32_u24 v7, 2112, v7
    v_lshrrev_b32 v6, 2, v6
    v_lshl_add_u32 v2, v6, 3, v7
    v_mul_u32_u24 v6, 192, v5
    v_add3_u32 v2, v2, v6, s73
    v_bfe_u32 v6, v0, 2, 2
    v_lshl_add_u32 v6, v4, 3, v6
    v_lshlrev_b32 v6, 2, v6
    v_and_b32 v7, 3, v0
    v_add_u32 v6, v6, v7
    v_lshlrev_b32 v7, 1, v5
    v_sub_u32 v6, v6, v7
    v_add_u32 v6, 64, v6
    s_lshl_b32 s33, s3, 5
    s_add_u32 s33, s33, 92416
    v_lshrrev_b32 v7, 1, v6
    v_mul_u32_u24 v7, 144, v7
    v_and_b32 v8, 1, v6
    v_lshl_add_u32 v7, v8, 3, v7
    v_add_u32 v232, s33, v7
    v_subrev_u32 v6, 1, v6
    v_lshrrev_b32 v7, 1, v6
    v_mul_u32_u24 v7, 144, v7
    v_and_b32 v8, 1, v6
    v_lshl_add_u32 v7, v8, 3, v7
    v_add_u32 v233, s33, v7
    v_lshlrev_b32 v22, 1, v20
    v_sub_u32 v22, v22, v21
    v_add_u32 v22, 5, v22
    v_mul_u32_u24 v22, 144, v22
    v_add_u32 v22, s33, v22
    v_lshl_add_u32 v6, v21, 3, v20
    v_sub_u32 v6, 39, v6
    v_and_b32 v7, 3, v6
    v_mul_u32_u24 v7, 2112, v7
    v_lshrrev_b32 v6, 2, v6
    v_lshl_add_u32 v19, v6, 3, v7
    v_add_u32 v19, s73, v19
    v_mul_u32_u24 v30, 1184, v28
    v_lshl_add_u32 v30, v29, 4, v30
    s_mul_i32 s33, s3, 9600
    s_add_u32 s33, s33, 97024
    v_add_u32 v30, s33, v30
    s_lshl_b32 s33, s3, 5
    s_add_u32 s33, s33, 91968
    v_lshl_add_u32 v31, v28, 2, s33
    v_mov_b32 v4, 91904
    ds_write_b96 v4, v[24:26]
    s_mul_i32 s33, s3, 1152
    s_add_u32 s33, s33, 92416
    v_add_u32 v4, s33, v1
    ds_write_b128 v4, v[24:27]
    ds_write_b128 v4, v[24:27] offset:128
    v_min_u32 v4, 35, v0
    v_mul_u32_u24 v5, 43, v4
    v_lshrrev_b32 v5, 7, v5
    v_mul_u32_u24 v6, 3, v5
    v_sub_u32 v4, v4, v6
    v_mul_u32_u24 v5, 2304, v5
    v_lshl_add_u32 v234, v4, 7, v5
    s_lshr_b32 s97, s84, 1
    s_mul_i32 s97, s97, 1327104
    s_mul_i32 s33, s83, 55296
    s_add_u32 s97, s97, s33
    s_and_b32 s33, s84, 1
    s_mul_i32 s33, s33, 1152
    s_sub_u32 s87, 1152, s33
    s_add_u32 s87, s87, s97
    s_add_u32 s97, s97, s33
    s_mul_i32 s34, s66, 43
    s_lshr_b32 s34, s34, 8
    s_mul_i32 s35, s34, 6
    s_sub_u32 s35, s66, s35
    s_cmp_ge_u32 s72, 528
    s_cselect_b32 s80, 11, 10
    s_cselect_b32 s81, 20, 0
    s_sub_u32 s81, s72, s81
    s_sub_u32 s81, s81, 508
    v_mov_b32 v4, s34
    v_mov_b32 v5, s35
    v_mov_b32 v6, s80
    v_mov_b32 v7, s81
    v_and_b32 v8, 16, v0
    v_cmp_eq_u32 vcc, 0, v8
    s_nop 1
    v_cndmask_b32 v4, v6, v4, vcc
    v_cndmask_b32 v5, v7, v5, vcc
    v_lshlrev_b32 v5, 2, v5
    v_mul_u32_u24 v6, 43, v4
    v_lshrrev_b32 v6, 7, v6
    v_mul_u32_u24 v7, 3, v6
    v_sub_u32 v7, v4, v7
    v_lshl_add_u32 v5, v7, 8, v5
    v_lshl_add_u32 v8, v20, 2, v6
    v_lshl_add_u32 v237, v8, 11, v5
    v_mul_u32_u24 v34, 9216, v28
    v_lshl_add_u32 v34, v29, 4, v34
    s_lshr_b32 s33, s84, 1
    s_mul_i32 s33, s33, 2304
    s_and_b32 s34, s84, 1
    s_mul_i32 s34, s34, 1152
    s_add_u32 s85, s33, s34
    s_mul_i32 s89, s83, 663552
    s_add_u32 s89, s89, s85
    s_mov_b32 s14, 147456
    s_lshl_b32 s34, s90, 8
    s_lshl_b32 s35, s70, 8
    s_mov_b32 s33, 0x3f803f80
    v_mov_b32 v44, 0
    v_mov_b32 v45, 0
    v_mov_b32 v46, 0
    v_mov_b32 v47, 0
    s_nop 7
    s_nop 7
    s_cmp_eq_u32 s3, 3
    s_cbranch_scc1 L_x3
    s_waitcnt vmcnt(0)
    s_mov_b32 s12, s38
    s_mov_b32 s13, s39
    buffer_load_dword v192, v254, s[12:15], s34 offen
    buffer_load_dwordx2 v[198:199], v33, s[12:15], s35 offen
    s_mov_b32 s12, s40
    s_mov_b32 s13, s41
    buffer_load_dword v193, v254, s[12:15], s34 offen
    buffer_load_dwordx2 v[200:201], v33, s[12:15], s35 offen
    s_mov_b32 s12, s42
    s_mov_b32 s13, s43
    buffer_load_dword v194, v254, s[12:15], s34 offen
    buffer_load_dwordx2 v[202:203], v33, s[12:15], s35 offen
    s_mov_b32 s12, s44
    s_mov_b32 s13, s45
    buffer_load_dword v195, v254, s[12:15], s34 offen
    buffer_load_dwordx2 v[204:205], v33, s[12:15], s35 offen
    s_mov_b32 s12, s46
    s_mov_b32 s13, s47
    buffer_load_dword v196, v254, s[12:15], s34 offen
    buffer_load_dwordx2 v[206:207], v33, s[12:15], s35 offen
    s_mov_b32 s12, s48
    s_mov_b32 s13, s49
    buffer_load_dword v197, v254, s[12:15], s34 offen
    buffer_load_dwordx2 v[208:209], v33, s[12:15], s35 offen
    s_branch L_xj
L_x3:
    s_add_u32 s86, s89, 0
    buffer_load_dwordx4 a[0:3], v34, s[8:11], s86 offen offset:0
    buffer_load_dwordx4 a[36:39], v34, s[8:11], s86 offen offset:128
    buffer_load_dwordx4 a[72:75], v34, s[8:11], s86 offen offset:256
    s_add_u32 s86, s86, 73728
    buffer_load_dwordx4 a[4:7], v34, s[8:11], s86 offen offset:0
    buffer_load_dwordx4 a[40:43], v34, s[8:11], s86 offen offset:128
    buffer_load_dwordx4 a[76:79], v34, s[8:11], s86 offen offset:256
    s_add_u32 s86, s86, 73728
    buffer_load_dwordx4 a[8:11], v34, s[8:11], s86 offen offset:0
    buffer_load_dwordx4 a[44:47], v34, s[8:11], s86 offen offset:128
    buffer_load_dwordx4 a[80:83], v34, s[8:11], s86 offen offset:256
    s_add_u32 s86, s86, 73728
    buffer_load_dwordx4 a[12:15], v34, s[8:11], s86 offen offset:0
    buffer_load_dwordx4 a[48:51], v34, s[8:11], s86 offen offset:128
    buffer_load_dwordx4 a[84:87], v34, s[8:11], s86 offen offset:256
    s_add_u32 s86, s86, 73728
    buffer_load_dwordx4 a[16:19], v34, s[8:11], s86 offen offset:0
    buffer_load_dwordx4 a[52:55], v34, s[8:11], s86 offen offset:128
    buffer_load_dwordx4 a[88:91], v34, s[8:11], s86 offen offset:256
    s_add_u32 s86, s86, 73728
    buffer_load_dwordx4 a[20:23], v34, s[8:11], s86 offen offset:0
    buffer_load_dwordx4 a[56:59], v34, s[8:11], s86 offen offset:128
    buffer_load_dwordx4 a[92:95], v34, s[8:11], s86 offen offset:256
    s_add_u32 s86, s86, 73728
    buffer_load_dwordx4 a[24:27], v34, s[8:11], s86 offen offset:0
    buffer_load_dwordx4 a[60:63], v34, s[8:11], s86 offen offset:128
    buffer_load_dwordx4 a[96:99], v34, s[8:11], s86 offen offset:256
    s_add_u32 s86, s86, 73728
    buffer_load_dwordx4 a[28:31], v34, s[8:11], s86 offen offset:0
    buffer_load_dwordx4 a[64:67], v34, s[8:11], s86 offen offset:128
    buffer_load_dwordx4 a[100:103], v34, s[8:11], s86 offen offset:256
    s_add_u32 s86, s86, 73728
    buffer_load_dwordx4 a[32:35], v34, s[8:11], s86 offen offset:0
    buffer_load_dwordx4 a[68:71], v34, s[8:11], s86 offen offset:128
    buffer_load_dwordx4 a[104:107], v34, s[8:11], s86 offen offset:256
    s_waitcnt vmcnt(30)
L_xj:
    s_mov_b32 s12, s58
    s_mov_b32 s13, s59
    s_mov_b32 s14, 0x510000
    s_mov_b32 s15, 0x00020000
    v_dot2c_f32_bf16 v44, s33, v128
    v_dot2c_f32_bf16 v46, v128, v128
    v_dot2c_f32_bf16 v45, s33, v129
    v_dot2c_f32_bf16 v47, v129, v129
    v_dot2c_f32_bf16 v44, s33, v130
    v_dot2c_f32_bf16 v46, v130, v130
    v_dot2c_f32_bf16 v45, s33, v131
    v_dot2c_f32_bf16 v47, v131, v131
    v_dot2c_f32_bf16 v44, s33, v132
    v_dot2c_f32_bf16 v46, v132, v132
    v_dot2c_f32_bf16 v45, s33, v133
    v_dot2c_f32_bf16 v47, v133, v133
    v_dot2c_f32_bf16 v44, s33, v134
    v_dot2c_f32_bf16 v46, v134, v134
    v_dot2c_f32_bf16 v45, s33, v135
    v_dot2c_f32_bf16 v47, v135, v135
    v_dot2c_f32_bf16 v44, s33, v136
    v_dot2c_f32_bf16 v46, v136, v136
    v_dot2c_f32_bf16 v45, s33, v137
    v_dot2c_f32_bf16 v47, v137, v137
    v_dot2c_f32_bf16 v44, s33, v138
    v_dot2c_f32_bf16 v46, v138, v138
    v_dot2c_f32_bf16 v45, s33, v139
    v_dot2c_f32_bf16 v47, v139, v139
    v_dot2c_f32_bf16 v44, s33, v140
    v_dot2c_f32_bf16 v46, v140, v140
    v_dot2c_f32_bf16 v45, s33, v141
    v_dot2c_f32_bf16 v47, v141, v141
    v_dot2c_f32_bf16 v44, s33, v142
    v_dot2c_f32_bf16 v46, v142, v142
    v_dot2c_f32_bf16 v45, s33, v143
    v_dot2c_f32_bf16 v47, v143, v143
    v_dot2c_f32_bf16 v44, s33, v144
    v_dot2c_f32_bf16 v46, v144, v144
    v_dot2c_f32_bf16 v45, s33, v145
    v_dot2c_f32_bf16 v47, v145, v145
    v_dot2c_f32_bf16 v44, s33, v146
    v_dot2c_f32_bf16 v46, v146, v146
    v_dot2c_f32_bf16 v45, s33, v147
    v_dot2c_f32_bf16 v47, v147, v147
    v_dot2c_f32_bf16 v44, s33, v148
    v_dot2c_f32_bf16 v46, v148, v148
    v_dot2c_f32_bf16 v45, s33, v149
    v_dot2c_f32_bf16 v47, v149, v149
    v_dot2c_f32_bf16 v44, s33, v150
    v_dot2c_f32_bf16 v46, v150, v150
    v_dot2c_f32_bf16 v45, s33, v151
    v_dot2c_f32_bf16 v47, v151, v151
    v_dot2c_f32_bf16 v44, s33, v152
    v_dot2c_f32_bf16 v46, v152, v152
    v_dot2c_f32_bf16 v45, s33, v153
    v_dot2c_f32_bf16 v47, v153, v153
    v_dot2c_f32_bf16 v44, s33, v154
    v_dot2c_f32_bf16 v46, v154, v154
    v_dot2c_f32_bf16 v45, s33, v155
    v_dot2c_f32_bf16 v47, v155, v155
    v_dot2c_f32_bf16 v44, s33, v156
    v_dot2c_f32_bf16 v46, v156, v156
    v_dot2c_f32_bf16 v45, s33, v157
    v_dot2c_f32_bf16 v47, v157, v157
    v_dot2c_f32_bf16 v44, s33, v158
    v_dot2c_f32_bf16 v46, v158, v158
    v_dot2c_f32_bf16 v45, s33, v159
    v_dot2c_f32_bf16 v47, v159, v159
    v_dot2c_f32_bf16 v44, s33, v160
    v_dot2c_f32_bf16 v46, v160, v160
    v_dot2c_f32_bf16 v45, s33, v161
    v_dot2c_f32_bf16 v47, v161, v161
    v_dot2c_f32_bf16 v44, s33, v162
    v_dot2c_f32_bf16 v46, v162, v162
    v_dot2c_f32_bf16 v45, s33, v163
    v_dot2c_f32_bf16 v47, v163, v163
    s_nop 2
    v_add_f32 v6, v44, v45
    v_add_f32 v46, v46, v47
    s_nop 0
    v_add_f32_dpp v6, v6, v6 quad_perm:[1,0,3,2] row_mask:0xf bank_mask:0xf
    s_nop 1
    v_add_f32_dpp v6, v6, v6 quad_perm:[2,3,0,1] row_mask:0xf bank_mask:0xf
    s_nop 1
    v_add_f32_dpp v6, v6, v6 row_half_mirror row_mask:0xf bank_mask:0xf
    v_add_f32_dpp v46, v46, v46 quad_perm:[1,0,3,2] row_mask:0xf bank_mask:0xf
    s_nop 1
    v_add_f32_dpp v46, v46, v46 quad_perm:[2,3,0,1] row_mask:0xf bank_mask:0xf
    s_nop 1
    v_add_f32_dpp v46, v46, v46 row_half_mirror row_mask:0xf bank_mask:0xf
    v_mul_f32 v6, 0x3ae38e39, v6
    v_cvt_pk_bf16_f32 v45, v6, v6
    v_xor_b32 v126, 0x80008000, v45
    v_mul_f32 v46, 0x3ae38e39, v46
    v_fma_f32 v46, -v6, v6, v46
    v_max_f32 v46, 0, v46
    v_cvt_pk_bf16_f32 v46, v46, v46
    v_lshlrev_b32 v46, 16, v46
    v_add_f32 v46, 0x3727c5ac, v46
    v_cvt_pk_bf16_f32 v46, v46, v46
    v_lshlrev_b32 v46, 16, v46
    v_sqrt_f32 v46, v46
    s_nop 0
    v_cvt_pk_bf16_f32 v46, v46, v46
    v_lshlrev_b32 v46, 16, v46
    v_rcp_f32 v44, v46
    v_lshlrev_b32 v46, 16, v126
    v_mul_f32 v46, v46, v44
    ds_write2_b32 v31, v126, v44 offset1:32
    v_lshlrev_b32 v48, 16, v128
    v_and_b32 v49, 0xffff0000, v128
    v_lshlrev_b32 v50, 16, v129
    v_and_b32 v51, 0xffff0000, v129
    v_lshlrev_b32 v52, 16, v130
    v_and_b32 v53, 0xffff0000, v130
    v_lshlrev_b32 v54, 16, v131
    v_and_b32 v55, 0xffff0000, v131
    v_pk_fma_f32 v[48:49], v[48:49], v[44:45], v[46:47] op_sel_hi:[1,0,0]
    v_pk_fma_f32 v[50:51], v[50:51], v[44:45], v[46:47] op_sel_hi:[1,0,0]
    v_pk_fma_f32 v[52:53], v[52:53], v[44:45], v[46:47] op_sel_hi:[1,0,0]
    v_pk_fma_f32 v[54:55], v[54:55], v[44:45], v[46:47] op_sel_hi:[1,0,0]
    v_cvt_pk_bf16_f32 v128, v48, v49
    v_cvt_pk_bf16_f32 v129, v50, v51
    v_cvt_pk_bf16_f32 v130, v52, v53
    v_cvt_pk_bf16_f32 v131, v54, v55
    v_lshlrev_b32 v48, 16, v132
    v_and_b32 v49, 0xffff0000, v132
    v_lshlrev_b32 v50, 16, v133
    v_and_b32 v51, 0xffff0000, v133
    v_lshlrev_b32 v52, 16, v134
    v_and_b32 v53, 0xffff0000, v134
    v_lshlrev_b32 v54, 16, v135
    v_and_b32 v55, 0xffff0000, v135
    v_pk_fma_f32 v[48:49], v[48:49], v[44:45], v[46:47] op_sel_hi:[1,0,0]
    v_pk_fma_f32 v[50:51], v[50:51], v[44:45], v[46:47] op_sel_hi:[1,0,0]
    v_pk_fma_f32 v[52:53], v[52:53], v[44:45], v[46:47] op_sel_hi:[1,0,0]
    v_pk_fma_f32 v[54:55], v[54:55], v[44:45], v[46:47] op_sel_hi:[1,0,0]
    v_cvt_pk_bf16_f32 v132, v48, v49
    v_cvt_pk_bf16_f32 v133, v50, v51
    v_cvt_pk_bf16_f32 v134, v52, v53
    v_cvt_pk_bf16_f32 v135, v54, v55
    v_lshlrev_b32 v48, 16, v136
    v_and_b32 v49, 0xffff0000, v136
    v_lshlrev_b32 v50, 16, v137
    v_and_b32 v51, 0xffff0000, v137
    v_lshlrev_b32 v52, 16, v138
    v_and_b32 v53, 0xffff0000, v138
    v_lshlrev_b32 v54, 16, v139
    v_and_b32 v55, 0xffff0000, v139
    v_pk_fma_f32 v[48:49], v[48:49], v[44:45], v[46:47] op_sel_hi:[1,0,0]
    v_pk_fma_f32 v[50:51], v[50:51], v[44:45], v[46:47] op_sel_hi:[1,0,0]
    v_pk_fma_f32 v[52:53], v[52:53], v[44:45], v[46:47] op_sel_hi:[1,0,0]
    v_pk_fma_f32 v[54:55], v[54:55], v[44:45], v[46:47] op_sel_hi:[1,0,0]
    v_cvt_pk_bf16_f32 v136, v48, v49
    v_cvt_pk_bf16_f32 v137, v50, v51
    v_cvt_pk_bf16_f32 v138, v52, v53
    v_cvt_pk_bf16_f32 v139, v54, v55
    ds_write_b128 v30, v[128:131] offset:0
    ds_write_b128 v30, v[132:135] offset:128
    ds_write_b128 v30, v[136:139] offset:256
    v_lshlrev_b32 v48, 16, v140
    v_and_b32 v49, 0xffff0000, v140
    v_lshlrev_b32 v50, 16, v141
    v_and_b32 v51, 0xffff0000, v141
    v_lshlrev_b32 v52, 16, v142
    v_and_b32 v53, 0xffff0000, v142
    v_lshlrev_b32 v54, 16, v143
    v_and_b32 v55, 0xffff0000, v143
    v_pk_fma_f32 v[48:49], v[48:49], v[44:45], v[46:47] op_sel_hi:[1,0,0]
    v_pk_fma_f32 v[50:51], v[50:51], v[44:45], v[46:47] op_sel_hi:[1,0,0]
    v_pk_fma_f32 v[52:53], v[52:53], v[44:45], v[46:47] op_sel_hi:[1,0,0]
    v_pk_fma_f32 v[54:55], v[54:55], v[44:45], v[46:47] op_sel_hi:[1,0,0]
    v_cvt_pk_bf16_f32 v140, v48, v49
    v_cvt_pk_bf16_f32 v141, v50, v51
    v_cvt_pk_bf16_f32 v142, v52, v53
    v_cvt_pk_bf16_f32 v143, v54, v55
    v_lshlrev_b32 v48, 16, v144
    v_and_b32 v49, 0xffff0000, v144
    v_lshlrev_b32 v50, 16, v145
    v_and_b32 v51, 0xffff0000, v145
    v_lshlrev_b32 v52, 16, v146
    v_and_b32 v53, 0xffff0000, v146
    v_lshlrev_b32 v54, 16, v147
    v_and_b32 v55, 0xffff0000, v147
    v_pk_fma_f32 v[48:49], v[48:49], v[44:45], v[46:47] op_sel_hi:[1,0,0]
    v_pk_fma_f32 v[50:51], v[50:51], v[44:45], v[46:47] op_sel_hi:[1,0,0]
    v_pk_fma_f32 v[52:53], v[52:53], v[44:45], v[46:47] op_sel_hi:[1,0,0]
    v_pk_fma_f32 v[54:55], v[54:55], v[44:45], v[46:47] op_sel_hi:[1,0,0]
    v_cvt_pk_bf16_f32 v144, v48, v49
    v_cvt_pk_bf16_f32 v145, v50, v51
    v_cvt_pk_bf16_f32 v146, v52, v53
    v_cvt_pk_bf16_f32 v147, v54, v55
    v_lshlrev_b32 v48, 16, v148
    v_and_b32 v49, 0xffff0000, v148
    v_lshlrev_b32 v50, 16, v149
    v_and_b32 v51, 0xffff0000, v149
    v_lshlrev_b32 v52, 16, v150
    v_and_b32 v53, 0xffff0000, v150
    v_lshlrev_b32 v54, 16, v151
    v_and_b32 v55, 0xffff0000, v151
    v_pk_fma_f32 v[48:49], v[48:49], v[44:45], v[46:47] op_sel_hi:[1,0,0]
    v_pk_fma_f32 v[50:51], v[50:51], v[44:45], v[46:47] op_sel_hi:[1,0,0]
    v_pk_fma_f32 v[52:53], v[52:53], v[44:45], v[46:47] op_sel_hi:[1,0,0]
    v_pk_fma_f32 v[54:55], v[54:55], v[44:45], v[46:47] op_sel_hi:[1,0,0]
    v_cvt_pk_bf16_f32 v148, v48, v49
    v_cvt_pk_bf16_f32 v149, v50, v51
    v_cvt_pk_bf16_f32 v150, v52, v53
    v_cvt_pk_bf16_f32 v151, v54, v55
    ds_write_b128 v30, v[140:143] offset:384
    ds_write_b128 v30, v[144:147] offset:512
    ds_write_b128 v30, v[148:151] offset:640
    v_lshlrev_b32 v48, 16, v152
    v_and_b32 v49, 0xffff0000, v152
    v_lshlrev_b32 v50, 16, v153
    v_and_b32 v51, 0xffff0000, v153
    v_lshlrev_b32 v52, 16, v154
    v_and_b32 v53, 0xffff0000, v154
    v_lshlrev_b32 v54, 16, v155
    v_and_b32 v55, 0xffff0000, v155
    v_pk_fma_f32 v[48:49], v[48:49], v[44:45], v[46:47] op_sel_hi:[1,0,0]
    v_pk_fma_f32 v[50:51], v[50:51], v[44:45], v[46:47] op_sel_hi:[1,0,0]
    v_pk_fma_f32 v[52:53], v[52:53], v[44:45], v[46:47] op_sel_hi:[1,0,0]
    v_pk_fma_f32 v[54:55], v[54:55], v[44:45], v[46:47] op_sel_hi:[1,0,0]
    v_cvt_pk_bf16_f32 v152, v48, v49
    v_cvt_pk_bf16_f32 v153, v50, v51
    v_cvt_pk_bf16_f32 v154, v52, v53
    v_cvt_pk_bf16_f32 v155, v54, v55
    v_lshlrev_b32 v48, 16, v156
    v_and_b32 v49, 0xffff0000, v156
    v_lshlrev_b32 v50, 16, v157
    v_and_b32 v51, 0xffff0000, v157
    v_lshlrev_b32 v52, 16, v158
    v_and_b32 v53, 0xffff0000, v158
    v_lshlrev_b32 v54, 16, v159
    v_and_b32 v55, 0xffff0000, v159
    v_pk_fma_f32 v[48:49], v[48:49], v[44:45], v[46:47] op_sel_hi:[1,0,0]
    v_pk_fma_f32 v[50:51], v[50:51], v[44:45], v[46:47] op_sel_hi:[1,0,0]
    v_pk_fma_f32 v[52:53], v[52:53], v[44:45], v[46:47] op_sel_hi:[1,0,0]
    v_pk_fma_f32 v[54:55], v[54:55], v[44:45], v[46:47] op_sel_hi:[1,0,0]
    v_cvt_pk_bf16_f32 v156, v48, v49
    v_cvt_pk_bf16_f32 v157, v50, v51
    v_cvt_pk_bf16_f32 v158, v52, v53
    v_cvt_pk_bf16_f32 v159, v54, v55
    v_lshlrev_b32 v48, 16, v160
    v_and_b32 v49, 0xffff0000, v160
    v_lshlrev_b32 v50, 16, v161
    v_and_b32 v51, 0xffff0000, v161
    v_lshlrev_b32 v52, 16, v162
    v_and_b32 v53, 0xffff0000, v162
    v_lshlrev_b32 v54, 16, v163
    v_and_b32 v55, 0xffff0000, v163
    v_pk_fma_f32 v[48:49], v[48:49], v[44:45], v[46:47] op_sel_hi:[1,0,0]
    v_pk_fma_f32 v[50:51], v[50:51], v[44:45], v[46:47] op_sel_hi:[1,0,0]
    v_pk_fma_f32 v[52:53], v[52:53], v[44:45], v[46:47] op_sel_hi:[1,0,0]
    v_pk_fma_f32 v[54:55], v[54:55], v[44:45], v[46:47] op_sel_hi:[1,0,0]
    v_cvt_pk_bf16_f32 v160, v48, v49
    v_cvt_pk_bf16_f32 v161, v50, v51
    v_cvt_pk_bf16_f32 v162, v52, v53
    v_cvt_pk_bf16_f32 v163, v54, v55
    ds_write_b128 v30, v[152:155] offset:768
    ds_write_b128 v30, v[156:159] offset:896
    ds_write_b128 v30, v[160:163] offset:1024
    s_cmp_eq_u32 s3, 3
    s_cbranch_scc1 L_w3
    s_waitcnt lgkmcnt(0)
    s_barrier
    s_and_b32 s33, s90, 1
    s_lshl_b32 s33, s33, 4
    s_lshr_b32 s74, s74, s33
    s_lshl_b32 s74, s74, 16
    s_lshr_b32 s77, s77, s33
    s_lshl_b32 s77, s77, 16
    s_and_b32 s33, s91, 1
    s_lshl_b32 s33, s33, 4
    s_lshr_b32 s75, s75, s33
    s_lshl_b32 s75, s75, 16
    s_lshr_b32 s78, s78, s33
    s_lshl_b32 s78, s78, 16
    s_and_b32 s33, s92, 1
    s_lshl_b32 s33, s33, 4
    s_lshr_b32 s76, s76, s33
    s_lshl_b32 s76, s76, 16
    s_lshr_b32 s79, s79, s33
    s_lshl_b32 s79, s79, 16
    s_waitcnt vmcnt(0)
    v_permlane32_swap_b32 v198, v199
    v_permlane32_swap_b32 v200, v201
    v_permlane32_swap_b32 v202, v203
    v_permlane32_swap_b32 v204, v205
    v_permlane32_swap_b32 v206, v207
    v_permlane32_swap_b32 v208, v209
    s_call_b64 s[6:7], L_kgen
    s_mov_b32 s93, 2688
    v_mov_b32 v4, 91908
    v_mov_b32 v5, 1
    s_mov_b64 exec, 1
    ds_add_u32 v4, v5
    s_mov_b64 exec, -1
    s_call_b64 s[6:7], L_kgen
    s_mov_b32 s33, L_const-parallel_sum__ssm_conv_s4__dense_activation_relu__prompt_kernel
    buffer_load_dwordx4 v[240:243], v1, s[24:27], s33 offen offset:0
    buffer_load_dwordx2 v[244:245], v1, s[24:27], s33 offen offset:16
    buffer_load_dwordx4 v[246:249], v1, s[24:27], s33 offen offset:1024
    buffer_load_dwordx2 v[250:251], v1, s[24:27], s33 offen offset:1040
    s_add_u32 s33, s33, 2176
    buffer_load_dwordx4 a[240:243], v1, s[24:27], s33 offen offset:0
    buffer_load_dwordx4 a[244:247], v1, s[24:27], s33 offen offset:1024
    buffer_load_dwordx4 a[248:251], v1, s[24:27], s33 offen offset:2048
    buffer_load_dwordx4 a[252:255], v1, s[24:27], s33 offen offset:3072
    s_call_b64 s[6:7], L_kgen
    s_waitcnt vmcnt(0)
    v_mov_b32 v4, s67
    v_add_u32_sdwa v210, v240, v4 dst_sel:DWORD dst_unused:UNUSED_PAD src0_sel:WORD_0 src1_sel:DWORD
    v_add_u32_sdwa v211, v240, v4 dst_sel:DWORD dst_unused:UNUSED_PAD src0_sel:WORD_1 src1_sel:DWORD
    v_add_u32_sdwa v212, v241, v4 dst_sel:DWORD dst_unused:UNUSED_PAD src0_sel:WORD_0 src1_sel:DWORD
    v_add_u32_sdwa v213, v241, v4 dst_sel:DWORD dst_unused:UNUSED_PAD src0_sel:WORD_1 src1_sel:DWORD
    v_add_u32_sdwa v214, v242, v4 dst_sel:DWORD dst_unused:UNUSED_PAD src0_sel:WORD_0 src1_sel:DWORD
    v_add_u32_sdwa v215, v242, v4 dst_sel:DWORD dst_unused:UNUSED_PAD src0_sel:WORD_1 src1_sel:DWORD
    v_add_u32_sdwa v216, v243, v4 dst_sel:DWORD dst_unused:UNUSED_PAD src0_sel:WORD_0 src1_sel:DWORD
    v_add_u32_sdwa v217, v243, v4 dst_sel:DWORD dst_unused:UNUSED_PAD src0_sel:WORD_1 src1_sel:DWORD
    v_add_u32_sdwa v218, v244, v4 dst_sel:DWORD dst_unused:UNUSED_PAD src0_sel:WORD_0 src1_sel:DWORD
    v_add_u32_sdwa v219, v244, v4 dst_sel:DWORD dst_unused:UNUSED_PAD src0_sel:WORD_1 src1_sel:DWORD
    v_add_u32_sdwa v220, v245, v4 dst_sel:DWORD dst_unused:UNUSED_PAD src0_sel:WORD_0 src1_sel:DWORD
    v_add_u32_sdwa v221, v246, v4 dst_sel:DWORD dst_unused:UNUSED_PAD src0_sel:WORD_0 src1_sel:DWORD
    v_add_u32_sdwa v222, v246, v4 dst_sel:DWORD dst_unused:UNUSED_PAD src0_sel:WORD_1 src1_sel:DWORD
    v_add_u32_sdwa v223, v247, v4 dst_sel:DWORD dst_unused:UNUSED_PAD src0_sel:WORD_0 src1_sel:DWORD
    v_add_u32_sdwa v224, v247, v4 dst_sel:DWORD dst_unused:UNUSED_PAD src0_sel:WORD_1 src1_sel:DWORD
    v_add_u32_sdwa v225, v248, v4 dst_sel:DWORD dst_unused:UNUSED_PAD src0_sel:WORD_0 src1_sel:DWORD
    v_add_u32_sdwa v226, v248, v4 dst_sel:DWORD dst_unused:UNUSED_PAD src0_sel:WORD_1 src1_sel:DWORD
    v_add_u32_sdwa v227, v249, v4 dst_sel:DWORD dst_unused:UNUSED_PAD src0_sel:WORD_0 src1_sel:DWORD
    v_add_u32_sdwa v228, v249, v4 dst_sel:DWORD dst_unused:UNUSED_PAD src0_sel:WORD_1 src1_sel:DWORD
    v_add_u32_sdwa v229, v250, v4 dst_sel:DWORD dst_unused:UNUSED_PAD src0_sel:WORD_0 src1_sel:DWORD
    v_add_u32_sdwa v230, v250, v4 dst_sel:DWORD dst_unused:UNUSED_PAD src0_sel:WORD_1 src1_sel:DWORD
    v_add_u32_sdwa v231, v251, v4 dst_sel:DWORD dst_unused:UNUSED_PAD src0_sel:WORD_0 src1_sel:DWORD
    s_call_b64 s[6:7], L_exp
    v_add_u32 v18, 8448, v18
    s_call_b64 s[6:7], L_exp
    v_mov_b32 v4, 91904
L_lw_26:
    ds_read_b32 v5, v4
    s_waitcnt lgkmcnt(0)
    v_cmp_ne_u32 vcc, 1, v5
    s_cbranch_vccnz L_lw_26
    s_cmp_eq_u32 s3, 2
    s_cbranch_scc1 L_tw6
    s_cmp_eq_u32 s3, 1
    s_cbranch_scc1 L_tw5
    s_add_u32 s33, s97, 768
    buffer_load_dword a227, v234, s[12:15], s33 offen
    s_add_u32 s33, s97, 442368
    buffer_load_dword a227, v234, s[12:15], s33 offen
    s_add_u32 s33, s97, 885120
    buffer_load_dword a227, v234, s[12:15], s33 offen
    s_add_u32 s33, s97, 28416
    buffer_load_dword a227, v234, s[12:15], s33 offen
    s_add_u32 s33, s97, 470016
    buffer_load_dword a227, v234, s[12:15], s33 offen
    s_add_u32 s33, s97, 912768
    buffer_load_dword a227, v234, s[12:15], s33 offen
    s_branch L_tw7
L_tw5:
    s_add_u32 s33, s97, 384
    buffer_load_dword a227, v234, s[12:15], s33 offen
    s_add_u32 s33, s97, 443136
    buffer_load_dword a227, v234, s[12:15], s33 offen
    s_add_u32 s33, s97, 884736
    buffer_load_dword a227, v234, s[12:15], s33 offen
    s_add_u32 s33, s97, 28032
    buffer_load_dword a227, v234, s[12:15], s33 offen
    s_add_u32 s33, s97, 470784
    buffer_load_dword a227, v234, s[12:15], s33 offen
    s_add_u32 s33, s97, 912384
    buffer_load_dword a227, v234, s[12:15], s33 offen
    s_branch L_tw7
L_tw6:
    s_add_u32 s33, s87, 0
    buffer_load_dword a227, v234, s[12:15], s33 offen
    s_add_u32 s33, s87, 442752
    buffer_load_dword a227, v234, s[12:15], s33 offen
    s_add_u32 s33, s87, 885504
    buffer_load_dword a227, v234, s[12:15], s33 offen
    s_add_u32 s33, s87, 27648
    buffer_load_dword a227, v234, s[12:15], s33 offen
    s_add_u32 s33, s87, 470400
    buffer_load_dword a227, v234, s[12:15], s33 offen
    s_add_u32 s33, s87, 913152
    buffer_load_dword a227, v234, s[12:15], s33 offen
L_tw7:
    s_mov_b32 s81, 2
    s_branch L_cvs
L_w3:
    s_waitcnt lgkmcnt(0)
    s_barrier
    s_mov_b32 s33, L_const-parallel_sum__ssm_conv_s4__dense_activation_relu__prompt_kernel
    buffer_load_dwordx4 v[240:243], v1, s[24:27], s33 offen offset:0
    buffer_load_dwordx2 v[244:245], v1, s[24:27], s33 offen offset:16
    buffer_load_dwordx4 v[246:249], v1, s[24:27], s33 offen offset:1024
    buffer_load_dwordx2 v[250:251], v1, s[24:27], s33 offen offset:1040
    s_add_u32 s33, s33, 2176
    buffer_load_dwordx4 a[240:243], v1, s[24:27], s33 offen offset:0
    buffer_load_dwordx4 a[244:247], v1, s[24:27], s33 offen offset:1024
    buffer_load_dwordx4 a[248:251], v1, s[24:27], s33 offen offset:2048
    buffer_load_dwordx4 a[252:255], v1, s[24:27], s33 offen offset:3072
    s_add_u32 s86, s89, 384
    buffer_load_dwordx4 a[108:111], v34, s[8:11], s86 offen offset:0
    buffer_load_dwordx4 a[144:147], v34, s[8:11], s86 offen offset:128
    buffer_load_dwordx4 a[180:183], v34, s[8:11], s86 offen offset:256
    s_add_u32 s86, s86, 73728
    buffer_load_dwordx4 a[112:115], v34, s[8:11], s86 offen offset:0
    buffer_load_dwordx4 a[148:151], v34, s[8:11], s86 offen offset:128
    buffer_load_dwordx4 a[184:187], v34, s[8:11], s86 offen offset:256
    s_add_u32 s86, s86, 73728
    buffer_load_dwordx4 a[116:119], v34, s[8:11], s86 offen offset:0
    buffer_load_dwordx4 a[152:155], v34, s[8:11], s86 offen offset:128
    buffer_load_dwordx4 a[188:191], v34, s[8:11], s86 offen offset:256
    s_add_u32 s86, s86, 73728
    buffer_load_dwordx4 a[120:123], v34, s[8:11], s86 offen offset:0
    buffer_load_dwordx4 a[156:159], v34, s[8:11], s86 offen offset:128
    buffer_load_dwordx4 a[192:195], v34, s[8:11], s86 offen offset:256
    s_add_u32 s86, s86, 73728
    buffer_load_dwordx4 a[124:127], v34, s[8:11], s86 offen offset:0
    buffer_load_dwordx4 a[160:163], v34, s[8:11], s86 offen offset:128
    buffer_load_dwordx4 a[196:199], v34, s[8:11], s86 offen offset:256
    s_add_u32 s86, s86, 73728
    buffer_load_dwordx4 a[128:131], v34, s[8:11], s86 offen offset:0
    buffer_load_dwordx4 a[164:167], v34, s[8:11], s86 offen offset:128
    buffer_load_dwordx4 a[200:203], v34, s[8:11], s86 offen offset:256
    s_add_u32 s86, s86, 73728
    buffer_load_dwordx4 a[132:135], v34, s[8:11], s86 offen offset:0
    buffer_load_dwordx4 a[168:171], v34, s[8:11], s86 offen offset:128
    buffer_load_dwordx4 a[204:207], v34, s[8:11], s86 offen offset:256
    s_add_u32 s86, s86, 73728
    buffer_load_dwordx4 a[136:139], v34, s[8:11], s86 offen offset:0
    buffer_load_dwordx4 a[172:175], v34, s[8:11], s86 offen offset:128
    buffer_load_dwordx4 a[208:211], v34, s[8:11], s86 offen offset:256
    s_add_u32 s86, s86, 73728
    buffer_load_dwordx4 a[140:143], v34, s[8:11], s86 offen offset:0
    buffer_load_dwordx4 a[176:179], v34, s[8:11], s86 offen offset:128
    buffer_load_dwordx4 a[212:215], v34, s[8:11], s86 offen offset:256
    v_min_u32 v4, 59, v0
    v_subrev_u32 v4, 48, v4
    v_and_b32 v5, 3, v4
    v_lshlrev_b32 v5, 1, v5
    v_lshrrev_b32 v4, 2, v4
    v_lshl_add_u32 v4, v4, 3, v5
    s_mul_i32 s34, s83, 24
    s_and_b32 s33, s84, 1
    s_add_u32 s33, s33, s34
    v_add_u32 v4, s33, v4
    v_lshlrev_b32 v6, 8, v4
    s_and_b32 s33, s68, 3
    s_lshl_b32 s33, s33, 2
    s_add_u32 s33, s33, 64
    v_add_u32 v6, s33, v6
    v_lshrrev_b32 v5, 1, v0
    v_lshlrev_b32 v5, 3, v5
    v_and_b32 v4, 1, v0
    v_add_u32 v4, v4, v5
    s_and_b32 s33, s84, 6
    v_add_u32 v4, s33, v4
    v_lshlrev_b32 v7, 8, v4
    s_and_b32 s33, s84, 1
    s_lshl_b32 s33, s33, 3
    s_add_u32 s33, s33, s83
    s_lshl_b32 s33, s33, 2
    v_add_u32 v7, s33, v7
    v_cmp_gt_u32 vcc, 48, v0
    s_nop 1
    v_cndmask_b32 v41, v6, v7, vcc
    v_lshlrev_b32 v40, 8, v0
    s_lshl_b32 s33, s66, 2
    s_add_u32 s33, s33, 49152
    v_add_u32 v40, s33, v40
    v_and_b32 v4, 7, v20
    v_lshlrev_b32 v4, 4, v4
    v_lshl_add_u32 v4, v21, 3, v4
    v_lshrrev_b32 v5, 3, v20
    v_mul_u32_u24 v5, 9216, v5
    v_add_u32 v42, v4, v5
    s_mul_i32 s96, s83, 18432
    s_add_u32 s96, s96, s85
    s_add_u32 s96, s96, 33161216
    v_cmp_lt_u32 s[94:95], 7, v20
    v_mov_b32 v6, 0x3f80
    v_mov_b32 v7, 0x3f800000
    v_mov_b32 v43, 1
    v_cmp_eq_u32 vcc, 0, v20
    s_nop 1
    v_cndmask_b32 v4, 0, v6, vcc
    v_cmp_eq_u32 vcc, 1, v20
    s_nop 1
    v_cndmask_b32 v36, v4, v7, vcc
    v_cmp_eq_u32 vcc, 2, v20
    s_nop 1
    v_cndmask_b32 v4, 0, v6, vcc
    v_cmp_eq_u32 vcc, 3, v20
    s_nop 1
    v_cndmask_b32 v37, v4, v7, vcc
    v_cmp_eq_u32 vcc, 4, v20
    s_nop 1
    v_cndmask_b32 v4, 0, v6, vcc
    v_cmp_eq_u32 vcc, 5, v20
    s_nop 1
    v_cndmask_b32 v38, v4, v7, vcc
    v_cmp_eq_u32 vcc, 6, v20
    s_nop 1
    v_cndmask_b32 v4, 0, v6, vcc
    v_cmp_eq_u32 vcc, 7, v20
    s_nop 1
    v_cndmask_b32 v39, v4, v7, vcc
    v_mul_u32_u24 v31, 9600, v21
    v_bfe_u32 v4, v0, 2, 2
    v_mul_u32_u24 v4, 1184, v4
    v_add_u32 v31, v31, v4
    v_and_b32 v4, 3, v0
    v_lshl_add_u32 v31, v4, 3, v31
    v_add_u32 v31, 97024, v31
    v_add_u32 v4, 91968, v254
    ds_read_b32 v35, v4
    v_lshlrev_b32 v5, 4, v29
    v_lshl_add_u32 v5, v21, 7, v5
    v_bfe_u32 v4, v0, 3, 1
    v_lshl_add_u32 v32, v4, 15, v5
    s_lshl_b32 s82, s68, 9
    s_lshl_b32 s88, s68, 8
    s_add_u32 s88, s88, 33357824
    s_waitcnt vmcnt(35)
    v_mfma_f32_16x16x32_bf16 v[44:47], v[36:39], a[0:3], 0
    v_mfma_f32_16x16x32_bf16 v[48:51], v[36:39], a[36:39], 0
    v_mfma_f32_16x16x32_bf16 v[52:55], v[36:39], a[72:75], 0
    v_mfma_f32_16x16x32_bf16 v[44:47], v[36:39], a[4:7], v[44:47]
    v_mfma_f32_16x16x32_bf16 v[48:51], v[36:39], a[40:43], v[48:51]
    v_mfma_f32_16x16x32_bf16 v[52:55], v[36:39], a[76:79], v[52:55]
    v_mfma_f32_16x16x32_bf16 v[44:47], v[36:39], a[8:11], v[44:47]
    v_mfma_f32_16x16x32_bf16 v[48:51], v[36:39], a[44:47], v[48:51]
    v_mfma_f32_16x16x32_bf16 v[52:55], v[36:39], a[80:83], v[52:55]
    v_mfma_f32_16x16x32_bf16 v[44:47], v[36:39], a[12:15], v[44:47]
    v_mfma_f32_16x16x32_bf16 v[48:51], v[36:39], a[48:51], v[48:51]
    v_mfma_f32_16x16x32_bf16 v[52:55], v[36:39], a[84:87], v[52:55]
    v_mfma_f32_16x16x32_bf16 v[44:47], v[36:39], a[16:19], v[44:47]
    v_mfma_f32_16x16x32_bf16 v[48:51], v[36:39], a[52:55], v[48:51]
    v_mfma_f32_16x16x32_bf16 v[52:55], v[36:39], a[88:91], v[52:55]
    v_mfma_f32_16x16x32_bf16 v[44:47], v[36:39], a[20:23], v[44:47]
    v_mfma_f32_16x16x32_bf16 v[48:51], v[36:39], a[56:59], v[48:51]
    v_mfma_f32_16x16x32_bf16 v[52:55], v[36:39], a[92:95], v[52:55]
    v_mfma_f32_16x16x32_bf16 v[44:47], v[36:39], a[24:27], v[44:47]
    v_mfma_f32_16x16x32_bf16 v[48:51], v[36:39], a[60:63], v[48:51]
    v_mfma_f32_16x16x32_bf16 v[52:55], v[36:39], a[96:99], v[52:55]
    v_mfma_f32_16x16x32_bf16 v[44:47], v[36:39], a[28:31], v[44:47]
    v_mfma_f32_16x16x32_bf16 v[48:51], v[36:39], a[64:67], v[48:51]
    v_mfma_f32_16x16x32_bf16 v[52:55], v[36:39], a[100:103], v[52:55]
    v_mfma_f32_16x16x32_bf16 v[44:47], v[36:39], a[32:35], v[44:47]
    v_mfma_f32_16x16x32_bf16 v[48:51], v[36:39], a[68:71], v[48:51]
    v_mfma_f32_16x16x32_bf16 v[52:55], v[36:39], a[104:107], v[52:55]
    s_nop 5
    v_add_f32_dpp v44, v44, v44 row_ror:8 row_mask:0xf bank_mask:0xf
    v_add_f32_dpp v45, v45, v45 row_ror:8 row_mask:0xf bank_mask:0xf
    v_add_f32_dpp v46, v46, v46 row_ror:8 row_mask:0xf bank_mask:0xf
    v_add_f32_dpp v47, v47, v47 row_ror:8 row_mask:0xf bank_mask:0xf
    v_cvt_pk_bf16_f32 v4, v44, v45
    v_lshlrev_b32 v5, 16, v4
    v_and_b32 v6, 0xffff0000, v4
    v_sub_f32 v5, v44, v5
    v_sub_f32 v6, v45, v6
    v_cvt_pk_bf16_f32 v5, v5, v6
    v_cndmask_b32 v210, v4, v5, s[94:95]
    v_cvt_pk_bf16_f32 v4, v46, v47
    v_lshlrev_b32 v5, 16, v4
    v_and_b32 v6, 0xffff0000, v4
    v_sub_f32 v5, v46, v5
    v_sub_f32 v6, v47, v6
    v_cvt_pk_bf16_f32 v5, v5, v6
    v_cndmask_b32 v211, v4, v5, s[94:95]
    v_add_f32_dpp v48, v48, v48 row_ror:8 row_mask:0xf bank_mask:0xf
    v_add_f32_dpp v49, v49, v49 row_ror:8 row_mask:0xf bank_mask:0xf
    v_add_f32_dpp v50, v50, v50 row_ror:8 row_mask:0xf bank_mask:0xf
    v_add_f32_dpp v51, v51, v51 row_ror:8 row_mask:0xf bank_mask:0xf
    v_cvt_pk_bf16_f32 v4, v48, v49
    v_lshlrev_b32 v5, 16, v4
    v_and_b32 v6, 0xffff0000, v4
    v_sub_f32 v5, v48, v5
    v_sub_f32 v6, v49, v6
    v_cvt_pk_bf16_f32 v5, v5, v6
    v_cndmask_b32 v212, v4, v5, s[94:95]
    v_cvt_pk_bf16_f32 v4, v50, v51
    v_lshlrev_b32 v5, 16, v4
    v_and_b32 v6, 0xffff0000, v4
    v_sub_f32 v5, v50, v5
    v_sub_f32 v6, v51, v6
    v_cvt_pk_bf16_f32 v5, v5, v6
    v_cndmask_b32 v213, v4, v5, s[94:95]
    v_add_f32_dpp v52, v52, v52 row_ror:8 row_mask:0xf bank_mask:0xf
    v_add_f32_dpp v53, v53, v53 row_ror:8 row_mask:0xf bank_mask:0xf
    v_add_f32_dpp v54, v54, v54 row_ror:8 row_mask:0xf bank_mask:0xf
    v_add_f32_dpp v55, v55, v55 row_ror:8 row_mask:0xf bank_mask:0xf
    v_cvt_pk_bf16_f32 v4, v52, v53
    v_lshlrev_b32 v5, 16, v4
    v_and_b32 v6, 0xffff0000, v4
    v_sub_f32 v5, v52, v5
    v_sub_f32 v6, v53, v6
    v_cvt_pk_bf16_f32 v5, v5, v6
    v_cndmask_b32 v214, v4, v5, s[94:95]
    v_cvt_pk_bf16_f32 v4, v54, v55
    v_lshlrev_b32 v5, 16, v4
    v_and_b32 v6, 0xffff0000, v4
    v_sub_f32 v5, v54, v5
    v_sub_f32 v6, v55, v6
    v_cvt_pk_bf16_f32 v5, v5, v6
    v_cndmask_b32 v215, v4, v5, s[94:95]
    s_add_u32 s86, s89, 768
    buffer_load_dwordx4 a[0:3], v34, s[8:11], s86 offen offset:0
    buffer_load_dwordx4 a[36:39], v34, s[8:11], s86 offen offset:128
    buffer_load_dwordx4 a[72:75], v34, s[8:11], s86 offen offset:256
    s_add_u32 s86, s86, 73728
    buffer_load_dwordx4 a[4:7], v34, s[8:11], s86 offen offset:0
    buffer_load_dwordx4 a[40:43], v34, s[8:11], s86 offen offset:128
    buffer_load_dwordx4 a[76:79], v34, s[8:11], s86 offen offset:256
    s_add_u32 s86, s86, 73728
    buffer_load_dwordx4 a[8:11], v34, s[8:11], s86 offen offset:0
    buffer_load_dwordx4 a[44:47], v34, s[8:11], s86 offen offset:128
    buffer_load_dwordx4 a[80:83], v34, s[8:11], s86 offen offset:256
    s_add_u32 s86, s86, 73728
    buffer_load_dwordx4 a[12:15], v34, s[8:11], s86 offen offset:0
    buffer_load_dwordx4 a[48:51], v34, s[8:11], s86 offen offset:128
    buffer_load_dwordx4 a[84:87], v34, s[8:11], s86 offen offset:256
    s_add_u32 s86, s86, 73728
    buffer_load_dwordx4 a[16:19], v34, s[8:11], s86 offen offset:0
    buffer_load_dwordx4 a[52:55], v34, s[8:11], s86 offen offset:128
    buffer_load_dwordx4 a[88:91], v34, s[8:11], s86 offen offset:256
    s_add_u32 s86, s86, 73728
    buffer_load_dwordx4 a[20:23], v34, s[8:11], s86 offen offset:0
    buffer_load_dwordx4 a[56:59], v34, s[8:11], s86 offen offset:128
    buffer_load_dwordx4 a[92:95], v34, s[8:11], s86 offen offset:256
    s_add_u32 s86, s86, 73728
    buffer_load_dwordx4 a[24:27], v34, s[8:11], s86 offen offset:0
    buffer_load_dwordx4 a[60:63], v34, s[8:11], s86 offen offset:128
    buffer_load_dwordx4 a[96:99], v34, s[8:11], s86 offen offset:256
    s_add_u32 s86, s86, 73728
    buffer_load_dwordx4 a[28:31], v34, s[8:11], s86 offen offset:0
    buffer_load_dwordx4 a[64:67], v34, s[8:11], s86 offen offset:128
    buffer_load_dwordx4 a[100:103], v34, s[8:11], s86 offen offset:256
    s_add_u32 s86, s86, 73728
    buffer_load_dwordx4 a[32:35], v34, s[8:11], s86 offen offset:0
    buffer_load_dwordx4 a[68:71], v34, s[8:11], s86 offen offset:128
    buffer_load_dwordx4 a[104:107], v34, s[8:11], s86 offen offset:256
    ds_read_b64_tr_b16 v[66:67], v31 offset:0
    ds_read_b64_tr_b16 v[68:69], v31 offset:4736
    ds_read_b64_tr_b16 v[70:71], v31 offset:32
    ds_read_b64_tr_b16 v[72:73], v31 offset:4768
    ds_read_b64_tr_b16 v[74:75], v31 offset:64
    ds_read_b64_tr_b16 v[76:77], v31 offset:4800
    ds_read_b64_tr_b16 v[78:79], v31 offset:96
    ds_read_b64_tr_b16 v[80:81], v31 offset:4832
    ds_read_b64_tr_b16 v[82:83], v31 offset:128
    ds_read_b64_tr_b16 v[84:85], v31 offset:4864
    ds_read_b64_tr_b16 v[86:87], v31 offset:160
    ds_read_b64_tr_b16 v[88:89], v31 offset:4896
    ds_read_b64_tr_b16 v[90:91], v31 offset:192
    ds_read_b64_tr_b16 v[92:93], v31 offset:4928
    ds_read_b64_tr_b16 v[94:95], v31 offset:224
    ds_read_b64_tr_b16 v[96:97], v31 offset:4960
    ds_read_b64_tr_b16 v[98:99], v31 offset:256
    ds_read_b64_tr_b16 v[100:101], v31 offset:4992
    ds_read_b64_tr_b16 v[102:103], v31 offset:288
    ds_read_b64_tr_b16 v[104:105], v31 offset:5024
    ds_read_b64_tr_b16 v[106:107], v31 offset:320
    ds_read_b64_tr_b16 v[108:109], v31 offset:5056
    ds_read_b64_tr_b16 v[110:111], v31 offset:352
    ds_read_b64_tr_b16 v[112:113], v31 offset:5088
    ds_read_b64_tr_b16 v[114:115], v31 offset:384
    ds_read_b64_tr_b16 v[116:117], v31 offset:5120
    ds_read_b64_tr_b16 v[118:119], v31 offset:416
    ds_read_b64_tr_b16 v[120:121], v31 offset:5152
    ds_read_b64_tr_b16 v[122:123], v31 offset:448
    ds_read_b64_tr_b16 v[124:125], v31 offset:5184
    ds_read_b64_tr_b16 v[126:127], v31 offset:480
    ds_read_b64_tr_b16 v[128:129], v31 offset:5216
    ds_read_b64_tr_b16 v[130:131], v31 offset:512
    ds_read_b64_tr_b16 v[132:133], v31 offset:5248
    ds_read_b64_tr_b16 v[134:135], v31 offset:544
    ds_read_b64_tr_b16 v[136:137], v31 offset:5280
    ds_read_b64_tr_b16 v[138:139], v31 offset:576
    ds_read_b64_tr_b16 v[140:141], v31 offset:5312
    ds_read_b64_tr_b16 v[142:143], v31 offset:608
    ds_read_b64_tr_b16 v[144:145], v31 offset:5344
    ds_read_b64_tr_b16 v[146:147], v31 offset:640
    ds_read_b64_tr_b16 v[148:149], v31 offset:5376
    ds_read_b64_tr_b16 v[150:151], v31 offset:672
    ds_read_b64_tr_b16 v[152:153], v31 offset:5408
    ds_read_b64_tr_b16 v[154:155], v31 offset:704
    ds_read_b64_tr_b16 v[156:157], v31 offset:5440
    ds_read_b64_tr_b16 v[158:159], v31 offset:736
    ds_read_b64_tr_b16 v[160:161], v31 offset:5472
    ds_read_b64_tr_b16 v[162:163], v31 offset:768
    ds_read_b64_tr_b16 v[164:165], v31 offset:5504
    ds_read_b64_tr_b16 v[166:167], v31 offset:800
    ds_read_b64_tr_b16 v[168:169], v31 offset:5536
    ds_read_b64_tr_b16 v[170:171], v31 offset:832
    ds_read_b64_tr_b16 v[172:173], v31 offset:5568
    ds_read_b64_tr_b16 v[174:175], v31 offset:864
    ds_read_b64_tr_b16 v[176:177], v31 offset:5600
    ds_read_b64_tr_b16 v[178:179], v31 offset:896
    ds_read_b64_tr_b16 v[180:181], v31 offset:5632
    ds_read_b64_tr_b16 v[182:183], v31 offset:928
    ds_read_b64_tr_b16 v[184:185], v31 offset:5664
    ds_read_b64_tr_b16 v[186:187], v31 offset:960
    ds_read_b64_tr_b16 v[188:189], v31 offset:5696
    ds_read_b64_tr_b16 v[190:191], v31 offset:992
    ds_read_b64_tr_b16 v[192:193], v31 offset:5728
    ds_read_b64_tr_b16 v[194:195], v31 offset:1024
    ds_read_b64_tr_b16 v[196:197], v31 offset:5760
    ds_read_b64_tr_b16 v[198:199], v31 offset:1056
    ds_read_b64_tr_b16 v[200:201], v31 offset:5792
    ds_read_b64_tr_b16 v[202:203], v31 offset:1088
    ds_read_b64_tr_b16 v[204:205], v31 offset:5824
    ds_read_b64_tr_b16 v[206:207], v31 offset:1120
    ds_read_b64_tr_b16 v[208:209], v31 offset:5856
    s_add_u32 s33, s84, 64
    s_sub_u32 s33, s33, s66
    s_lshl_b32 s33, s33, 15
    s_lshl_b32 s34, s83, 4
    s_add_u32 s33, s33, s34
    v_mov_b32 v7, s33
    v_add_u32 v4, 0, v0
    v_mul_u32_u24 v5, 7282, v4
    v_lshrrev_b32 v5, 16, v5
    v_mul_u32_u24 v6, 9, v5
    v_sub_u32 v4, v4, v6
    v_cmp_eq_u32 vcc, 8, v4
    v_lshlrev_b32 v4, 4, v4
    s_nop 0
    v_cndmask_b32 v4, v4, v7, vcc
    v_lshl_add_u32 v56, v5, 7, v4
    v_add_u32 v4, 64, v0
    v_mul_u32_u24 v5, 7282, v4
    v_lshrrev_b32 v5, 16, v5
    v_mul_u32_u24 v6, 9, v5
    v_sub_u32 v4, v4, v6
    v_cmp_eq_u32 vcc, 8, v4
    v_lshlrev_b32 v4, 4, v4
    s_nop 0
    v_cndmask_b32 v4, v4, v7, vcc
    v_lshl_add_u32 v57, v5, 7, v4
    v_add_u32 v4, 128, v0
    v_mul_u32_u24 v5, 7282, v4
    v_lshrrev_b32 v5, 16, v5
    v_mul_u32_u24 v6, 9, v5
    v_sub_u32 v4, v4, v6
    v_cmp_eq_u32 vcc, 8, v4
    v_lshlrev_b32 v4, 4, v4
    s_nop 0
    v_cndmask_b32 v4, v4, v7, vcc
    v_lshl_add_u32 v58, v5, 7, v4
    v_add_u32 v4, 192, v0
    v_mul_u32_u24 v5, 7282, v4
    v_lshrrev_b32 v5, 16, v5
    v_mul_u32_u24 v6, 9, v5
    v_sub_u32 v4, v4, v6
    v_cmp_eq_u32 vcc, 8, v4
    v_lshlrev_b32 v4, 4, v4
    s_nop 0
    v_cndmask_b32 v4, v4, v7, vcc
    v_lshl_add_u32 v59, v5, 7, v4
    v_add_u32 v4, 256, v0
    v_mul_u32_u24 v5, 7282, v4
    v_lshrrev_b32 v5, 16, v5
    v_mul_u32_u24 v6, 9, v5
    v_sub_u32 v4, v4, v6
    v_cmp_eq_u32 vcc, 8, v4
    v_lshlrev_b32 v4, 4, v4
    s_nop 0
    v_cndmask_b32 v4, v4, v7, vcc
    v_lshl_add_u32 v60, v5, 7, v4
    v_add_u32 v4, 320, v0
    v_mul_u32_u24 v5, 7282, v4
    v_lshrrev_b32 v5, 16, v5
    v_mul_u32_u24 v6, 9, v5
    v_sub_u32 v4, v4, v6
    v_cmp_eq_u32 vcc, 8, v4
    v_lshlrev_b32 v4, 4, v4
    s_nop 0
    v_cndmask_b32 v4, v4, v7, vcc
    v_lshl_add_u32 v61, v5, 7, v4
    v_add_u32 v4, 384, v0
    v_mul_u32_u24 v5, 7282, v4
    v_lshrrev_b32 v5, 16, v5
    v_mul_u32_u24 v6, 9, v5
    v_sub_u32 v4, v4, v6
    v_cmp_eq_u32 vcc, 8, v4
    v_lshlrev_b32 v4, 4, v4
    s_nop 0
    v_cndmask_b32 v4, v4, v7, vcc
    v_lshl_add_u32 v62, v5, 7, v4
    v_add_u32 v4, 448, v0
    v_mul_u32_u24 v5, 7282, v4
    v_lshrrev_b32 v5, 16, v5
    v_mul_u32_u24 v6, 9, v5
    v_sub_u32 v4, v4, v6
    v_cmp_eq_u32 vcc, 8, v4
    v_lshlrev_b32 v4, 4, v4
    s_nop 0
    v_cndmask_b32 v4, v4, v7, vcc
    v_lshl_add_u32 v63, v5, 7, v4
    v_add_u32 v4, 512, v0
    v_mul_u32_u24 v5, 7282, v4
    v_lshrrev_b32 v5, 16, v5
    v_mul_u32_u24 v6, 9, v5
    v_sub_u32 v4, v4, v6
    v_cmp_eq_u32 vcc, 8, v4
    v_lshlrev_b32 v4, 4, v4
    s_nop 0
    v_cndmask_b32 v4, v4, v7, vcc
    v_lshl_add_u32 v64, v5, 7, v4
    s_waitcnt lgkmcnt(0)
    buffer_store_dword v35, v254, s[16:19], s88 offen sc1
    buffer_store_dwordx4 v[66:69], v32, s[16:19], s82 offen sc1
    s_add_u32 s82, s82, 65536
    buffer_store_dwordx4 v[70:73], v32, s[16:19], s82 offen sc1
    s_add_u32 s82, s82, 65536
    buffer_store_dwordx4 v[74:77], v32, s[16:19], s82 offen sc1
    s_add_u32 s82, s82, 65536
    buffer_store_dwordx4 v[78:81], v32, s[16:19], s82 offen sc1
    s_add_u32 s82, s82, 65536
    buffer_store_dwordx4 v[82:85], v32, s[16:19], s82 offen sc1
    s_add_u32 s82, s82, 65536
    buffer_store_dwordx4 v[86:89], v32, s[16:19], s82 offen sc1
    s_add_u32 s82, s82, 65536
    buffer_store_dwordx4 v[90:93], v32, s[16:19], s82 offen sc1
    s_add_u32 s82, s82, 65536
    buffer_store_dwordx4 v[94:97], v32, s[16:19], s82 offen sc1
    s_waitcnt vmcnt(36)
    v_mfma_f32_16x16x32_bf16 v[44:47], v[36:39], a[108:111], 0
    v_mfma_f32_16x16x32_bf16 v[48:51], v[36:39], a[144:147], 0
    v_mfma_f32_16x16x32_bf16 v[52:55], v[36:39], a[180:183], 0
    v_mfma_f32_16x16x32_bf16 v[44:47], v[36:39], a[112:115], v[44:47]
    v_mfma_f32_16x16x32_bf16 v[48:51], v[36:39], a[148:151], v[48:51]
    v_mfma_f32_16x16x32_bf16 v[52:55], v[36:39], a[184:187], v[52:55]
    v_mfma_f32_16x16x32_bf16 v[44:47], v[36:39], a[116:119], v[44:47]
    v_mfma_f32_16x16x32_bf16 v[48:51], v[36:39], a[152:155], v[48:51]
    v_mfma_f32_16x16x32_bf16 v[52:55], v[36:39], a[188:191], v[52:55]
    v_mfma_f32_16x16x32_bf16 v[44:47], v[36:39], a[120:123], v[44:47]
    v_mfma_f32_16x16x32_bf16 v[48:51], v[36:39], a[156:159], v[48:51]
    v_mfma_f32_16x16x32_bf16 v[52:55], v[36:39], a[192:195], v[52:55]
    v_mfma_f32_16x16x32_bf16 v[44:47], v[36:39], a[124:127], v[44:47]
    v_mfma_f32_16x16x32_bf16 v[48:51], v[36:39], a[160:163], v[48:51]
    v_mfma_f32_16x16x32_bf16 v[52:55], v[36:39], a[196:199], v[52:55]
    v_mfma_f32_16x16x32_bf16 v[44:47], v[36:39], a[128:131], v[44:47]
    v_mfma_f32_16x16x32_bf16 v[48:51], v[36:39], a[164:167], v[48:51]
    v_mfma_f32_16x16x32_bf16 v[52:55], v[36:39], a[200:203], v[52:55]
    v_mfma_f32_16x16x32_bf16 v[44:47], v[36:39], a[132:135], v[44:47]
    v_mfma_f32_16x16x32_bf16 v[48:51], v[36:39], a[168:171], v[48:51]
    v_mfma_f32_16x16x32_bf16 v[52:55], v[36:39], a[204:207], v[52:55]
    v_mfma_f32_16x16x32_bf16 v[44:47], v[36:39], a[136:139], v[44:47]
    v_mfma_f32_16x16x32_bf16 v[48:51], v[36:39], a[172:175], v[48:51]
    v_mfma_f32_16x16x32_bf16 v[52:55], v[36:39], a[208:211], v[52:55]
    v_mfma_f32_16x16x32_bf16 v[44:47], v[36:39], a[140:143], v[44:47]
    v_mfma_f32_16x16x32_bf16 v[48:51], v[36:39], a[176:179], v[48:51]
    v_mfma_f32_16x16x32_bf16 v[52:55], v[36:39], a[212:215], v[52:55]
    s_nop 5
    v_add_f32_dpp v44, v44, v44 row_ror:8 row_mask:0xf bank_mask:0xf
    v_add_f32_dpp v45, v45, v45 row_ror:8 row_mask:0xf bank_mask:0xf
    v_add_f32_dpp v46, v46, v46 row_ror:8 row_mask:0xf bank_mask:0xf
    v_add_f32_dpp v47, v47, v47 row_ror:8 row_mask:0xf bank_mask:0xf
    v_cvt_pk_bf16_f32 v4, v44, v45
    v_lshlrev_b32 v5, 16, v4
    v_and_b32 v6, 0xffff0000, v4
    v_sub_f32 v5, v44, v5
    v_sub_f32 v6, v45, v6
    v_cvt_pk_bf16_f32 v5, v5, v6
    v_cndmask_b32 v216, v4, v5, s[94:95]
    v_cvt_pk_bf16_f32 v4, v46, v47
    v_lshlrev_b32 v5, 16, v4
    v_and_b32 v6, 0xffff0000, v4
    v_sub_f32 v5, v46, v5
    v_sub_f32 v6, v47, v6
    v_cvt_pk_bf16_f32 v5, v5, v6
    v_cndmask_b32 v217, v4, v5, s[94:95]
    v_add_f32_dpp v48, v48, v48 row_ror:8 row_mask:0xf bank_mask:0xf
    v_add_f32_dpp v49, v49, v49 row_ror:8 row_mask:0xf bank_mask:0xf
    v_add_f32_dpp v50, v50, v50 row_ror:8 row_mask:0xf bank_mask:0xf
    v_add_f32_dpp v51, v51, v51 row_ror:8 row_mask:0xf bank_mask:0xf
    v_cvt_pk_bf16_f32 v4, v48, v49
    v_lshlrev_b32 v5, 16, v4
    v_and_b32 v6, 0xffff0000, v4
    v_sub_f32 v5, v48, v5
    v_sub_f32 v6, v49, v6
    v_cvt_pk_bf16_f32 v5, v5, v6
    v_cndmask_b32 v218, v4, v5, s[94:95]
    v_cvt_pk_bf16_f32 v4, v50, v51
    v_lshlrev_b32 v5, 16, v4
    v_and_b32 v6, 0xffff0000, v4
    v_sub_f32 v5, v50, v5
    v_sub_f32 v6, v51, v6
    v_cvt_pk_bf16_f32 v5, v5, v6
    v_cndmask_b32 v219, v4, v5, s[94:95]
    v_add_f32_dpp v52, v52, v52 row_ror:8 row_mask:0xf bank_mask:0xf
    v_add_f32_dpp v53, v53, v53 row_ror:8 row_mask:0xf bank_mask:0xf
    v_add_f32_dpp v54, v54, v54 row_ror:8 row_mask:0xf bank_mask:0xf
    v_add_f32_dpp v55, v55, v55 row_ror:8 row_mask:0xf bank_mask:0xf
    v_cvt_pk_bf16_f32 v4, v52, v53
    v_lshlrev_b32 v5, 16, v4
    v_and_b32 v6, 0xffff0000, v4
    v_sub_f32 v5, v52, v5
    v_sub_f32 v6, v53, v6
    v_cvt_pk_bf16_f32 v5, v5, v6
    v_cndmask_b32 v220, v4, v5, s[94:95]
    v_cvt_pk_bf16_f32 v4, v54, v55
    v_lshlrev_b32 v5, 16, v4
    v_and_b32 v6, 0xffff0000, v4
    v_sub_f32 v5, v54, v5
    v_sub_f32 v6, v55, v6
    v_cvt_pk_bf16_f32 v5, v5, v6
    v_cndmask_b32 v221, v4, v5, s[94:95]
    s_add_u32 s82, s82, 65536
    buffer_store_dwordx4 v[98:101], v32, s[16:19], s82 offen sc1
    s_add_u32 s82, s82, 65536
    buffer_store_dwordx4 v[102:105], v32, s[16:19], s82 offen sc1
    s_add_u32 s82, s82, 65536
    buffer_store_dwordx4 v[106:109], v32, s[16:19], s82 offen sc1
    s_add_u32 s82, s82, 65536
    buffer_store_dwordx4 v[110:113], v32, s[16:19], s82 offen sc1
    s_add_u32 s82, s82, 65536
    buffer_store_dwordx4 v[114:117], v32, s[16:19], s82 offen sc1
    s_add_u32 s82, s82, 65536
    buffer_store_dwordx4 v[118:121], v32, s[16:19], s82 offen sc1
    s_add_u32 s82, s82, 65536
    buffer_store_dwordx4 v[122:125], v32, s[16:19], s82 offen sc1
    s_add_u32 s82, s82, 65536
    buffer_store_dwordx4 v[126:129], v32, s[16:19], s82 offen sc1
    s_add_u32 s82, s82, 65536
    buffer_store_dwordx4 v[130:133], v32, s[16:19], s82 offen sc1
    s_add_u32 s82, s82, 65536
    buffer_store_dwordx4 v[134:137], v32, s[16:19], s82 offen sc1
    s_add_u32 s82, s82, 65536
    buffer_store_dwordx4 v[138:141], v32, s[16:19], s82 offen sc1
    s_add_u32 s82, s82, 65536
    buffer_store_dwordx4 v[142:145], v32, s[16:19], s82 offen sc1
    s_add_u32 s82, s82, 65536
    buffer_store_dwordx4 v[146:149], v32, s[16:19], s82 offen sc1
    s_add_u32 s82, s82, 65536
    buffer_store_dwordx4 v[150:153], v32, s[16:19], s82 offen sc1
    s_add_u32 s82, s82, 65536
    buffer_store_dwordx4 v[154:157], v32, s[16:19], s82 offen sc1
    s_add_u32 s82, s82, 65536
    buffer_store_dwordx4 v[158:161], v32, s[16:19], s82 offen sc1
    s_add_u32 s82, s82, 65536
    buffer_store_dwordx4 v[162:165], v32, s[16:19], s82 offen sc1
    s_add_u32 s82, s82, 65536
    buffer_store_dwordx4 v[166:169], v32, s[16:19], s82 offen sc1
    s_add_u32 s82, s82, 65536
    buffer_store_dwordx4 v[170:173], v32, s[16:19], s82 offen sc1
    s_add_u32 s82, s82, 65536
    buffer_store_dwordx4 v[174:177], v32, s[16:19], s82 offen sc1
    s_add_u32 s82, s82, 65536
    buffer_store_dwordx4 v[178:181], v32, s[16:19], s82 offen sc1
    s_add_u32 s82, s82, 65536
    buffer_store_dwordx4 v[182:185], v32, s[16:19], s82 offen sc1
    s_add_u32 s82, s82, 65536
    buffer_store_dwordx4 v[186:189], v32, s[16:19], s82 offen sc1
    s_add_u32 s82, s82, 65536
    buffer_store_dwordx4 v[190:193], v32, s[16:19], s82 offen sc1
    s_add_u32 s82, s82, 65536
    buffer_store_dwordx4 v[194:197], v32, s[16:19], s82 offen sc1
    s_add_u32 s82, s82, 65536
    buffer_store_dwordx4 v[198:201], v32, s[16:19], s82 offen sc1
    s_add_u32 s82, s82, 65536
    buffer_store_dwordx4 v[202:205], v32, s[16:19], s82 offen sc1
    s_add_u32 s82, s82, 65536
    buffer_store_dwordx4 v[206:209], v32, s[16:19], s82 offen sc1
    s_waitcnt vmcnt(37)
    v_mfma_f32_16x16x32_bf16 v[44:47], v[36:39], a[0:3], 0
    v_mfma_f32_16x16x32_bf16 v[48:51], v[36:39], a[36:39], 0
    v_mfma_f32_16x16x32_bf16 v[52:55], v[36:39], a[72:75], 0
    v_mfma_f32_16x16x32_bf16 v[44:47], v[36:39], a[4:7], v[44:47]
    v_mfma_f32_16x16x32_bf16 v[48:51], v[36:39], a[40:43], v[48:51]
    v_mfma_f32_16x16x32_bf16 v[52:55], v[36:39], a[76:79], v[52:55]
    v_mfma_f32_16x16x32_bf16 v[44:47], v[36:39], a[8:11], v[44:47]
    v_mfma_f32_16x16x32_bf16 v[48:51], v[36:39], a[44:47], v[48:51]
    v_mfma_f32_16x16x32_bf16 v[52:55], v[36:39], a[80:83], v[52:55]
    v_mfma_f32_16x16x32_bf16 v[44:47], v[36:39], a[12:15], v[44:47]
    v_mfma_f32_16x16x32_bf16 v[48:51], v[36:39], a[48:51], v[48:51]
    v_mfma_f32_16x16x32_bf16 v[52:55], v[36:39], a[84:87], v[52:55]
    v_mfma_f32_16x16x32_bf16 v[44:47], v[36:39], a[16:19], v[44:47]
    v_mfma_f32_16x16x32_bf16 v[48:51], v[36:39], a[52:55], v[48:51]
    v_mfma_f32_16x16x32_bf16 v[52:55], v[36:39], a[88:91], v[52:55]
    v_mfma_f32_16x16x32_bf16 v[44:47], v[36:39], a[20:23], v[44:47]
    v_mfma_f32_16x16x32_bf16 v[48:51], v[36:39], a[56:59], v[48:51]
    v_mfma_f32_16x16x32_bf16 v[52:55], v[36:39], a[92:95], v[52:55]
    v_mfma_f32_16x16x32_bf16 v[44:47], v[36:39], a[24:27], v[44:47]
    v_mfma_f32_16x16x32_bf16 v[48:51], v[36:39], a[60:63], v[48:51]
    v_mfma_f32_16x16x32_bf16 v[52:55], v[36:39], a[96:99], v[52:55]
    v_mfma_f32_16x16x32_bf16 v[44:47], v[36:39], a[28:31], v[44:47]
    v_mfma_f32_16x16x32_bf16 v[48:51], v[36:39], a[64:67], v[48:51]
    v_mfma_f32_16x16x32_bf16 v[52:55], v[36:39], a[100:103], v[52:55]
    v_mfma_f32_16x16x32_bf16 v[44:47], v[36:39], a[32:35], v[44:47]
    v_mfma_f32_16x16x32_bf16 v[48:51], v[36:39], a[68:71], v[48:51]
    v_mfma_f32_16x16x32_bf16 v[52:55], v[36:39], a[104:107], v[52:55]
    s_nop 5
    v_add_f32_dpp v44, v44, v44 row_ror:8 row_mask:0xf bank_mask:0xf
    v_add_f32_dpp v45, v45, v45 row_ror:8 row_mask:0xf bank_mask:0xf
    v_add_f32_dpp v46, v46, v46 row_ror:8 row_mask:0xf bank_mask:0xf
    v_add_f32_dpp v47, v47, v47 row_ror:8 row_mask:0xf bank_mask:0xf
    v_cvt_pk_bf16_f32 v4, v44, v45
    v_lshlrev_b32 v5, 16, v4
    v_and_b32 v6, 0xffff0000, v4
    v_sub_f32 v5, v44, v5
    v_sub_f32 v6, v45, v6
    v_cvt_pk_bf16_f32 v5, v5, v6
    v_cndmask_b32 v222, v4, v5, s[94:95]
    v_cvt_pk_bf16_f32 v4, v46, v47
    v_lshlrev_b32 v5, 16, v4
    v_and_b32 v6, 0xffff0000, v4
    v_sub_f32 v5, v46, v5
    v_sub_f32 v6, v47, v6
    v_cvt_pk_bf16_f32 v5, v5, v6
    v_cndmask_b32 v223, v4, v5, s[94:95]
    v_add_f32_dpp v48, v48, v48 row_ror:8 row_mask:0xf bank_mask:0xf
    v_add_f32_dpp v49, v49, v49 row_ror:8 row_mask:0xf bank_mask:0xf
    v_add_f32_dpp v50, v50, v50 row_ror:8 row_mask:0xf bank_mask:0xf
    v_add_f32_dpp v51, v51, v51 row_ror:8 row_mask:0xf bank_mask:0xf
    v_cvt_pk_bf16_f32 v4, v48, v49
    v_lshlrev_b32 v5, 16, v4
    v_and_b32 v6, 0xffff0000, v4
    v_sub_f32 v5, v48, v5
    v_sub_f32 v6, v49, v6
    v_cvt_pk_bf16_f32 v5, v5, v6
    v_cndmask_b32 v224, v4, v5, s[94:95]
    v_cvt_pk_bf16_f32 v4, v50, v51
    v_lshlrev_b32 v5, 16, v4
    v_and_b32 v6, 0xffff0000, v4
    v_sub_f32 v5, v50, v5
    v_sub_f32 v6, v51, v6
    v_cvt_pk_bf16_f32 v5, v5, v6
    v_cndmask_b32 v225, v4, v5, s[94:95]
    v_add_f32_dpp v52, v52, v52 row_ror:8 row_mask:0xf bank_mask:0xf
    v_add_f32_dpp v53, v53, v53 row_ror:8 row_mask:0xf bank_mask:0xf
    v_add_f32_dpp v54, v54, v54 row_ror:8 row_mask:0xf bank_mask:0xf
    v_add_f32_dpp v55, v55, v55 row_ror:8 row_mask:0xf bank_mask:0xf
    v_cvt_pk_bf16_f32 v4, v52, v53
    v_lshlrev_b32 v5, 16, v4
    v_and_b32 v6, 0xffff0000, v4
    v_sub_f32 v5, v52, v5
    v_sub_f32 v6, v53, v6
    v_cvt_pk_bf16_f32 v5, v5, v6
    v_cndmask_b32 v226, v4, v5, s[94:95]
    v_cvt_pk_bf16_f32 v4, v54, v55
    v_lshlrev_b32 v5, 16, v4
    v_and_b32 v6, 0xffff0000, v4
    v_sub_f32 v5, v54, v5
    v_sub_f32 v6, v55, v6
    v_cvt_pk_bf16_f32 v5, v5, v6
    v_cndmask_b32 v227, v4, v5, s[94:95]
    s_mov_b32 exec_hi, 0
    buffer_store_dwordx2 v[210:211], v42, s[16:19], s96 offen offset:0 sc1
    buffer_store_dwordx2 v[212:213], v42, s[16:19], s96 offen offset:128 sc1
    buffer_store_dwordx2 v[214:215], v42, s[16:19], s96 offen offset:256 sc1
    buffer_store_dwordx2 v[216:217], v42, s[16:19], s96 offen offset:384 sc1
    buffer_store_dwordx2 v[218:219], v42, s[16:19], s96 offen offset:512 sc1
    buffer_store_dwordx2 v[220:221], v42, s[16:19], s96 offen offset:640 sc1
    buffer_store_dwordx2 v[222:223], v42, s[16:19], s96 offen offset:768 sc1
    buffer_store_dwordx2 v[224:225], v42, s[16:19], s96 offen offset:896 sc1
    buffer_store_dwordx2 v[226:227], v42, s[16:19], s96 offen offset:1024 sc1
    s_mov_b32 exec_hi, -1
    s_waitcnt vmcnt(9)
    buffer_store_dword v43, v40, s[16:19], s5 offen sc1
    v_mov_b32 v4, s67
    v_add_u32_sdwa v210, v240, v4 dst_sel:DWORD dst_unused:UNUSED_PAD src0_sel:WORD_0 src1_sel:DWORD
    v_add_u32_sdwa v211, v240, v4 dst_sel:DWORD dst_unused:UNUSED_PAD src0_sel:WORD_1 src1_sel:DWORD
    v_add_u32_sdwa v212, v241, v4 dst_sel:DWORD dst_unused:UNUSED_PAD src0_sel:WORD_0 src1_sel:DWORD
    v_add_u32_sdwa v213, v241, v4 dst_sel:DWORD dst_unused:UNUSED_PAD src0_sel:WORD_1 src1_sel:DWORD
    v_add_u32_sdwa v214, v242, v4 dst_sel:DWORD dst_unused:UNUSED_PAD src0_sel:WORD_0 src1_sel:DWORD
    v_add_u32_sdwa v215, v242, v4 dst_sel:DWORD dst_unused:UNUSED_PAD src0_sel:WORD_1 src1_sel:DWORD
    v_add_u32_sdwa v216, v243, v4 dst_sel:DWORD dst_unused:UNUSED_PAD src0_sel:WORD_0 src1_sel:DWORD
    v_add_u32_sdwa v217, v243, v4 dst_sel:DWORD dst_unused:UNUSED_PAD src0_sel:WORD_1 src1_sel:DWORD
    v_add_u32_sdwa v218, v244, v4 dst_sel:DWORD dst_unused:UNUSED_PAD src0_sel:WORD_0 src1_sel:DWORD
    v_add_u32_sdwa v219, v244, v4 dst_sel:DWORD dst_unused:UNUSED_PAD src0_sel:WORD_1 src1_sel:DWORD
    v_add_u32_sdwa v220, v245, v4 dst_sel:DWORD dst_unused:UNUSED_PAD src0_sel:WORD_0 src1_sel:DWORD
    v_add_u32_sdwa v221, v246, v4 dst_sel:DWORD dst_unused:UNUSED_PAD src0_sel:WORD_0 src1_sel:DWORD
    v_add_u32_sdwa v222, v246, v4 dst_sel:DWORD dst_unused:UNUSED_PAD src0_sel:WORD_1 src1_sel:DWORD
    v_add_u32_sdwa v223, v247, v4 dst_sel:DWORD dst_unused:UNUSED_PAD src0_sel:WORD_0 src1_sel:DWORD
    v_add_u32_sdwa v224, v247, v4 dst_sel:DWORD dst_unused:UNUSED_PAD src0_sel:WORD_1 src1_sel:DWORD
    v_add_u32_sdwa v225, v248, v4 dst_sel:DWORD dst_unused:UNUSED_PAD src0_sel:WORD_0 src1_sel:DWORD
    v_add_u32_sdwa v226, v248, v4 dst_sel:DWORD dst_unused:UNUSED_PAD src0_sel:WORD_1 src1_sel:DWORD
    v_add_u32_sdwa v227, v249, v4 dst_sel:DWORD dst_unused:UNUSED_PAD src0_sel:WORD_0 src1_sel:DWORD
    v_add_u32_sdwa v228, v249, v4 dst_sel:DWORD dst_unused:UNUSED_PAD src0_sel:WORD_1 src1_sel:DWORD
    v_add_u32_sdwa v229, v250, v4 dst_sel:DWORD dst_unused:UNUSED_PAD src0_sel:WORD_0 src1_sel:DWORD
    v_add_u32_sdwa v230, v250, v4 dst_sel:DWORD dst_unused:UNUSED_PAD src0_sel:WORD_1 src1_sel:DWORD
    v_add_u32_sdwa v231, v251, v4 dst_sel:DWORD dst_unused:UNUSED_PAD src0_sel:WORD_0 src1_sel:DWORD
    s_waitcnt vmcnt(1)
    buffer_store_dword v43, v41, s[16:19], s5 offen sc1
    v_mov_b32 v4, 91908
L_lw_27:
    ds_read_b32 v5, v4
    s_waitcnt lgkmcnt(0)
    v_cmp_ne_u32 vcc, 3, v5
    s_cbranch_vccnz L_lw_27
    s_call_b64 s[6:7], L_exp
    v_add_u32 v18, 8448, v18
    buffer_load_dword v35, v254, s[16:19], s4 offen sc1
    s_call_b64 s[6:7], L_exp
    v_subrev_u32 v18, 8448, v18
    s_waitcnt vmcnt(0)
    s_lshl_b32 s34, s66, 15
    v_cmp_eq_u32 vcc, 0, v35
    s_cbranch_vccnz L_slow_30
L_ok_28:
    s_mov_b32 m0, 97024
    s_nop 0
    buffer_load_dwordx4 v56, s[16:19], s34 offen sc1 lds
    s_mov_b32 m0, 98048
    s_nop 0
    buffer_load_dwordx4 v57, s[16:19], s34 offen sc1 lds
    s_mov_b32 m0, 99072
    s_nop 0
    buffer_load_dwordx4 v58, s[16:19], s34 offen sc1 lds
    s_mov_b32 m0, 100096
    s_nop 0
    buffer_load_dwordx4 v59, s[16:19], s34 offen sc1 lds
    s_mov_b32 m0, 101120
    s_nop 0
    buffer_load_dwordx4 v60, s[16:19], s34 offen sc1 lds
    s_mov_b32 m0, 102144
    s_nop 0
    buffer_load_dwordx4 v61, s[16:19], s34 offen sc1 lds
    s_mov_b32 m0, 103168
    s_nop 0
    buffer_load_dwordx4 v62, s[16:19], s34 offen sc1 lds
    s_mov_b32 m0, 104192
    s_nop 0
    buffer_load_dwordx4 v63, s[16:19], s34 offen sc1 lds
    s_mov_b32 m0, 105216
    s_nop 0
    buffer_load_dwordx4 v64, s[16:19], s34 offen sc1 lds
    s_add_u32 s34, s34, 8192
    s_mov_b32 m0, 106240
    s_nop 0
    buffer_load_dwordx4 v56, s[16:19], s34 offen sc1 lds
    s_mov_b32 m0, 107264
    s_nop 0
    buffer_load_dwordx4 v57, s[16:19], s34 offen sc1 lds
    s_mov_b32 m0, 108288
    s_nop 0
    buffer_load_dwordx4 v58, s[16:19], s34 offen sc1 lds
    s_mov_b32 m0, 109312
    s_nop 0
    buffer_load_dwordx4 v59, s[16:19], s34 offen sc1 lds
    s_mov_b32 m0, 110336
    s_nop 0
    buffer_load_dwordx4 v60, s[16:19], s34 offen sc1 lds
    s_mov_b32 m0, 111360
    s_nop 0
    buffer_load_dwordx4 v61, s[16:19], s34 offen sc1 lds
    s_mov_b32 m0, 112384
    s_nop 0
    buffer_load_dwordx4 v62, s[16:19], s34 offen sc1 lds
    s_mov_b32 m0, 113408
    s_nop 0
    buffer_load_dwordx4 v63, s[16:19], s34 offen sc1 lds
    s_mov_b32 m0, 114432
    s_nop 0
    buffer_load_dwordx4 v64, s[16:19], s34 offen sc1 lds
    s_add_u32 s34, s34, 8192
    s_mov_b32 m0, 115456
    s_nop 0
    buffer_load_dwordx4 v56, s[16:19], s34 offen sc1 lds
    s_mov_b32 m0, 116480
    s_nop 0
    buffer_load_dwordx4 v57, s[16:19], s34 offen sc1 lds
    s_mov_b32 m0, 117504
    s_nop 0
    buffer_load_dwordx4 v58, s[16:19], s34 offen sc1 lds
    s_mov_b32 m0, 118528
    s_nop 0
    buffer_load_dwordx4 v59, s[16:19], s34 offen sc1 lds
    s_mov_b32 m0, 119552
    s_nop 0
    buffer_load_dwordx4 v60, s[16:19], s34 offen sc1 lds
    s_mov_b32 m0, 120576
    s_nop 0
    buffer_load_dwordx4 v61, s[16:19], s34 offen sc1 lds
    s_mov_b32 m0, 121600
    s_nop 0
    buffer_load_dwordx4 v62, s[16:19], s34 offen sc1 lds
    s_mov_b32 m0, 122624
    s_nop 0
    buffer_load_dwordx4 v63, s[16:19], s34 offen sc1 lds
    s_mov_b32 m0, 123648
    s_nop 0
    buffer_load_dwordx4 v64, s[16:19], s34 offen sc1 lds
    s_add_u32 s34, s34, 8192
    s_mov_b32 m0, 124672
    s_nop 0
    buffer_load_dwordx4 v56, s[16:19], s34 offen sc1 lds
    s_mov_b32 m0, 125696
    s_nop 0
    buffer_load_dwordx4 v57, s[16:19], s34 offen sc1 lds
    s_mov_b32 m0, 126720
    s_nop 0
    buffer_load_dwordx4 v58, s[16:19], s34 offen sc1 lds
    s_mov_b32 m0, 127744
    s_nop 0
    buffer_load_dwordx4 v59, s[16:19], s34 offen sc1 lds
    s_mov_b32 m0, 128768
    s_nop 0
    buffer_load_dwordx4 v60, s[16:19], s34 offen sc1 lds
    s_mov_b32 m0, 129792
    s_nop 0
    buffer_load_dwordx4 v61, s[16:19], s34 offen sc1 lds
    s_mov_b32 m0, 130816
    s_nop 0
    buffer_load_dwordx4 v62, s[16:19], s34 offen sc1 lds
    s_mov_b32 m0, 131840
    s_nop 0
    buffer_load_dwordx4 v63, s[16:19], s34 offen sc1 lds
    s_mov_b32 m0, 132864
    s_nop 0
    buffer_load_dwordx4 v64, s[16:19], s34 offen sc1 lds
    s_add_u32 s33, s97, 0
    buffer_load_dword a227, v234, s[12:15], s33 offen
    s_add_u32 s33, s97, 442752
    buffer_load_dword a227, v234, s[12:15], s33 offen
    s_add_u32 s33, s97, 885504
    buffer_load_dword a227, v234, s[12:15], s33 offen
    s_add_u32 s33, s97, 27648
    buffer_load_dword a227, v234, s[12:15], s33 offen
    s_add_u32 s33, s97, 470400
    buffer_load_dword a227, v234, s[12:15], s33 offen
    s_add_u32 s33, s97, 913152
    buffer_load_dword a227, v234, s[12:15], s33 offen
    s_waitcnt vmcnt(6)
    v_mov_b32 v4, 91904
    v_mov_b32 v5, 1
    ds_write_b32 v4, v5
    buffer_store_byte v5, v24, s[28:31], s66 offen sc1
    s_mov_b32 s81, 3
L_cvs:
    s_lshl_b32 s80, s70, 12
    s_call_b64 s[6:7], L_conv
    s_cmp_eq_u32 s3, 2
    s_cbranch_scc1 L_c2
    s_cmp_eq_u32 s3, 3
    s_cbranch_scc1 L_tw4
    s_cmp_eq_u32 s3, 1
    s_cbranch_scc1 L_tw3
    s_add_u32 s33, s87, 768
    buffer_load_dword a227, v234, s[12:15], s33 offen
    s_add_u32 s33, s87, 442368
    buffer_load_dword a227, v234, s[12:15], s33 offen
    s_add_u32 s33, s87, 885120
    buffer_load_dword a227, v234, s[12:15], s33 offen
    s_add_u32 s33, s87, 28416
    buffer_load_dword a227, v234, s[12:15], s33 offen
    s_add_u32 s33, s87, 470016
    buffer_load_dword a227, v234, s[12:15], s33 offen
    s_add_u32 s33, s87, 912768
    buffer_load_dword a227, v234, s[12:15], s33 offen
    s_branch L_c2
L_tw3:
    s_add_u32 s33, s87, 384
    buffer_load_dword a227, v234, s[12:15], s33 offen
    s_add_u32 s33, s87, 443136
    buffer_load_dword a227, v234, s[12:15], s33 offen
    s_add_u32 s33, s87, 884736
    buffer_load_dword a227, v234, s[12:15], s33 offen
    s_add_u32 s33, s87, 28032
    buffer_load_dword a227, v234, s[12:15], s33 offen
    s_add_u32 s33, s87, 470784
    buffer_load_dword a227, v234, s[12:15], s33 offen
    s_add_u32 s33, s87, 912384
    buffer_load_dword a227, v234, s[12:15], s33 offen
    s_branch L_c2
L_tw4:
    s_call_b64 s[6:7], L_exp
L_c2:
    v_add_u32 v19, 8448, v19
    v_add_u32 v2, 8448, v2
    s_lshl_b32 s80, s71, 12
    s_call_b64 s[6:7], L_conv
    s_cmp_lg_u32 s81, 3
    s_cbranch_scc1 L_c3
    v_subrev_u32 v19, 8448, v19
    v_subrev_u32 v2, 8448, v2
    s_lshl_b32 s80, s72, 12
    s_call_b64 s[6:7], L_conv
L_c3:
    s_mov_b32 s5, 33031168
    v_mov_b32 v4, 91912
    v_mov_b32 v5, 1
    s_mov_b64 exec, 1
    s_waitcnt vmcnt(0)
    ds_add_rtn_u32 v5, v4, v5
    s_mov_b64 exec, -1
    v_mov_b32 v4, 1
    s_waitcnt lgkmcnt(0)
    v_readfirstlane_b32 s33, v5
    s_nop 0
    s_cmp_lg_u32 s33, 3
    s_cbranch_scc1 L_sdone
    buffer_store_dword v4, v237, s[16:19], s5 offen sc1
L_sdone:
    s_endpgm
L_exp:
    ds_read_u16 v144, v210
    ds_read_u16 v145, v211
    ds_read_u16 v146, v212
    ds_read_u16 v147, v213
    ds_read_u16 v148, v214
    ds_read_u16 v149, v215
    ds_read_u16 v150, v216
    ds_read_u16 v151, v217
    ds_read_u16 v152, v218
    ds_read_u16 v153, v219
    ds_read_u16 v154, v220
    ds_read_u16 v156, v221
    ds_read_u16 v157, v222
    ds_read_u16 v158, v223
    ds_read_u16 v159, v224
    ds_read_u16 v160, v225
    ds_read_u16 v161, v226
    ds_read_u16 v162, v227
    ds_read_u16 v163, v228
    ds_read_u16 v164, v229
    ds_read_u16 v165, v230
    ds_read_u16 v166, v231
    v_add_u32 v210, 2688, v210
    v_add_u32 v211, 2688, v211
    v_add_u32 v212, 2688, v212
    v_add_u32 v213, 2688, v213
    v_add_u32 v214, 2688, v214
    v_add_u32 v215, 2688, v215
    v_add_u32 v216, 2688, v216
    v_add_u32 v217, 2688, v217
    v_add_u32 v218, 2688, v218
    v_add_u32 v219, 2688, v219
    v_add_u32 v220, 2688, v220
    v_add_u32 v221, 2688, v221
    v_add_u32 v222, 2688, v222
    v_add_u32 v223, 2688, v223
    v_add_u32 v224, 2688, v224
    v_add_u32 v225, 2688, v225
    v_add_u32 v226, 2688, v226
    v_add_u32 v227, 2688, v227
    v_add_u32 v228, 2688, v228
    v_add_u32 v229, 2688, v229
    v_add_u32 v230, 2688, v230
    v_add_u32 v231, 2688, v231
    s_waitcnt lgkmcnt(11)
    v_lshl_or_b32 v168, v145, 16, v144
    v_lshl_or_b32 v169, v147, 16, v146
    v_lshl_or_b32 v170, v149, 16, v148
    v_lshl_or_b32 v171, v151, 16, v150
    v_lshl_or_b32 v172, v146, 16, v145
    v_lshl_or_b32 v173, v148, 16, v147
    v_lshl_or_b32 v174, v150, 16, v149
    v_lshl_or_b32 v175, v152, 16, v151
    v_lshl_or_b32 v176, v147, 16, v146
    v_lshl_or_b32 v177, v149, 16, v148
    v_lshl_or_b32 v178, v151, 16, v150
    v_lshl_or_b32 v179, v153, 16, v152
    v_lshl_or_b32 v180, v148, 16, v147
    v_lshl_or_b32 v181, v150, 16, v149
    v_lshl_or_b32 v182, v152, 16, v151
    v_lshl_or_b32 v183, v154, 16, v153
    ds_write_b128 v18, v[168:171] offset:0
    ds_write_b128 v18, v[172:175] offset:2112
    ds_write_b128 v18, v[176:179] offset:4224
    ds_write_b128 v18, v[180:183] offset:6336
    s_waitcnt lgkmcnt(4)
    v_lshl_or_b32 v184, v157, 16, v156
    v_lshl_or_b32 v185, v159, 16, v158
    v_lshl_or_b32 v186, v161, 16, v160
    v_lshl_or_b32 v187, v163, 16, v162
    v_lshl_or_b32 v188, v158, 16, v157
    v_lshl_or_b32 v189, v160, 16, v159
    v_lshl_or_b32 v190, v162, 16, v161
    v_lshl_or_b32 v191, v164, 16, v163
    v_lshl_or_b32 v192, v159, 16, v158
    v_lshl_or_b32 v193, v161, 16, v160
    v_lshl_or_b32 v194, v163, 16, v162
    v_lshl_or_b32 v195, v165, 16, v164
    v_lshl_or_b32 v196, v160, 16, v159
    v_lshl_or_b32 v197, v162, 16, v161
    v_lshl_or_b32 v198, v164, 16, v163
    v_lshl_or_b32 v199, v166, 16, v165
    ds_write_b128 v18, v[184:187] offset:1024
    ds_write_b128 v18, v[188:191] offset:3136
    ds_write_b128 v18, v[192:195] offset:5248
    ds_write_b128 v18, v[196:199] offset:7360
    s_setpc_b64 s[6:7]
L_conv:
    ds_read_b64 a[136:137], v19 offset:1024
    ds_read_b64 a[138:139], v19 offset:1032
    ds_read_b64 a[140:141], v19 offset:512
    ds_read_b64 a[142:143], v19 offset:520
    ds_read_b128 a[72:75], v22 offset:4032
    ds_read_b128 a[76:79], v22 offset:8640
    ds_read_b128 a[80:83], v22 offset:13248
    ds_read_b128 a[84:87], v22 offset:17856
    ds_read_b128 a[88:91], v22 offset:22464
    ds_read_b128 a[92:95], v22 offset:27072
    ds_read_b128 a[96:99], v22 offset:31680
    ds_read_b128 a[100:103], v22 offset:36288
    ds_read_b64 a[152:153], v19 offset:0
    ds_read_b64 a[154:155], v19 offset:8
    ds_read_b64 a[156:157], v19 offset:1120
    ds_read_b64 a[158:159], v19 offset:1128
    s_add_u32 s80, s80, 2359296
    s_waitcnt lgkmcnt(0)
    v_mfma_f32_16x16x32_bf16 v[28:31], a[136:139], a[72:75], 0
    ds_read_b64 a[144:145], v19 offset:960
    ds_read_b64 a[146:147], v19 offset:968
    v_mfma_f32_16x16x32_bf16 v[32:35], a[136:139], a[76:79], 0
    ds_read_b64 a[148:149], v19 offset:448
    ds_read_b64 a[150:151], v19 offset:456
    v_mfma_f32_16x16x32_bf16 v[36:39], a[136:139], a[80:83], 0
    ds_read_b128 a[104:107], v22 offset:3456
    ds_read_b128 a[108:111], v22 offset:8064
    v_mfma_f32_16x16x32_bf16 v[40:43], a[136:139], a[84:87], 0
    ds_read_b128 a[112:115], v22 offset:12672
    ds_read_b128 a[116:119], v22 offset:17280
    v_mfma_f32_16x16x32_bf16 v[44:47], a[136:139], a[88:91], 0
    ds_read_b128 a[120:123], v22 offset:21888
    ds_read_b128 a[124:127], v22 offset:26496
    v_mfma_f32_16x16x32_bf16 v[48:51], a[136:139], a[92:95], 0
    ds_read_b128 a[128:131], v22 offset:31104
    ds_read_b128 a[132:135], v22 offset:35712
    v_mfma_f32_16x16x32_bf16 v[52:55], a[136:139], a[96:99], 0
    ds_read_b64_tr_b16 a[0:1], v232 offset:0
    ds_read_b64_tr_b16 a[2:3], v232 offset:1152
    v_mfma_f32_16x16x32_bf16 v[56:59], a[136:139], a[100:103], 0
    ds_read_b64_tr_b16 a[4:5], v232 offset:4608
    ds_read_b64_tr_b16 a[6:7], v232 offset:5760
    v_mfma_f32_16x16x32_bf16 v[32:35], a[140:143], a[72:75], v[32:35]
    ds_read_b64_tr_b16 a[8:9], v232 offset:9216
    ds_read_b64_tr_b16 a[10:11], v232 offset:10368
    v_mfma_f32_16x16x32_bf16 v[36:39], a[140:143], a[76:79], v[36:39]
    ds_read_b64_tr_b16 a[12:13], v232 offset:13824
    v_mfma_f32_16x16x32_bf16 v[40:43], a[140:143], a[80:83], v[40:43]
    ds_read_b64_tr_b16 a[14:15], v232 offset:14976
    v_mfma_f32_16x16x32_bf16 v[44:47], a[140:143], a[84:87], v[44:47]
    ds_read_b64_tr_b16 a[16:17], v232 offset:18432
    v_mfma_f32_16x16x32_bf16 v[48:51], a[140:143], a[88:91], v[48:51]
    ds_read_b64_tr_b16 a[18:19], v232 offset:19584
    v_mfma_f32_16x16x32_bf16 v[52:55], a[140:143], a[92:95], v[52:55]
    ds_read_b64_tr_b16 a[20:21], v232 offset:23040
    v_mfma_f32_16x16x32_bf16 v[56:59], a[140:143], a[96:99], v[56:59]
    ds_read_b64_tr_b16 a[22:23], v232 offset:24192
    v_mfma_f32_16x16x32_bf16 v[36:39], a[152:155], a[72:75], v[36:39]
    ds_read_b64 v[144:145], v2 offset:1728
    v_mfma_f32_16x16x32_bf16 v[40:43], a[152:155], a[76:79], v[40:43]
    ds_read_b64 v[146:147], v2 offset:1736
    v_mfma_f32_16x16x32_bf16 v[44:47], a[152:155], a[80:83], v[44:47]
    ds_read_b64 v[148:149], v2 offset:1696
    v_mfma_f32_16x16x32_bf16 v[48:51], a[152:155], a[84:87], v[48:51]
    ds_read_b64 v[150:151], v2 offset:1704
    v_mfma_f32_16x16x32_bf16 v[52:55], a[152:155], a[88:91], v[52:55]
    ds_read_b64 v[152:153], v2 offset:1664
    v_mfma_f32_16x16x32_bf16 v[56:59], a[152:155], a[92:95], v[56:59]
    ds_read_b64 v[154:155], v2 offset:1672
    v_mfma_f32_16x16x32_bf16 v[44:47], a[156:159], a[72:75], v[44:47]
    ds_read_b64 v[156:157], v2 offset:1632
    v_mfma_f32_16x16x32_bf16 v[48:51], a[156:159], a[76:79], v[48:51]
    ds_read_b64 v[158:159], v2 offset:1640
    v_mfma_f32_16x16x32_bf16 v[52:55], a[156:159], a[80:83], v[52:55]
    v_mfma_f32_16x16x32_bf16 v[56:59], a[156:159], a[84:87], v[56:59]
    s_waitcnt lgkmcnt(15)
    v_mfma_f32_16x16x32_bf16 v[28:31], a[144:147], a[104:107], v[28:31]
    ds_read_b64 a[136:137], v19 offset:896
    v_mfma_f32_16x16x32_bf16 v[32:35], a[144:147], a[108:111], v[32:35]
    ds_read_b64 a[138:139], v19 offset:904
    v_mfma_f32_16x16x32_bf16 v[36:39], a[144:147], a[112:115], v[36:39]
    ds_read_b64 a[140:141], v19 offset:384
    v_mfma_f32_16x16x32_bf16 v[40:43], a[144:147], a[116:119], v[40:43]
    ds_read_b64 a[142:143], v19 offset:392
    v_mfma_f32_16x16x32_bf16 v[44:47], a[144:147], a[120:123], v[44:47]
    ds_read_b128 a[72:75], v22 offset:2880
    v_mfma_f32_16x16x32_bf16 v[48:51], a[144:147], a[124:127], v[48:51]
    ds_read_b128 a[76:79], v22 offset:7488
    v_mfma_f32_16x16x32_bf16 v[52:55], a[144:147], a[128:131], v[52:55]
    ds_read_b128 a[80:83], v22 offset:12096
    v_mfma_f32_16x16x32_bf16 v[56:59], a[144:147], a[132:135], v[56:59]
    ds_read_b128 a[84:87], v22 offset:16704
    v_mfma_f32_16x16x32_bf16 v[32:35], a[148:151], a[104:107], v[32:35]
    ds_read_b128 a[88:91], v22 offset:21312
    v_mfma_f32_16x16x32_bf16 v[36:39], a[148:151], a[108:111], v[36:39]
    ds_read_b128 a[92:95], v22 offset:25920
    v_mfma_f32_16x16x32_bf16 v[40:43], a[148:151], a[112:115], v[40:43]
    ds_read_b128 a[96:99], v22 offset:30528
    v_mfma_f32_16x16x32_bf16 v[44:47], a[148:151], a[116:119], v[44:47]
    ds_read_b128 a[100:103], v22 offset:35136
    v_mfma_f32_16x16x32_bf16 v[48:51], a[148:151], a[120:123], v[48:51]
    v_mfma_f32_16x16x32_bf16 v[52:55], a[148:151], a[124:127], v[52:55]
    v_mfma_f32_16x16x32_bf16 v[56:59], a[148:151], a[128:131], v[56:59]
    s_waitcnt lgkmcnt(12)
    v_mfma_f32_16x16x32_bf16 v[112:115], a[0:3], v[144:147], 0
    v_and_b32 v160, v144, v10
    v_and_b32 v161, v145, v10
    v_mfma_f32_16x16x32_bf16 v[116:119], a[4:7], v[144:147], 0
    v_and_b32 v162, v146, v10
    v_and_b32 v163, v147, v10
    v_mfma_f32_16x16x32_bf16 v[120:123], a[8:11], v[144:147], 0
    v_and_b32 v164, v148, v10
    v_and_b32 v165, v149, v10
    v_mfma_f32_16x16x32_bf16 v[124:127], a[12:15], v[144:147], 0
    v_and_b32 v166, v150, v10
    v_and_b32 v167, v151, v10
    v_mfma_f32_16x16x32_bf16 v[116:119], a[0:3], v[148:151], v[116:119]
    v_and_b32 v168, v152, v10
    v_and_b32 v169, v153, v10
    v_mfma_f32_16x16x32_bf16 v[120:123], a[4:7], v[148:151], v[120:123]
    v_and_b32 v170, v154, v10
    v_and_b32 v171, v155, v10
    v_mfma_f32_16x16x32_bf16 v[124:127], a[8:11], v[148:151], v[124:127]
    v_and_b32 v172, v156, v10
    v_and_b32 v173, v157, v10
    v_mfma_f32_16x16x32_bf16 v[120:123], a[0:3], v[152:155], v[120:123]
    v_and_b32 v174, v158, v10
    v_and_b32 v175, v159, v10
    v_mfma_f32_16x16x32_bf16 v[124:127], a[4:7], v[152:155], v[124:127]
    v_mfma_f32_16x16x32_bf16 v[124:127], a[0:3], v[156:159], v[124:127]
    s_waitcnt lgkmcnt(0)
    v_mfma_f32_16x16x32_bf16 v[28:31], a[136:139], a[72:75], v[28:31]
    ds_read_b64 a[144:145], v19 offset:832
    ds_read_b64 a[146:147], v19 offset:840
    v_mfma_f32_16x16x32_bf16 v[32:35], a[136:139], a[76:79], v[32:35]
    ds_read_b64 a[148:149], v19 offset:320
    ds_read_b64 a[150:151], v19 offset:328
    v_mfma_f32_16x16x32_bf16 v[36:39], a[136:139], a[80:83], v[36:39]
    ds_read_b128 a[104:107], v22 offset:2304
    ds_read_b128 a[108:111], v22 offset:6912
    v_mfma_f32_16x16x32_bf16 v[40:43], a[136:139], a[84:87], v[40:43]
    ds_read_b128 a[112:115], v22 offset:11520
    ds_read_b128 a[116:119], v22 offset:16128
    v_mfma_f32_16x16x32_bf16 v[44:47], a[136:139], a[88:91], v[44:47]
    ds_read_b128 a[120:123], v22 offset:20736
    ds_read_b128 a[124:127], v22 offset:25344
    v_mfma_f32_16x16x32_bf16 v[48:51], a[136:139], a[92:95], v[48:51]
    ds_read_b128 a[128:131], v22 offset:29952
    ds_read_b128 a[132:135], v22 offset:34560
    v_mfma_f32_16x16x32_bf16 v[52:55], a[136:139], a[96:99], v[52:55]
    ds_read_b64_tr_b16 a[24:25], v233 offset:0
    ds_read_b64_tr_b16 a[26:27], v233 offset:1152
    v_mfma_f32_16x16x32_bf16 v[56:59], a[136:139], a[100:103], v[56:59]
    ds_read_b64_tr_b16 a[28:29], v233 offset:4608
    ds_read_b64_tr_b16 a[30:31], v233 offset:5760
    v_mfma_f32_16x16x32_bf16 v[32:35], a[140:143], a[72:75], v[32:35]
    ds_read_b64_tr_b16 a[32:33], v233 offset:9216
    ds_read_b64_tr_b16 a[34:35], v233 offset:10368
    v_mfma_f32_16x16x32_bf16 v[36:39], a[140:143], a[76:79], v[36:39]
    ds_read_b64_tr_b16 a[36:37], v233 offset:13824
    ds_read_b64_tr_b16 a[38:39], v233 offset:14976
    v_mfma_f32_16x16x32_bf16 v[40:43], a[140:143], a[80:83], v[40:43]
    ds_read_b64_tr_b16 a[40:41], v233 offset:18432
    ds_read_b64_tr_b16 a[42:43], v233 offset:19584
    v_mfma_f32_16x16x32_bf16 v[44:47], a[140:143], a[84:87], v[44:47]
    ds_read_b64_tr_b16 a[44:45], v233 offset:23040
    v_mfma_f32_16x16x32_bf16 v[48:51], a[140:143], a[88:91], v[48:51]
    ds_read_b64_tr_b16 a[46:47], v233 offset:24192
    v_mfma_f32_16x16x32_bf16 v[52:55], a[140:143], a[92:95], v[52:55]
    v_mfma_f32_16x16x32_bf16 v[56:59], a[140:143], a[96:99], v[56:59]
    v_mfma_f32_16x16x32_bf16 v[128:131], a[0:3], v[160:163], 0
    ds_read_b64 a[48:49], v2 offset:1280
    ds_read_b64 a[50:51], v2 offset:1288
    v_mfma_f32_16x16x32_bf16 v[132:135], a[4:7], v[160:163], 0
    ds_read_b64 a[52:53], v2 offset:1248
    ds_read_b64 a[54:55], v2 offset:1256
    v_mfma_f32_16x16x32_bf16 v[136:139], a[8:11], v[160:163], 0
    ds_read_b64 a[56:57], v2 offset:1216
    ds_read_b64 a[58:59], v2 offset:1224
    v_mfma_f32_16x16x32_bf16 v[140:143], a[12:15], v[160:163], 0
    ds_read_b64 a[60:61], v2 offset:1376
    ds_read_b64 a[62:63], v2 offset:1384
    v_mfma_f32_16x16x32_bf16 v[132:135], a[0:3], v[164:167], v[132:135]
    ds_read_b64 a[64:65], v2 offset:1344
    v_mfma_f32_16x16x32_bf16 v[136:139], a[4:7], v[164:167], v[136:139]
    ds_read_b64 a[66:67], v2 offset:1352
    v_mfma_f32_16x16x32_bf16 v[140:143], a[8:11], v[164:167], v[140:143]
    ds_read_b64 a[68:69], v2 offset:1312
    v_mfma_f32_16x16x32_bf16 v[136:139], a[0:3], v[168:171], v[136:139]
    ds_read_b64 a[70:71], v2 offset:1320
    v_mfma_f32_16x16x32_bf16 v[140:143], a[4:7], v[168:171], v[140:143]
    v_mfma_f32_16x16x32_bf16 v[140:143], a[0:3], v[172:175], v[140:143]
    s_waitcnt lgkmcnt(15)
    v_mfma_f32_16x16x32_bf16 v[28:31], a[144:147], a[104:107], v[28:31]
    ds_read_b64 a[136:137], v19 offset:768
    v_mfma_f32_16x16x32_bf16 v[32:35], a[144:147], a[108:111], v[32:35]
    ds_read_b64 a[138:139], v19 offset:776
    v_mfma_f32_16x16x32_bf16 v[36:39], a[144:147], a[112:115], v[36:39]
    ds_read_b64 a[140:141], v19 offset:256
    v_mfma_f32_16x16x32_bf16 v[40:43], a[144:147], a[116:119], v[40:43]
    ds_read_b64 a[142:143], v19 offset:264
    v_mfma_f32_16x16x32_bf16 v[44:47], a[144:147], a[120:123], v[44:47]
    ds_read_b128 a[72:75], v22 offset:1728
    v_mfma_f32_16x16x32_bf16 v[48:51], a[144:147], a[124:127], v[48:51]
    ds_read_b128 a[76:79], v22 offset:6336
    v_mfma_f32_16x16x32_bf16 v[52:55], a[144:147], a[128:131], v[52:55]
    ds_read_b128 a[80:83], v22 offset:10944
    v_mfma_f32_16x16x32_bf16 v[56:59], a[144:147], a[132:135], v[56:59]
    ds_read_b128 a[84:87], v22 offset:15552
    v_mfma_f32_16x16x32_bf16 v[32:35], a[148:151], a[104:107], v[32:35]
    ds_read_b128 a[88:91], v22 offset:20160
    v_mfma_f32_16x16x32_bf16 v[36:39], a[148:151], a[108:111], v[36:39]
    ds_read_b128 a[92:95], v22 offset:24768
    v_mfma_f32_16x16x32_bf16 v[40:43], a[148:151], a[112:115], v[40:43]
    ds_read_b128 a[96:99], v22 offset:29376
    v_mfma_f32_16x16x32_bf16 v[44:47], a[148:151], a[116:119], v[44:47]
    ds_read_b128 a[100:103], v22 offset:33984
    v_mfma_f32_16x16x32_bf16 v[48:51], a[148:151], a[120:123], v[48:51]
    v_mfma_f32_16x16x32_bf16 v[52:55], a[148:151], a[124:127], v[52:55]
    v_mfma_f32_16x16x32_bf16 v[56:59], a[148:151], a[128:131], v[56:59]
    s_waitcnt lgkmcnt(12)
    v_mfma_f32_16x16x32_bf16 v[64:67], a[0:3], a[48:51], 0
    v_cvt_pk_bf16_f32 v112, v112, v113
    v_cvt_pk_bf16_f32 v113, v114, v115
    v_mfma_f32_16x16x32_bf16 v[88:91], a[24:27], a[60:63], 0
    v_cvt_pk_bf16_f32 v114, v128, v129
    v_cvt_pk_bf16_f32 v115, v130, v131
    v_mfma_f32_16x16x32_bf16 v[68:71], a[4:7], a[48:51], 0
    v_cvt_pk_bf16_f32 v116, v116, v117
    v_cvt_pk_bf16_f32 v117, v118, v119
    v_mfma_f32_16x16x32_bf16 v[92:95], a[28:31], a[60:63], 0
    v_cvt_pk_bf16_f32 v118, v132, v133
    v_cvt_pk_bf16_f32 v119, v134, v135
    v_mfma_f32_16x16x32_bf16 v[72:75], a[8:11], a[48:51], 0
    v_cvt_pk_bf16_f32 v120, v120, v121
    v_cvt_pk_bf16_f32 v121, v122, v123
    v_mfma_f32_16x16x32_bf16 v[96:99], a[32:35], a[60:63], 0
    v_cvt_pk_bf16_f32 v122, v136, v137
    v_cvt_pk_bf16_f32 v123, v138, v139
    v_mfma_f32_16x16x32_bf16 v[76:79], a[12:15], a[48:51], 0
    v_cvt_pk_bf16_f32 v124, v124, v125
    v_cvt_pk_bf16_f32 v125, v126, v127
    v_mfma_f32_16x16x32_bf16 v[100:103], a[36:39], a[60:63], 0
    v_cvt_pk_bf16_f32 v126, v140, v141
    v_cvt_pk_bf16_f32 v127, v142, v143
    v_mfma_f32_16x16x32_bf16 v[80:83], a[16:19], a[48:51], 0
    v_mov_b32_dpp v128, v112 row_shr:1 row_mask:0xf bank_mask:0xf bound_ctrl:0
    v_mov_b32_dpp v129, v113 row_shr:1 row_mask:0xf bank_mask:0xf bound_ctrl:0
    v_mfma_f32_16x16x32_bf16 v[104:107], a[40:43], a[60:63], 0
    v_mov_b32_dpp v130, v114 row_shr:1 row_mask:0xf bank_mask:0xf bound_ctrl:0
    v_mov_b32_dpp v131, v115 row_shr:1 row_mask:0xf bank_mask:0xf bound_ctrl:0
    v_mfma_f32_16x16x32_bf16 v[84:87], a[20:23], a[48:51], 0
    v_mov_b32_dpp v132, v112 row_ror:1 row_mask:0xf bank_mask:0xf
    v_mov_b32_dpp v133, v113 row_ror:1 row_mask:0xf bank_mask:0xf
    v_mfma_f32_16x16x32_bf16 v[108:111], a[44:47], a[60:63], 0
    v_mov_b32_dpp v134, v114 row_ror:1 row_mask:0xf bank_mask:0xf
    v_mov_b32_dpp v135, v115 row_ror:1 row_mask:0xf bank_mask:0xf
    v_mfma_f32_16x16x32_bf16 v[68:71], a[0:3], a[52:55], v[68:71]
    v_mov_b32_dpp v132, v116 row_shr:1 row_mask:0xf bank_mask:0xf
    v_mov_b32_dpp v133, v117 row_shr:1 row_mask:0xf bank_mask:0xf
    v_mfma_f32_16x16x32_bf16 v[92:95], a[24:27], a[64:67], v[92:95]
    v_mov_b32_dpp v134, v118 row_shr:1 row_mask:0xf bank_mask:0xf
    v_mov_b32_dpp v135, v119 row_shr:1 row_mask:0xf bank_mask:0xf
    v_mfma_f32_16x16x32_bf16 v[72:75], a[4:7], a[52:55], v[72:75]
    v_mov_b32_dpp v136, v116 row_ror:1 row_mask:0xf bank_mask:0xf
    v_mov_b32_dpp v137, v117 row_ror:1 row_mask:0xf bank_mask:0xf
    v_mfma_f32_16x16x32_bf16 v[96:99], a[28:31], a[64:67], v[96:99]
    v_mov_b32_dpp v138, v118 row_ror:1 row_mask:0xf bank_mask:0xf
    v_mov_b32_dpp v139, v119 row_ror:1 row_mask:0xf bank_mask:0xf
    v_mfma_f32_16x16x32_bf16 v[76:79], a[8:11], a[52:55], v[76:79]
    v_mov_b32_dpp v136, v120 row_shr:1 row_mask:0xf bank_mask:0xf
    v_mfma_f32_16x16x32_bf16 v[100:103], a[32:35], a[64:67], v[100:103]
    v_mov_b32_dpp v137, v121 row_shr:1 row_mask:0xf bank_mask:0xf
    v_mfma_f32_16x16x32_bf16 v[80:83], a[12:15], a[52:55], v[80:83]
    v_mov_b32_dpp v138, v122 row_shr:1 row_mask:0xf bank_mask:0xf
    v_mfma_f32_16x16x32_bf16 v[104:107], a[36:39], a[64:67], v[104:107]
    v_mov_b32_dpp v139, v123 row_shr:1 row_mask:0xf bank_mask:0xf
    v_mfma_f32_16x16x32_bf16 v[84:87], a[16:19], a[52:55], v[84:87]
    v_mov_b32_dpp v140, v120 row_ror:1 row_mask:0xf bank_mask:0xf
    v_mfma_f32_16x16x32_bf16 v[108:111], a[40:43], a[64:67], v[108:111]
    v_mov_b32_dpp v141, v121 row_ror:1 row_mask:0xf bank_mask:0xf
    v_mfma_f32_16x16x32_bf16 v[72:75], a[0:3], a[56:59], v[72:75]
    v_mov_b32_dpp v142, v122 row_ror:1 row_mask:0xf bank_mask:0xf
    v_mfma_f32_16x16x32_bf16 v[96:99], a[24:27], a[68:71], v[96:99]
    v_mov_b32_dpp v143, v123 row_ror:1 row_mask:0xf bank_mask:0xf
    v_mfma_f32_16x16x32_bf16 v[76:79], a[4:7], a[56:59], v[76:79]
    v_mov_b32_dpp v140, v124 row_shr:1 row_mask:0xf bank_mask:0xf
    v_mfma_f32_16x16x32_bf16 v[100:103], a[28:31], a[68:71], v[100:103]
    v_mov_b32_dpp v141, v125 row_shr:1 row_mask:0xf bank_mask:0xf
    v_mfma_f32_16x16x32_bf16 v[80:83], a[8:11], a[56:59], v[80:83]
    v_mov_b32_dpp v142, v126 row_shr:1 row_mask:0xf bank_mask:0xf
    v_mfma_f32_16x16x32_bf16 v[104:107], a[32:35], a[68:71], v[104:107]
    v_mov_b32_dpp v143, v127 row_shr:1 row_mask:0xf bank_mask:0xf
    v_mfma_f32_16x16x32_bf16 v[84:87], a[12:15], a[56:59], v[84:87]
    v_mfma_f32_16x16x32_bf16 v[108:111], a[36:39], a[68:71], v[108:111]
    s_waitcnt lgkmcnt(0)
    v_mfma_f32_16x16x32_bf16 v[28:31], a[136:139], a[72:75], v[28:31]
    ds_read_b64 a[144:145], v19 offset:704
    v_mfma_f32_16x16x32_bf16 v[32:35], a[136:139], a[76:79], v[32:35]
    ds_read_b64 a[146:147], v19 offset:712
    v_mfma_f32_16x16x32_bf16 v[36:39], a[136:139], a[80:83], v[36:39]
    ds_read_b64 a[148:149], v19 offset:192
    v_mfma_f32_16x16x32_bf16 v[40:43], a[136:139], a[84:87], v[40:43]
    ds_read_b64 a[150:151], v19 offset:200
    v_mfma_f32_16x16x32_bf16 v[44:47], a[136:139], a[88:91], v[44:47]
    ds_read_b128 a[104:107], v22 offset:1152
    v_mfma_f32_16x16x32_bf16 v[48:51], a[136:139], a[92:95], v[48:51]
    ds_read_b128 a[108:111], v22 offset:5760
    v_mfma_f32_16x16x32_bf16 v[52:55], a[136:139], a[96:99], v[52:55]
    ds_read_b128 a[112:115], v22 offset:10368
    v_mfma_f32_16x16x32_bf16 v[56:59], a[136:139], a[100:103], v[56:59]
    ds_read_b128 a[116:119], v22 offset:14976
    v_mfma_f32_16x16x32_bf16 v[32:35], a[140:143], a[72:75], v[32:35]
    ds_read_b128 a[120:123], v22 offset:19584
    v_mfma_f32_16x16x32_bf16 v[36:39], a[140:143], a[76:79], v[36:39]
    ds_read_b128 a[124:127], v22 offset:24192
    v_mfma_f32_16x16x32_bf16 v[40:43], a[140:143], a[80:83], v[40:43]
    ds_read_b128 a[128:131], v22 offset:28800
    v_mfma_f32_16x16x32_bf16 v[44:47], a[140:143], a[84:87], v[44:47]
    ds_read_b128 a[132:135], v22 offset:33408
    v_mfma_f32_16x16x32_bf16 v[48:51], a[140:143], a[88:91], v[48:51]
    v_mfma_f32_16x16x32_bf16 v[52:55], a[140:143], a[92:95], v[52:55]
    v_mfma_f32_16x16x32_bf16 v[56:59], a[140:143], a[96:99], v[56:59]
    v_mfma_f32_16x16x32_bf16 v[44:47], a[252:255], v[112:115], v[44:47]
    v_mfma_f32_16x16x32_bf16 v[48:51], a[252:255], v[116:119], v[48:51]
    v_mfma_f32_16x16x32_bf16 v[52:55], a[252:255], v[120:123], v[52:55]
    v_mfma_f32_16x16x32_bf16 v[56:59], a[252:255], v[124:127], v[56:59]
    v_mfma_f32_16x16x32_bf16 v[44:47], a[248:251], v[128:131], v[44:47]
    v_mfma_f32_16x16x32_bf16 v[48:51], a[248:251], v[132:135], v[48:51]
    v_mfma_f32_16x16x32_bf16 v[52:55], a[248:251], v[136:139], v[52:55]
    v_mfma_f32_16x16x32_bf16 v[56:59], a[248:251], v[140:143], v[56:59]
    s_waitcnt lgkmcnt(0)
    v_mfma_f32_16x16x32_bf16 v[28:31], a[144:147], a[104:107], v[28:31]
    ds_read_b64 a[136:137], v19 offset:640
    ds_read_b64 a[138:139], v19 offset:648
    v_mfma_f32_16x16x32_bf16 v[32:35], a[144:147], a[108:111], v[32:35]
    ds_read_b64 a[140:141], v19 offset:128
    ds_read_b64 a[142:143], v19 offset:136
    v_mfma_f32_16x16x32_bf16 v[36:39], a[144:147], a[112:115], v[36:39]
    ds_read_b128 a[72:75], v22 offset:576
    ds_read_b128 a[76:79], v22 offset:5184
    v_mfma_f32_16x16x32_bf16 v[40:43], a[144:147], a[116:119], v[40:43]
    ds_read_b128 a[80:83], v22 offset:9792
    ds_read_b128 a[84:87], v22 offset:14400
    v_mfma_f32_16x16x32_bf16 v[44:47], a[144:147], a[120:123], v[44:47]
    ds_read_b128 a[88:91], v22 offset:19008
    ds_read_b128 a[92:95], v22 offset:23616
    v_mfma_f32_16x16x32_bf16 v[48:51], a[144:147], a[124:127], v[48:51]
    ds_read_b128 a[96:99], v22 offset:28224
    ds_read_b128 a[100:103], v22 offset:32832
    v_mfma_f32_16x16x32_bf16 v[52:55], a[144:147], a[128:131], v[52:55]
    v_cvt_pk_bf16_f32 v64, v64, v65
    v_cvt_pk_bf16_f32 v65, v66, v67
    v_mfma_f32_16x16x32_bf16 v[56:59], a[144:147], a[132:135], v[56:59]
    v_cvt_pk_bf16_f32 v66, v88, v89
    v_cvt_pk_bf16_f32 v67, v90, v91
    v_mfma_f32_16x16x32_bf16 v[32:35], a[148:151], a[104:107], v[32:35]
    v_cvt_pk_bf16_f32 v68, v68, v69
    v_cvt_pk_bf16_f32 v69, v70, v71
    v_mfma_f32_16x16x32_bf16 v[36:39], a[148:151], a[108:111], v[36:39]
    v_cvt_pk_bf16_f32 v70, v92, v93
    v_cvt_pk_bf16_f32 v71, v94, v95
    v_mfma_f32_16x16x32_bf16 v[40:43], a[148:151], a[112:115], v[40:43]
    v_cvt_pk_bf16_f32 v72, v72, v73
    v_cvt_pk_bf16_f32 v73, v74, v75
    v_mfma_f32_16x16x32_bf16 v[44:47], a[148:151], a[116:119], v[44:47]
    v_cvt_pk_bf16_f32 v74, v96, v97
    v_cvt_pk_bf16_f32 v75, v98, v99
    v_mfma_f32_16x16x32_bf16 v[48:51], a[148:151], a[120:123], v[48:51]
    v_cvt_pk_bf16_f32 v76, v76, v77
    v_cvt_pk_bf16_f32 v77, v78, v79
    v_mfma_f32_16x16x32_bf16 v[52:55], a[148:151], a[124:127], v[52:55]
    v_cvt_pk_bf16_f32 v78, v100, v101
    v_cvt_pk_bf16_f32 v79, v102, v103
    v_mfma_f32_16x16x32_bf16 v[56:59], a[148:151], a[128:131], v[56:59]
    v_cvt_pk_bf16_f32 v80, v80, v81
    v_cvt_pk_bf16_f32 v81, v82, v83
    v_cvt_pk_bf16_f32 v82, v104, v105
    v_cvt_pk_bf16_f32 v83, v106, v107
    v_cvt_pk_bf16_f32 v84, v84, v85
    v_cvt_pk_bf16_f32 v85, v86, v87
    v_cvt_pk_bf16_f32 v86, v108, v109
    v_cvt_pk_bf16_f32 v87, v110, v111
    s_waitcnt lgkmcnt(0)
    v_mfma_f32_16x16x32_bf16 v[28:31], a[136:139], a[72:75], v[28:31]
    ds_read_b64 a[144:145], v19 offset:576
    ds_read_b64 a[146:147], v19 offset:584
    v_mfma_f32_16x16x32_bf16 v[32:35], a[136:139], a[76:79], v[32:35]
    ds_read_b64 a[148:149], v19 offset:64
    ds_read_b64 a[150:151], v19 offset:72
    v_mfma_f32_16x16x32_bf16 v[36:39], a[136:139], a[80:83], v[36:39]
    ds_read_b128 a[104:107], v22 offset:0
    ds_read_b128 a[108:111], v22 offset:4608
    v_mfma_f32_16x16x32_bf16 v[40:43], a[136:139], a[84:87], v[40:43]
    ds_read_b128 a[112:115], v22 offset:9216
    ds_read_b128 a[116:119], v22 offset:13824
    v_mfma_f32_16x16x32_bf16 v[44:47], a[136:139], a[88:91], v[44:47]
    ds_read_b128 a[120:123], v22 offset:18432
    ds_read_b128 a[124:127], v22 offset:23040
    v_mfma_f32_16x16x32_bf16 v[48:51], a[136:139], a[92:95], v[48:51]
    ds_read_b128 a[128:131], v22 offset:27648
    ds_read_b128 a[132:135], v22 offset:32256
    v_mfma_f32_16x16x32_bf16 v[52:55], a[136:139], a[96:99], v[52:55]
    v_mov_b32_dpp v88, v64 row_shr:1 row_mask:0xf bank_mask:0xf bound_ctrl:0
    v_mov_b32_dpp v89, v65 row_shr:1 row_mask:0xf bank_mask:0xf bound_ctrl:0
    v_mfma_f32_16x16x32_bf16 v[56:59], a[136:139], a[100:103], v[56:59]
    v_mov_b32_dpp v90, v66 row_shr:1 row_mask:0xf bank_mask:0xf bound_ctrl:0
    v_mov_b32_dpp v91, v67 row_shr:1 row_mask:0xf bank_mask:0xf bound_ctrl:0
    v_mfma_f32_16x16x32_bf16 v[32:35], a[140:143], a[72:75], v[32:35]
    v_mov_b32_dpp v92, v64 row_ror:1 row_mask:0xf bank_mask:0xf
    v_mov_b32_dpp v93, v65 row_ror:1 row_mask:0xf bank_mask:0xf
    v_mfma_f32_16x16x32_bf16 v[36:39], a[140:143], a[76:79], v[36:39]
    v_mov_b32_dpp v94, v66 row_ror:1 row_mask:0xf bank_mask:0xf
    v_mov_b32_dpp v95, v67 row_ror:1 row_mask:0xf bank_mask:0xf
    v_mfma_f32_16x16x32_bf16 v[40:43], a[140:143], a[80:83], v[40:43]
    v_mov_b32_dpp v92, v68 row_shr:1 row_mask:0xf bank_mask:0xf
    v_mov_b32_dpp v93, v69 row_shr:1 row_mask:0xf bank_mask:0xf
    v_mfma_f32_16x16x32_bf16 v[44:47], a[140:143], a[84:87], v[44:47]
    v_mov_b32_dpp v94, v70 row_shr:1 row_mask:0xf bank_mask:0xf
    v_mov_b32_dpp v95, v71 row_shr:1 row_mask:0xf bank_mask:0xf
    v_mfma_f32_16x16x32_bf16 v[48:51], a[140:143], a[88:91], v[48:51]
    v_mov_b32_dpp v96, v68 row_ror:1 row_mask:0xf bank_mask:0xf
    v_mov_b32_dpp v97, v69 row_ror:1 row_mask:0xf bank_mask:0xf
    v_mfma_f32_16x16x32_bf16 v[52:55], a[140:143], a[92:95], v[52:55]
    v_mov_b32_dpp v98, v70 row_ror:1 row_mask:0xf bank_mask:0xf
    v_mov_b32_dpp v99, v71 row_ror:1 row_mask:0xf bank_mask:0xf
    v_mfma_f32_16x16x32_bf16 v[56:59], a[140:143], a[96:99], v[56:59]
    v_mov_b32_dpp v96, v72 row_shr:1 row_mask:0xf bank_mask:0xf
    v_mov_b32_dpp v97, v73 row_shr:1 row_mask:0xf bank_mask:0xf
    v_mov_b32_dpp v98, v74 row_shr:1 row_mask:0xf bank_mask:0xf
    v_mov_b32_dpp v99, v75 row_shr:1 row_mask:0xf bank_mask:0xf
    s_waitcnt lgkmcnt(0)
    v_mfma_f32_16x16x32_bf16 v[28:31], a[144:147], a[104:107], v[28:31]
    v_mov_b32_dpp v100, v72 row_ror:1 row_mask:0xf bank_mask:0xf
    v_mov_b32_dpp v101, v73 row_ror:1 row_mask:0xf bank_mask:0xf
    v_mfma_f32_16x16x32_bf16 v[32:35], a[144:147], a[108:111], v[32:35]
    v_mov_b32_dpp v102, v74 row_ror:1 row_mask:0xf bank_mask:0xf
    v_mov_b32_dpp v103, v75 row_ror:1 row_mask:0xf bank_mask:0xf
    v_mfma_f32_16x16x32_bf16 v[36:39], a[144:147], a[112:115], v[36:39]
    v_mov_b32_dpp v100, v76 row_shr:1 row_mask:0xf bank_mask:0xf
    v_mov_b32_dpp v101, v77 row_shr:1 row_mask:0xf bank_mask:0xf
    v_mfma_f32_16x16x32_bf16 v[40:43], a[144:147], a[116:119], v[40:43]
    v_mov_b32_dpp v102, v78 row_shr:1 row_mask:0xf bank_mask:0xf
    v_mov_b32_dpp v103, v79 row_shr:1 row_mask:0xf bank_mask:0xf
    v_mfma_f32_16x16x32_bf16 v[44:47], a[144:147], a[120:123], v[44:47]
    v_mov_b32_dpp v104, v76 row_ror:1 row_mask:0xf bank_mask:0xf
    v_mov_b32_dpp v105, v77 row_ror:1 row_mask:0xf bank_mask:0xf
    v_mfma_f32_16x16x32_bf16 v[48:51], a[144:147], a[124:127], v[48:51]
    v_mov_b32_dpp v106, v78 row_ror:1 row_mask:0xf bank_mask:0xf
    v_mov_b32_dpp v107, v79 row_ror:1 row_mask:0xf bank_mask:0xf
    v_mfma_f32_16x16x32_bf16 v[52:55], a[144:147], a[128:131], v[52:55]
    v_mov_b32_dpp v104, v80 row_shr:1 row_mask:0xf bank_mask:0xf
    v_mov_b32_dpp v105, v81 row_shr:1 row_mask:0xf bank_mask:0xf
    v_mfma_f32_16x16x32_bf16 v[56:59], a[144:147], a[132:135], v[56:59]
    v_mov_b32_dpp v106, v82 row_shr:1 row_mask:0xf bank_mask:0xf
    v_mov_b32_dpp v107, v83 row_shr:1 row_mask:0xf bank_mask:0xf
    v_mfma_f32_16x16x32_bf16 v[32:35], a[148:151], a[104:107], v[32:35]
    v_mov_b32_dpp v108, v80 row_ror:1 row_mask:0xf bank_mask:0xf
    v_mov_b32_dpp v109, v81 row_ror:1 row_mask:0xf bank_mask:0xf
    v_mfma_f32_16x16x32_bf16 v[36:39], a[148:151], a[108:111], v[36:39]
    v_mov_b32_dpp v110, v82 row_ror:1 row_mask:0xf bank_mask:0xf
    v_mov_b32_dpp v111, v83 row_ror:1 row_mask:0xf bank_mask:0xf
    v_mfma_f32_16x16x32_bf16 v[40:43], a[148:151], a[112:115], v[40:43]
    v_mov_b32_dpp v108, v84 row_shr:1 row_mask:0xf bank_mask:0xf
    v_mov_b32_dpp v109, v85 row_shr:1 row_mask:0xf bank_mask:0xf
    v_mfma_f32_16x16x32_bf16 v[44:47], a[148:151], a[116:119], v[44:47]
    v_mov_b32_dpp v110, v86 row_shr:1 row_mask:0xf bank_mask:0xf
    v_mfma_f32_16x16x32_bf16 v[48:51], a[148:151], a[120:123], v[48:51]
    v_mov_b32_dpp v111, v87 row_shr:1 row_mask:0xf bank_mask:0xf
    v_mfma_f32_16x16x32_bf16 v[52:55], a[148:151], a[124:127], v[52:55]
    v_mfma_f32_16x16x32_bf16 v[56:59], a[148:151], a[128:131], v[56:59]
    v_mfma_f32_16x16x32_bf16 v[36:39], a[244:247], v[64:67], v[36:39]
    v_mfma_f32_16x16x32_bf16 v[40:43], a[244:247], v[68:71], v[40:43]
    v_mfma_f32_16x16x32_bf16 v[44:47], a[244:247], v[72:75], v[44:47]
    v_mfma_f32_16x16x32_bf16 v[48:51], a[244:247], v[76:79], v[48:51]
    v_mfma_f32_16x16x32_bf16 v[52:55], a[244:247], v[80:83], v[52:55]
    v_mfma_f32_16x16x32_bf16 v[56:59], a[244:247], v[84:87], v[56:59]
    v_mfma_f32_16x16x32_bf16 v[36:39], a[240:243], v[88:91], v[36:39]
    v_mfma_f32_16x16x32_bf16 v[40:43], a[240:243], v[92:95], v[40:43]
    v_mfma_f32_16x16x32_bf16 v[44:47], a[240:243], v[96:99], v[44:47]
    v_mfma_f32_16x16x32_bf16 v[48:51], a[240:243], v[100:103], v[48:51]
    v_mfma_f32_16x16x32_bf16 v[52:55], a[240:243], v[104:107], v[52:55]
    v_mfma_f32_16x16x32_bf16 v[56:59], a[240:243], v[108:111], v[56:59]
    v_add_u32 v22, 16, v22
    v_add_u32 v232, 16, v232
    v_add_u32 v233, 16, v233
    v_cvt_pk_bf16_f32 v176, v28, v29
    v_cvt_pk_bf16_f32 v177, v30, v31
    v_cvt_pk_bf16_f32 v178, v32, v33
    v_cvt_pk_bf16_f32 v179, v34, v35
    v_cvt_pk_bf16_f32 v180, v36, v37
    v_cvt_pk_bf16_f32 v181, v38, v39
    v_cvt_pk_bf16_f32 v182, v40, v41
    v_cvt_pk_bf16_f32 v183, v42, v43
    v_cvt_pk_bf16_f32 v184, v44, v45
    v_cvt_pk_bf16_f32 v185, v46, v47
    v_cvt_pk_bf16_f32 v186, v48, v49
    v_cvt_pk_bf16_f32 v187, v50, v51
    v_cvt_pk_bf16_f32 v188, v52, v53
    v_cvt_pk_bf16_f32 v189, v54, v55
    v_cvt_pk_bf16_f32 v190, v56, v57
    v_cvt_pk_bf16_f32 v191, v58, v59
    v_permlane16_swap_b32 v176, v178
    v_permlane16_swap_b32 v177, v179
    v_permlane16_swap_b32 v180, v182
    v_permlane16_swap_b32 v181, v183
    v_permlane16_swap_b32 v184, v186
    v_permlane16_swap_b32 v185, v187
    v_permlane16_swap_b32 v188, v190
    v_permlane16_swap_b32 v189, v191
    buffer_store_dwordx4 v[176:179], v1, s[16:19], s80 offen offset:0 sc1
    buffer_store_dwordx4 v[180:183], v1, s[16:19], s80 offen offset:1024 sc1
    buffer_store_dwordx4 v[184:187], v1, s[16:19], s80 offen offset:2048 sc1
    buffer_store_dwordx4 v[188:191], v1, s[16:19], s80 offen offset:3072 sc1
    s_setpc_b64 s[6:7]
L_kgen:
    v_mov_b32 v23, 0x3fb8aa3b
    v_mul_f32 v23, s74, v23
    v_exp_f32 v23, v23
    v_lshlrev_b32 v28, 16, v192
    v_and_b32 v29, 0xffff0000, v192
    v_lshlrev_b32 v30, 16, v193
    v_and_b32 v31, 0xffff0000, v193
    v_lshlrev_b32 v32, 16, v194
    v_and_b32 v33, 0xffff0000, v194
    v_lshlrev_b32 v34, 16, v195
    v_and_b32 v35, 0xffff0000, v195
    v_lshlrev_b32 v36, 16, v196
    v_and_b32 v37, 0xffff0000, v196
    v_lshlrev_b32 v38, 16, v197
    v_and_b32 v39, 0xffff0000, v197
    v_cvt_pk_bf16_f32 v23, v23, v23
    v_lshlrev_b32 v23, 16, v23
    v_mul_f32 v28, v28, v23
    v_mul_f32 v29, v29, v23
    v_mul_f32 v30, v30, v23
    v_mul_f32 v31, v31, v23
    v_mul_f32 v28, 0x3fb8aa3b, v28
    v_mul_f32 v29, 0x3fb8aa3b, v29
    v_mul_f32 v30, 0x3e22f983, v30
    v_mul_f32 v31, 0x3e22f983, v31
    v_pk_mul_f32 v[44:45], v[36:37], v[32:33]
    v_pk_mul_f32 v[46:47], v[36:37], v[34:35] neg_lo:[1,0] neg_hi:[1,0]
    v_pk_fma_f32 v[44:45], v[38:39], v[34:35], v[44:45] neg_lo:[1,0,0] neg_hi:[1,0,0]
    v_pk_fma_f32 v[46:47], v[38:39], v[32:33], v[46:47] neg_lo:[1,0,0] neg_hi:[1,0,0]
    v_cvt_pk_f16_f32 v112, v44, v46
    v_cvt_pk_f16_f32 v113, v45, v47
    v_mov_b32 v104, 0x3c00
    v_mov_b32 v105, 0x3c00
    s_mov_b32 m0, s73
    v_fract_f32 v42, v30
    v_exp_f32 v56, v28
    v_mul_f32 v60, 0x43000000, v28
    v_mul_f32 v50, 0x43000000, v30
    v_fract_f32 v43, v31
    v_exp_f32 v57, v29
    v_mul_f32 v61, 0x43000000, v29
    v_mul_f32 v51, 0x43000000, v31
    v_cos_f32 v40, v42
    v_sin_f32 v42, v42
    v_fract_f32 v50, v50
    v_exp_f32 v60, v60
    v_cos_f32 v41, v43
    v_sin_f32 v43, v43
    v_fract_f32 v51, v51
    v_exp_f32 v61, v61
    v_pk_mul_f32 v[40:41], v[40:41], v[56:57]
    v_pk_mul_f32 v[42:43], v[42:43], v[56:57]
    v_cos_f32 v48, v50
    v_sin_f32 v50, v50
    v_cvt_pk_f16_f32 v64, v40, v42
    v_cvt_pk_f16_f32 v65, v41, v43
    v_cos_f32 v49, v51
    v_sin_f32 v51, v51
    v_pk_mul_f32 v[56:57], v[42:43], v[42:43]
    v_pk_add_f32 v[46:47], v[40:41], v[40:41]
    v_pk_mul_f32 v[48:49], v[48:49], v[60:61]
    v_pk_mul_f32 v[50:51], v[50:51], v[60:61]
    v_pk_fma_f32 v[44:45], v[40:41], v[40:41], v[56:57] neg_lo:[0,0,1] neg_hi:[0,0,1]
    v_pk_mul_f32 v[46:47], v[46:47], v[42:43]
    v_cvt_pk_f16_f32 v78, v48, v50
    v_cvt_pk_f16_f32 v79, v49, v51
    v_cvt_pk_f16_f32 v66, v44, v46
    v_cvt_pk_f16_f32 v67, v45, v47
    v_pk_mul_f32 v[60:61], v[50:51], v[50:51]
    v_pk_add_f32 v[54:55], v[48:49], v[48:49]
    v_pk_mul_f32 v[56:57], v[46:47], v[46:47]
    v_pk_add_f32 v[42:43], v[44:45], v[44:45]
    v_pk_fma_f32 v[52:53], v[48:49], v[48:49], v[60:61] neg_lo:[0,0,1] neg_hi:[0,0,1]
    v_pk_mul_f32 v[54:55], v[54:55], v[50:51]
    v_pk_fma_f32 v[40:41], v[44:45], v[44:45], v[56:57] neg_lo:[0,0,1] neg_hi:[0,0,1]
    v_pk_mul_f32 v[42:43], v[42:43], v[46:47]
    v_cvt_pk_f16_f32 v80, v52, v54
    v_cvt_pk_f16_f32 v81, v53, v55
    v_cvt_pk_f16_f32 v70, v40, v42
    v_cvt_pk_f16_f32 v71, v41, v43
    v_pk_mul_f32 v[60:61], v[54:55], v[54:55]
    v_pk_add_f32 v[50:51], v[52:53], v[52:53]
    v_pk_mul_f32 v[56:57], v[42:43], v[42:43]
    v_pk_add_f32 v[46:47], v[40:41], v[40:41]
    v_pk_fma_f32 v[48:49], v[52:53], v[52:53], v[60:61] neg_lo:[0,0,1] neg_hi:[0,0,1]
    v_pk_mul_f32 v[50:51], v[50:51], v[54:55]
    v_pk_fma_f32 v[44:45], v[40:41], v[40:41], v[56:57] neg_lo:[0,0,1] neg_hi:[0,0,1]
    v_pk_mul_f32 v[46:47], v[46:47], v[42:43]
    v_cvt_pk_f16_f32 v84, v48, v50
    v_cvt_pk_f16_f32 v85, v49, v51
    v_cvt_pk_f16_f32 v96, v44, v46
    v_cvt_pk_f16_f32 v97, v45, v47
    v_pk_mul_f32 v[60:61], v[50:51], v[50:51]
    v_pk_add_f32 v[54:55], v[48:49], v[48:49]
    v_pk_mul_f32 v[56:57], v[46:47], v[46:47]
    v_pk_add_f32 v[42:43], v[44:45], v[44:45]
    v_pk_fma_f32 v[52:53], v[48:49], v[48:49], v[60:61] neg_lo:[0,0,1] neg_hi:[0,0,1]
    v_pk_mul_f32 v[54:55], v[54:55], v[50:51]
    v_pk_fma_f32 v[40:41], v[44:45], v[44:45], v[56:57] neg_lo:[0,0,1] neg_hi:[0,0,1]
    v_pk_mul_f32 v[42:43], v[42:43], v[46:47]
    v_cvt_pk_f16_f32 v92, v52, v54
    v_cvt_pk_f16_f32 v93, v53, v55
    v_cvt_pk_f16_f32 v98, v40, v42
    v_cvt_pk_f16_f32 v99, v41, v43
    v_pk_mul_f32 v[60:61], v[54:55], v[54:55]
    v_pk_add_f32 v[50:51], v[52:53], v[52:53]
    v_pk_mul_f32 v[56:57], v[42:43], v[42:43]
    v_pk_add_f32 v[46:47], v[40:41], v[40:41]
    v_pk_fma_f32 v[48:49], v[52:53], v[52:53], v[60:61] neg_lo:[0,0,1] neg_hi:[0,0,1]
    v_pk_mul_f32 v[50:51], v[50:51], v[54:55]
    v_pk_fma_f32 v[44:45], v[40:41], v[40:41], v[56:57] neg_lo:[0,0,1] neg_hi:[0,0,1]
    v_pk_mul_f32 v[46:47], v[46:47], v[42:43]
    v_cvt_pk_f16_f32 v94, v48, v50
    v_cvt_pk_f16_f32 v95, v49, v51
    v_cvt_pk_f16_f32 v100, v44, v46
    v_cvt_pk_f16_f32 v101, v45, v47
    v_pk_mul_f32 v[56:57], v[46:47], v[46:47]
    v_pk_add_f32 v[42:43], v[44:45], v[44:45]
    v_pk_fma_f32 v[40:41], v[44:45], v[44:45], v[56:57] neg_lo:[0,0,1] neg_hi:[0,0,1]
    v_pk_mul_f32 v[42:43], v[42:43], v[46:47]
    v_cvt_pk_f16_f32 v102, v40, v42
    v_cvt_pk_f16_f32 v103, v41, v43
    v_pk_mul_f16 v114, v112, v96 op_sel_hi:[0,1] neg_hi:[1,0]
    v_pk_mul_f16 v68, v66, v64 op_sel_hi:[0,1]
    v_pk_mul_f16 v115, v113, v97 op_sel_hi:[0,1] neg_hi:[1,0]
    v_pk_mul_f16 v69, v67, v65 op_sel_hi:[0,1]
    v_pk_fma_f16 v114, v112, v96, v114 op_sel:[1,1,0] op_sel_hi:[1,0,1]
    v_pk_fma_f16 v68, v66, v64, v68 op_sel:[1,1,0] op_sel_hi:[1,0,1] neg_lo:[1,0,0]
    v_pk_fma_f16 v115, v113, v97, v115 op_sel:[1,1,0] op_sel_hi:[1,0,1]
    v_pk_fma_f16 v69, v67, v65, v69 op_sel:[1,1,0] op_sel_hi:[1,0,1] neg_lo:[1,0,0]
    ds_write_addtid_b32 v112 offset:0
    ds_write_addtid_b32 v113 offset:256
    ds_write_addtid_b32 v104 offset:8448
    ds_write_addtid_b32 v105 offset:8704
    ds_write_addtid_b32 v64 offset:8976
    ds_write_addtid_b32 v65 offset:9232
    ds_write_addtid_b32 v66 offset:9504
    ds_write_addtid_b32 v67 offset:9760
    ds_write_addtid_b32 v70 offset:10560
    ds_write_addtid_b32 v71 offset:10816
    ds_write_addtid_b32 v78 offset:12672
    ds_write_addtid_b32 v79 offset:12928
    ds_write_addtid_b32 v114 offset:528
    ds_write_addtid_b32 v115 offset:784
    ds_write_addtid_b32 v68 offset:10032
    ds_write_addtid_b32 v69 offset:10288
    v_pk_mul_f16 v116, v112, v98 op_sel_hi:[0,1] neg_hi:[1,0]
    v_pk_mul_f16 v118, v114, v98 op_sel_hi:[0,1] neg_hi:[1,0]
    v_pk_mul_f16 v72, v70, v64 op_sel_hi:[0,1]
    v_pk_mul_f16 v74, v70, v66 op_sel_hi:[0,1]
    v_pk_mul_f16 v76, v70, v68 op_sel_hi:[0,1]
    v_pk_mul_f16 v117, v113, v99 op_sel_hi:[0,1] neg_hi:[1,0]
    v_pk_mul_f16 v119, v115, v99 op_sel_hi:[0,1] neg_hi:[1,0]
    v_pk_mul_f16 v73, v71, v65 op_sel_hi:[0,1]
    v_pk_mul_f16 v75, v71, v67 op_sel_hi:[0,1]
    v_pk_mul_f16 v77, v71, v69 op_sel_hi:[0,1]
    v_pk_fma_f16 v116, v112, v98, v116 op_sel:[1,1,0] op_sel_hi:[1,0,1]
    v_pk_fma_f16 v118, v114, v98, v118 op_sel:[1,1,0] op_sel_hi:[1,0,1]
    v_pk_fma_f16 v72, v70, v64, v72 op_sel:[1,1,0] op_sel_hi:[1,0,1] neg_lo:[1,0,0]
    v_pk_fma_f16 v74, v70, v66, v74 op_sel:[1,1,0] op_sel_hi:[1,0,1] neg_lo:[1,0,0]
    v_pk_fma_f16 v76, v70, v68, v76 op_sel:[1,1,0] op_sel_hi:[1,0,1] neg_lo:[1,0,0]
    v_pk_fma_f16 v117, v113, v99, v117 op_sel:[1,1,0] op_sel_hi:[1,0,1]
    v_pk_fma_f16 v119, v115, v99, v119 op_sel:[1,1,0] op_sel_hi:[1,0,1]
    v_pk_fma_f16 v73, v71, v65, v73 op_sel:[1,1,0] op_sel_hi:[1,0,1] neg_lo:[1,0,0]
    v_pk_fma_f16 v75, v71, v67, v75 op_sel:[1,1,0] op_sel_hi:[1,0,1] neg_lo:[1,0,0]
    v_pk_fma_f16 v77, v71, v69, v77 op_sel:[1,1,0] op_sel_hi:[1,0,1] neg_lo:[1,0,0]
    ds_write_addtid_b32 v116 offset:1056
    ds_write_addtid_b32 v117 offset:1312
    ds_write_addtid_b32 v118 offset:1584
    ds_write_addtid_b32 v119 offset:1840
    ds_write_addtid_b32 v72 offset:11088
    ds_write_addtid_b32 v73 offset:11344
    ds_write_addtid_b32 v74 offset:11616
    ds_write_addtid_b32 v75 offset:11872
    ds_write_addtid_b32 v76 offset:12144
    ds_write_addtid_b32 v77 offset:12400
    v_pk_mul_f16 v120, v112, v100 op_sel_hi:[0,1] neg_hi:[1,0]
    v_pk_mul_f16 v122, v114, v100 op_sel_hi:[0,1] neg_hi:[1,0]
    v_pk_mul_f16 v124, v116, v100 op_sel_hi:[0,1] neg_hi:[1,0]
    v_pk_mul_f16 v126, v118, v100 op_sel_hi:[0,1] neg_hi:[1,0]
    v_pk_mul_f16 v40, v78, v64 op_sel_hi:[0,1]
    v_pk_mul_f16 v42, v78, v66 op_sel_hi:[0,1]
    v_pk_mul_f16 v121, v113, v101 op_sel_hi:[0,1] neg_hi:[1,0]
    v_pk_mul_f16 v123, v115, v101 op_sel_hi:[0,1] neg_hi:[1,0]
    v_pk_mul_f16 v125, v117, v101 op_sel_hi:[0,1] neg_hi:[1,0]
    v_pk_mul_f16 v127, v119, v101 op_sel_hi:[0,1] neg_hi:[1,0]
    v_pk_mul_f16 v41, v79, v65 op_sel_hi:[0,1]
    v_pk_mul_f16 v43, v79, v67 op_sel_hi:[0,1]
    v_pk_fma_f16 v120, v112, v100, v120 op_sel:[1,1,0] op_sel_hi:[1,0,1]
    v_pk_fma_f16 v122, v114, v100, v122 op_sel:[1,1,0] op_sel_hi:[1,0,1]
    v_pk_fma_f16 v124, v116, v100, v124 op_sel:[1,1,0] op_sel_hi:[1,0,1]
    v_pk_fma_f16 v126, v118, v100, v126 op_sel:[1,1,0] op_sel_hi:[1,0,1]
    v_pk_fma_f16 v40, v78, v64, v40 op_sel:[1,1,0] op_sel_hi:[1,0,1] neg_lo:[1,0,0]
    v_pk_fma_f16 v42, v78, v66, v42 op_sel:[1,1,0] op_sel_hi:[1,0,1] neg_lo:[1,0,0]
    v_pk_fma_f16 v121, v113, v101, v121 op_sel:[1,1,0] op_sel_hi:[1,0,1]
    v_pk_fma_f16 v123, v115, v101, v123 op_sel:[1,1,0] op_sel_hi:[1,0,1]
    v_pk_fma_f16 v125, v117, v101, v125 op_sel:[1,1,0] op_sel_hi:[1,0,1]
    v_pk_fma_f16 v127, v119, v101, v127 op_sel:[1,1,0] op_sel_hi:[1,0,1]
    v_pk_fma_f16 v41, v79, v65, v41 op_sel:[1,1,0] op_sel_hi:[1,0,1] neg_lo:[1,0,0]
    v_pk_fma_f16 v43, v79, v67, v43 op_sel:[1,1,0] op_sel_hi:[1,0,1] neg_lo:[1,0,0]
    ds_write_addtid_b32 v120 offset:2112
    ds_write_addtid_b32 v121 offset:2368
    ds_write_addtid_b32 v122 offset:2640
    ds_write_addtid_b32 v123 offset:2896
    ds_write_addtid_b32 v124 offset:3168
    ds_write_addtid_b32 v125 offset:3424
    ds_write_addtid_b32 v126 offset:3696
    ds_write_addtid_b32 v127 offset:3952
    ds_write_addtid_b32 v40 offset:13200
    ds_write_addtid_b32 v41 offset:13456
    ds_write_addtid_b32 v42 offset:13728
    ds_write_addtid_b32 v43 offset:13984
    v_pk_mul_f16 v44, v78, v68 op_sel_hi:[0,1]
    v_pk_mul_f16 v46, v78, v70 op_sel_hi:[0,1]
    v_pk_mul_f16 v104, v78, v72 op_sel_hi:[0,1]
    v_pk_mul_f16 v106, v78, v74 op_sel_hi:[0,1]
    v_pk_mul_f16 v108, v78, v76 op_sel_hi:[0,1]
    v_pk_mul_f16 v45, v79, v69 op_sel_hi:[0,1]
    v_pk_mul_f16 v47, v79, v71 op_sel_hi:[0,1]
    v_pk_mul_f16 v105, v79, v73 op_sel_hi:[0,1]
    v_pk_mul_f16 v107, v79, v75 op_sel_hi:[0,1]
    v_pk_mul_f16 v109, v79, v77 op_sel_hi:[0,1]
    v_pk_fma_f16 v44, v78, v68, v44 op_sel:[1,1,0] op_sel_hi:[1,0,1] neg_lo:[1,0,0]
    v_pk_fma_f16 v46, v78, v70, v46 op_sel:[1,1,0] op_sel_hi:[1,0,1] neg_lo:[1,0,0]
    v_pk_fma_f16 v104, v78, v72, v104 op_sel:[1,1,0] op_sel_hi:[1,0,1] neg_lo:[1,0,0]
    v_pk_fma_f16 v106, v78, v74, v106 op_sel:[1,1,0] op_sel_hi:[1,0,1] neg_lo:[1,0,0]
    v_pk_fma_f16 v108, v78, v76, v108 op_sel:[1,1,0] op_sel_hi:[1,0,1] neg_lo:[1,0,0]
    v_pk_fma_f16 v45, v79, v69, v45 op_sel:[1,1,0] op_sel_hi:[1,0,1] neg_lo:[1,0,0]
    v_pk_fma_f16 v47, v79, v71, v47 op_sel:[1,1,0] op_sel_hi:[1,0,1] neg_lo:[1,0,0]
    v_pk_fma_f16 v105, v79, v73, v105 op_sel:[1,1,0] op_sel_hi:[1,0,1] neg_lo:[1,0,0]
    v_pk_fma_f16 v107, v79, v75, v107 op_sel:[1,1,0] op_sel_hi:[1,0,1] neg_lo:[1,0,0]
    v_pk_fma_f16 v109, v79, v77, v109 op_sel:[1,1,0] op_sel_hi:[1,0,1] neg_lo:[1,0,0]
    ds_write_addtid_b32 v44 offset:14256
    ds_write_addtid_b32 v45 offset:14512
    ds_write_addtid_b32 v46 offset:14784
    ds_write_addtid_b32 v47 offset:15040
    ds_write_addtid_b32 v104 offset:15312
    ds_write_addtid_b32 v105 offset:15568
    ds_write_addtid_b32 v106 offset:15840
    ds_write_addtid_b32 v107 offset:16096
    ds_write_addtid_b32 v108 offset:16368
    ds_write_addtid_b32 v109 offset:16624
    v_pk_mul_f16 v40, v112, v102 op_sel_hi:[0,1] neg_hi:[1,0]
    v_pk_mul_f16 v42, v114, v102 op_sel_hi:[0,1] neg_hi:[1,0]
    v_pk_mul_f16 v44, v116, v102 op_sel_hi:[0,1] neg_hi:[1,0]
    v_pk_mul_f16 v46, v118, v102 op_sel_hi:[0,1] neg_hi:[1,0]
    v_pk_mul_f16 v104, v120, v102 op_sel_hi:[0,1] neg_hi:[1,0]
    v_pk_mul_f16 v106, v122, v102 op_sel_hi:[0,1] neg_hi:[1,0]
    v_pk_mul_f16 v108, v124, v102 op_sel_hi:[0,1] neg_hi:[1,0]
    v_pk_mul_f16 v110, v126, v102 op_sel_hi:[0,1] neg_hi:[1,0]
    v_pk_mul_f16 v41, v113, v103 op_sel_hi:[0,1] neg_hi:[1,0]
    v_pk_mul_f16 v43, v115, v103 op_sel_hi:[0,1] neg_hi:[1,0]
    v_pk_mul_f16 v45, v117, v103 op_sel_hi:[0,1] neg_hi:[1,0]
    v_pk_mul_f16 v47, v119, v103 op_sel_hi:[0,1] neg_hi:[1,0]
    v_pk_mul_f16 v105, v121, v103 op_sel_hi:[0,1] neg_hi:[1,0]
    v_pk_mul_f16 v107, v123, v103 op_sel_hi:[0,1] neg_hi:[1,0]
    v_pk_mul_f16 v109, v125, v103 op_sel_hi:[0,1] neg_hi:[1,0]
    v_pk_mul_f16 v111, v127, v103 op_sel_hi:[0,1] neg_hi:[1,0]
    v_pk_fma_f16 v40, v112, v102, v40 op_sel:[1,1,0] op_sel_hi:[1,0,1]
    v_pk_fma_f16 v42, v114, v102, v42 op_sel:[1,1,0] op_sel_hi:[1,0,1]
    v_pk_fma_f16 v44, v116, v102, v44 op_sel:[1,1,0] op_sel_hi:[1,0,1]
    v_pk_fma_f16 v46, v118, v102, v46 op_sel:[1,1,0] op_sel_hi:[1,0,1]
    v_pk_fma_f16 v104, v120, v102, v104 op_sel:[1,1,0] op_sel_hi:[1,0,1]
    v_pk_fma_f16 v106, v122, v102, v106 op_sel:[1,1,0] op_sel_hi:[1,0,1]
    v_pk_fma_f16 v108, v124, v102, v108 op_sel:[1,1,0] op_sel_hi:[1,0,1]
    v_pk_fma_f16 v110, v126, v102, v110 op_sel:[1,1,0] op_sel_hi:[1,0,1]
    v_pk_fma_f16 v41, v113, v103, v41 op_sel:[1,1,0] op_sel_hi:[1,0,1]
    v_pk_fma_f16 v43, v115, v103, v43 op_sel:[1,1,0] op_sel_hi:[1,0,1]
    v_pk_fma_f16 v45, v117, v103, v45 op_sel:[1,1,0] op_sel_hi:[1,0,1]
    v_pk_fma_f16 v47, v119, v103, v47 op_sel:[1,1,0] op_sel_hi:[1,0,1]
    v_pk_fma_f16 v105, v121, v103, v105 op_sel:[1,1,0] op_sel_hi:[1,0,1]
    v_pk_fma_f16 v107, v123, v103, v107 op_sel:[1,1,0] op_sel_hi:[1,0,1]
    v_pk_fma_f16 v109, v125, v103, v109 op_sel:[1,1,0] op_sel_hi:[1,0,1]
    v_pk_fma_f16 v111, v127, v103, v111 op_sel:[1,1,0] op_sel_hi:[1,0,1]
    ds_write_addtid_b32 v40 offset:4224
    ds_write_addtid_b32 v41 offset:4480
    ds_write_addtid_b32 v42 offset:4752
    ds_write_addtid_b32 v43 offset:5008
    ds_write_addtid_b32 v44 offset:5280
    ds_write_addtid_b32 v45 offset:5536
    ds_write_addtid_b32 v46 offset:5808
    ds_write_addtid_b32 v47 offset:6064
    ds_write_addtid_b32 v104 offset:6336
    ds_write_addtid_b32 v105 offset:6592
    ds_write_addtid_b32 v106 offset:6864
    ds_write_addtid_b32 v107 offset:7120
    ds_write_addtid_b32 v108 offset:7392
    ds_write_addtid_b32 v109 offset:7648
    ds_write_addtid_b32 v110 offset:7920
    ds_write_addtid_b32 v111 offset:8176
    ds_read_b128 v[112:115], v11 offset:0
    ds_read_b128 v[144:147], v11 offset:8448
    ds_read_b128 v[116:119], v11 offset:16
    ds_read_b128 v[148:151], v11 offset:8464
    ds_read_b128 v[120:123], v11 offset:32
    ds_read_b128 v[152:155], v11 offset:8480
    ds_read_b128 v[124:127], v11 offset:48
    ds_read_b128 v[156:159], v11 offset:8496
    ds_read_b128 v[128:131], v11 offset:64
    ds_read_b128 v[160:163], v11 offset:8512
    ds_read_b128 v[132:135], v11 offset:80
    ds_read_b128 v[164:167], v11 offset:8528
    ds_read_b128 v[136:139], v11 offset:96
    ds_read_b128 v[168:171], v11 offset:8544
    ds_read_b128 v[140:143], v11 offset:112
    ds_read_b128 v[172:175], v11 offset:8560
    v_pk_mul_f16 v82, v80, v78 op_sel_hi:[0,1]
    v_pk_mul_f16 v86, v84, v78 op_sel_hi:[0,1]
    v_pk_mul_f16 v88, v84, v80 op_sel_hi:[0,1]
    v_pk_mul_f16 v40, v80, v66 op_sel_hi:[0,1]
    v_pk_mul_f16 v42, v80, v70 op_sel_hi:[0,1]
    v_pk_mul_f16 v44, v80, v74 op_sel_hi:[0,1]
    v_pk_mul_f16 v46, v84, v70 op_sel_hi:[0,1]
    v_pk_mul_f16 v83, v81, v79 op_sel_hi:[0,1]
    v_pk_mul_f16 v87, v85, v79 op_sel_hi:[0,1]
    v_pk_mul_f16 v89, v85, v81 op_sel_hi:[0,1]
    v_pk_mul_f16 v41, v81, v67 op_sel_hi:[0,1]
    v_pk_mul_f16 v43, v81, v71 op_sel_hi:[0,1]
    v_pk_mul_f16 v45, v81, v75 op_sel_hi:[0,1]
    v_pk_mul_f16 v47, v85, v71 op_sel_hi:[0,1]
    v_pk_fma_f16 v82, v80, v78, v82 op_sel:[1,1,0] op_sel_hi:[1,0,1] neg_lo:[1,0,0]
    v_pk_fma_f16 v86, v84, v78, v86 op_sel:[1,1,0] op_sel_hi:[1,0,1] neg_lo:[1,0,0]
    v_pk_fma_f16 v88, v84, v80, v88 op_sel:[1,1,0] op_sel_hi:[1,0,1] neg_lo:[1,0,0]
    v_pk_fma_f16 v40, v80, v66, v40 op_sel:[1,1,0] op_sel_hi:[1,0,1] neg_lo:[1,0,0]
    v_pk_fma_f16 v42, v80, v70, v42 op_sel:[1,1,0] op_sel_hi:[1,0,1] neg_lo:[1,0,0]
    v_pk_fma_f16 v44, v80, v74, v44 op_sel:[1,1,0] op_sel_hi:[1,0,1] neg_lo:[1,0,0]
    v_pk_fma_f16 v46, v84, v70, v46 op_sel:[1,1,0] op_sel_hi:[1,0,1] neg_lo:[1,0,0]
    v_pk_fma_f16 v83, v81, v79, v83 op_sel:[1,1,0] op_sel_hi:[1,0,1] neg_lo:[1,0,0]
    v_pk_fma_f16 v87, v85, v79, v87 op_sel:[1,1,0] op_sel_hi:[1,0,1] neg_lo:[1,0,0]
    v_pk_fma_f16 v89, v85, v81, v89 op_sel:[1,1,0] op_sel_hi:[1,0,1] neg_lo:[1,0,0]
    v_pk_fma_f16 v41, v81, v67, v41 op_sel:[1,1,0] op_sel_hi:[1,0,1] neg_lo:[1,0,0]
    v_pk_fma_f16 v43, v81, v71, v43 op_sel:[1,1,0] op_sel_hi:[1,0,1] neg_lo:[1,0,0]
    v_pk_fma_f16 v45, v81, v75, v45 op_sel:[1,1,0] op_sel_hi:[1,0,1] neg_lo:[1,0,0]
    v_pk_fma_f16 v47, v85, v71, v47 op_sel:[1,1,0] op_sel_hi:[1,0,1] neg_lo:[1,0,0]
    ds_write_addtid_b32 v82 offset:2112
    ds_write_addtid_b32 v83 offset:2368
    ds_write_addtid_b32 v86 offset:5280
    ds_write_addtid_b32 v87 offset:5536
    ds_write_addtid_b32 v88 offset:6336
    ds_write_addtid_b32 v89 offset:6592
    ds_write_addtid_b32 v40 offset:528
    ds_write_addtid_b32 v41 offset:784
    ds_write_addtid_b32 v42 offset:1056
    ds_write_addtid_b32 v43 offset:1312
    ds_write_addtid_b32 v44 offset:1584
    ds_write_addtid_b32 v45 offset:1840
    ds_write_addtid_b32 v46 offset:4752
    ds_write_addtid_b32 v47 offset:5008
    ds_write_addtid_b32 v80 offset:0
    ds_write_addtid_b32 v81 offset:256
    ds_write_addtid_b32 v84 offset:4224
    ds_write_addtid_b32 v85 offset:4480
    v_pk_mul_f16 v90, v84, v82 op_sel_hi:[0,1]
    v_pk_mul_f16 v104, v82, v66 op_sel_hi:[0,1]
    v_pk_mul_f16 v106, v82, v70 op_sel_hi:[0,1]
    v_pk_mul_f16 v108, v82, v74 op_sel_hi:[0,1]
    v_pk_mul_f16 v40, v86, v70 op_sel_hi:[0,1]
    v_pk_mul_f16 v42, v88, v70 op_sel_hi:[0,1]
    v_pk_mul_f16 v91, v85, v83 op_sel_hi:[0,1]
    v_pk_mul_f16 v105, v83, v67 op_sel_hi:[0,1]
    v_pk_mul_f16 v107, v83, v71 op_sel_hi:[0,1]
    v_pk_mul_f16 v109, v83, v75 op_sel_hi:[0,1]
    v_pk_mul_f16 v41, v87, v71 op_sel_hi:[0,1]
    v_pk_mul_f16 v43, v89, v71 op_sel_hi:[0,1]
    v_pk_fma_f16 v90, v84, v82, v90 op_sel:[1,1,0] op_sel_hi:[1,0,1] neg_lo:[1,0,0]
    v_pk_fma_f16 v104, v82, v66, v104 op_sel:[1,1,0] op_sel_hi:[1,0,1] neg_lo:[1,0,0]
    v_pk_fma_f16 v106, v82, v70, v106 op_sel:[1,1,0] op_sel_hi:[1,0,1] neg_lo:[1,0,0]
    v_pk_fma_f16 v108, v82, v74, v108 op_sel:[1,1,0] op_sel_hi:[1,0,1] neg_lo:[1,0,0]
    v_pk_fma_f16 v40, v86, v70, v40 op_sel:[1,1,0] op_sel_hi:[1,0,1] neg_lo:[1,0,0]
    v_pk_fma_f16 v42, v88, v70, v42 op_sel:[1,1,0] op_sel_hi:[1,0,1] neg_lo:[1,0,0]
    v_pk_fma_f16 v91, v85, v83, v91 op_sel:[1,1,0] op_sel_hi:[1,0,1] neg_lo:[1,0,0]
    v_pk_fma_f16 v105, v83, v67, v105 op_sel:[1,1,0] op_sel_hi:[1,0,1] neg_lo:[1,0,0]
    v_pk_fma_f16 v107, v83, v71, v107 op_sel:[1,1,0] op_sel_hi:[1,0,1] neg_lo:[1,0,0]
    v_pk_fma_f16 v109, v83, v75, v109 op_sel:[1,1,0] op_sel_hi:[1,0,1] neg_lo:[1,0,0]
    v_pk_fma_f16 v41, v87, v71, v41 op_sel:[1,1,0] op_sel_hi:[1,0,1] neg_lo:[1,0,0]
    v_pk_fma_f16 v43, v89, v71, v43 op_sel:[1,1,0] op_sel_hi:[1,0,1] neg_lo:[1,0,0]
    ds_write_addtid_b32 v90 offset:7392
    ds_write_addtid_b32 v91 offset:7648
    ds_write_addtid_b32 v104 offset:2640
    ds_write_addtid_b32 v105 offset:2896
    ds_write_addtid_b32 v106 offset:3168
    ds_write_addtid_b32 v107 offset:3424
    ds_write_addtid_b32 v108 offset:3696
    ds_write_addtid_b32 v109 offset:3952
    ds_write_addtid_b32 v40 offset:5808
    ds_write_addtid_b32 v41 offset:6064
    ds_write_addtid_b32 v42 offset:6864
    ds_write_addtid_b32 v43 offset:7120
    v_pk_mul_f16 v110, v90, v70 op_sel_hi:[0,1]
    v_pk_mul_f16 v40, v92, v78 op_sel_hi:[0,1]
    v_pk_mul_f16 v42, v92, v80 op_sel_hi:[0,1]
    v_pk_mul_f16 v44, v92, v82 op_sel_hi:[0,1]
    v_pk_mul_f16 v46, v92, v84 op_sel_hi:[0,1]
    v_pk_mul_f16 v104, v92, v86 op_sel_hi:[0,1]
    v_pk_mul_f16 v106, v92, v88 op_sel_hi:[0,1]
    v_pk_mul_f16 v108, v92, v90 op_sel_hi:[0,1]
    v_pk_mul_f16 v111, v91, v71 op_sel_hi:[0,1]
    v_pk_mul_f16 v41, v93, v79 op_sel_hi:[0,1]
    v_pk_mul_f16 v43, v93, v81 op_sel_hi:[0,1]
    v_pk_mul_f16 v45, v93, v83 op_sel_hi:[0,1]
    v_pk_mul_f16 v47, v93, v85 op_sel_hi:[0,1]
    v_pk_mul_f16 v105, v93, v87 op_sel_hi:[0,1]
    v_pk_mul_f16 v107, v93, v89 op_sel_hi:[0,1]
    v_pk_mul_f16 v109, v93, v91 op_sel_hi:[0,1]
    v_pk_fma_f16 v110, v90, v70, v110 op_sel:[1,1,0] op_sel_hi:[1,0,1] neg_lo:[1,0,0]
    v_pk_fma_f16 v40, v92, v78, v40 op_sel:[1,1,0] op_sel_hi:[1,0,1] neg_lo:[1,0,0]
    v_pk_fma_f16 v42, v92, v80, v42 op_sel:[1,1,0] op_sel_hi:[1,0,1] neg_lo:[1,0,0]
    v_pk_fma_f16 v44, v92, v82, v44 op_sel:[1,1,0] op_sel_hi:[1,0,1] neg_lo:[1,0,0]
    v_pk_fma_f16 v46, v92, v84, v46 op_sel:[1,1,0] op_sel_hi:[1,0,1] neg_lo:[1,0,0]
    v_pk_fma_f16 v104, v92, v86, v104 op_sel:[1,1,0] op_sel_hi:[1,0,1] neg_lo:[1,0,0]
    v_pk_fma_f16 v106, v92, v88, v106 op_sel:[1,1,0] op_sel_hi:[1,0,1] neg_lo:[1,0,0]
    v_pk_fma_f16 v108, v92, v90, v108 op_sel:[1,1,0] op_sel_hi:[1,0,1] neg_lo:[1,0,0]
    v_pk_fma_f16 v111, v91, v71, v111 op_sel:[1,1,0] op_sel_hi:[1,0,1] neg_lo:[1,0,0]
    v_pk_fma_f16 v41, v93, v79, v41 op_sel:[1,1,0] op_sel_hi:[1,0,1] neg_lo:[1,0,0]
    v_pk_fma_f16 v43, v93, v81, v43 op_sel:[1,1,0] op_sel_hi:[1,0,1] neg_lo:[1,0,0]
    v_pk_fma_f16 v45, v93, v83, v45 op_sel:[1,1,0] op_sel_hi:[1,0,1] neg_lo:[1,0,0]
    v_pk_fma_f16 v47, v93, v85, v47 op_sel:[1,1,0] op_sel_hi:[1,0,1] neg_lo:[1,0,0]
    v_pk_fma_f16 v105, v93, v87, v105 op_sel:[1,1,0] op_sel_hi:[1,0,1] neg_lo:[1,0,0]
    v_pk_fma_f16 v107, v93, v89, v107 op_sel:[1,1,0] op_sel_hi:[1,0,1] neg_lo:[1,0,0]
    v_pk_fma_f16 v109, v93, v91, v109 op_sel:[1,1,0] op_sel_hi:[1,0,1] neg_lo:[1,0,0]
    ds_write_addtid_b32 v110 offset:7920
    ds_write_addtid_b32 v111 offset:8176
    ds_write_addtid_b32 v40 offset:8976
    ds_write_addtid_b32 v41 offset:9232
    ds_write_addtid_b32 v42 offset:9504
    ds_write_addtid_b32 v43 offset:9760
    ds_write_addtid_b32 v44 offset:10032
    ds_write_addtid_b32 v45 offset:10288
    ds_write_addtid_b32 v46 offset:10560
    ds_write_addtid_b32 v47 offset:10816
    ds_write_addtid_b32 v104 offset:11088
    ds_write_addtid_b32 v105 offset:11344
    ds_write_addtid_b32 v106 offset:11616
    ds_write_addtid_b32 v107 offset:11872
    ds_write_addtid_b32 v108 offset:12144
    ds_write_addtid_b32 v109 offset:12400
    ds_write_addtid_b32 v92 offset:8448
    ds_write_addtid_b32 v93 offset:8704
    ds_write_addtid_b32 v94 offset:12672
    ds_write_addtid_b32 v95 offset:12928
    ds_read_b128 v[28:31], v11 offset:0
    ds_read_b128 v[32:35], v11 offset:16
    ds_read_b128 v[36:39], v11 offset:32
    ds_read_b128 v[40:43], v11 offset:48
    ds_read_b128 v[44:47], v11 offset:64
    ds_read_b128 v[48:51], v11 offset:80
    ds_read_b128 v[52:55], v11 offset:96
    ds_read_b128 v[56:59], v11 offset:112
    s_waitcnt lgkmcnt(8)
    v_mfma_f32_16x16x32_f16 v[176:179], v[144:147], v[112:115], 0
    ds_read_b128 v[60:63], v11 offset:8448
    v_mfma_f32_16x16x32_f16 v[176:179], v[148:151], v[116:119], v[176:179]
    ds_read_b128 v[64:67], v11 offset:8464
    v_mfma_f32_16x16x32_f16 v[176:179], v[152:155], v[120:123], v[176:179]
    ds_read_b128 v[68:71], v11 offset:8480
    v_mfma_f32_16x16x32_f16 v[176:179], v[156:159], v[124:127], v[176:179]
    ds_read_b128 v[72:75], v11 offset:8496
    v_mfma_f32_16x16x32_f16 v[176:179], v[160:163], v[128:131], v[176:179]
    ds_read_b128 v[76:79], v11 offset:8512
    v_mfma_f32_16x16x32_f16 v[176:179], v[164:167], v[132:135], v[176:179]
    ds_read_b128 v[80:83], v11 offset:8528
    v_mfma_f32_16x16x32_f16 v[176:179], v[168:171], v[136:139], v[176:179]
    ds_read_b128 v[84:87], v11 offset:8544
    v_mfma_f32_16x16x32_f16 v[176:179], v[172:175], v[140:143], v[176:179]
    ds_read_b128 v[88:91], v11 offset:8560
    s_waitcnt lgkmcnt(8)
    v_mfma_f32_16x16x32_f16 v[180:183], v[28:31], v[112:115], 0
    v_mfma_f32_16x16x32_f16 v[180:183], v[32:35], v[116:119], v[180:183]
    v_mfma_f32_16x16x32_f16 v[180:183], v[36:39], v[120:123], v[180:183]
    v_mfma_f32_16x16x32_f16 v[180:183], v[40:43], v[124:127], v[180:183]
    v_mfma_f32_16x16x32_f16 v[180:183], v[44:47], v[128:131], v[180:183]
    v_mfma_f32_16x16x32_f16 v[180:183], v[48:51], v[132:135], v[180:183]
    v_mfma_f32_16x16x32_f16 v[180:183], v[52:55], v[136:139], v[180:183]
    v_mfma_f32_16x16x32_f16 v[180:183], v[56:59], v[140:143], v[180:183]
    v_cmp_eq_u32 vcc, 0, v0
    v_mov_b32 v4, s77
    s_nop 0
    v_cndmask_b32 v4, 0, v4, vcc
    v_fma_f32 v176, v176, v23, v4
    v_mul_f32 v177, v177, v23
    v_mul_f32 v178, v178, v23
    v_mul_f32 v179, v179, v23
    v_cvt_pk_bf16_f32 v96, v176, v177
    v_cvt_pk_bf16_f32 v97, v178, v179
    s_waitcnt lgkmcnt(0)
    v_mfma_f32_16x16x32_f16 v[184:187], v[60:63], v[112:115], 0
    v_mfma_f32_16x16x32_f16 v[184:187], v[64:67], v[116:119], v[184:187]
    v_mfma_f32_16x16x32_f16 v[184:187], v[68:71], v[120:123], v[184:187]
    v_mfma_f32_16x16x32_f16 v[184:187], v[72:75], v[124:127], v[184:187]
    v_mfma_f32_16x16x32_f16 v[184:187], v[76:79], v[128:131], v[184:187]
    v_mfma_f32_16x16x32_f16 v[184:187], v[80:83], v[132:135], v[184:187]
    v_mfma_f32_16x16x32_f16 v[184:187], v[84:87], v[136:139], v[184:187]
    v_mfma_f32_16x16x32_f16 v[184:187], v[88:91], v[140:143], v[184:187]
    ds_write_b16 v3, v96
    ds_write_b16_d16_hi v12, v96
    ds_write_b16 v12, v97 offset:264
    ds_write_b16_d16_hi v12, v97 offset:528
    v_mul_f32 v180, v180, v23
    v_mul_f32 v181, v181, v23
    v_mul_f32 v182, v182, v23
    v_mul_f32 v183, v183, v23
    v_cvt_pk_bf16_f32 v98, v180, v181
    v_cvt_pk_bf16_f32 v99, v182, v183
    ds_write_b16 v13, v98
    ds_write_b16_d16_hi v14, v98
    ds_write_b16 v15, v99
    ds_write_b16_d16_hi v16, v99
    ds_write_b32 v9, v24 offset:2616
    v_mul_f32 v184, v184, v23
    v_mul_f32 v185, v185, v23
    v_mul_f32 v186, v186, v23
    v_mul_f32 v187, v187, v23
    v_cvt_pk_bf16_f32 v100, v184, v185
    v_cvt_pk_bf16_f32 v101, v186, v187
    ds_write_b16 v17, v100 offset:2104
    ds_write_b16_d16_hi v17, v100 offset:2136
    ds_write_b16 v17, v101 offset:2168
    ds_write_b16_d16_hi v17, v101 offset:2200
    v_add_u32 v3, s93, v3
    v_add_u32 v9, s93, v9
    v_add_u32 v12, s93, v12
    v_add_u32 v13, s93, v13
    v_add_u32 v14, s93, v14
    v_add_u32 v15, s93, v15
    v_add_u32 v16, s93, v16
    v_add_u32 v17, s93, v17
    v_mov_b32 v192, v198
    v_mov_b32 v198, v199
    v_mov_b32 v193, v200
    v_mov_b32 v200, v201
    v_mov_b32 v194, v202
    v_mov_b32 v202, v203
    v_mov_b32 v195, v204
    v_mov_b32 v204, v205
    v_mov_b32 v196, v206
    v_mov_b32 v206, v207
    v_mov_b32 v197, v208
    v_mov_b32 v208, v209
    s_mov_b32 s74, s75
    s_mov_b32 s75, s76
    s_mov_b32 s77, s78
    s_mov_b32 s78, s79
    s_setpc_b64 s[6:7]
L_slow_5:
    s_mov_b32 s98, 0
L_spin_4:
    buffer_load_dword v248, v249, s[16:19], s4 offen sc1
    s_waitcnt vmcnt(0)
    v_cmp_eq_u32 vcc, 0, v248
    s_nop 1
    s_cbranch_vccz L_ok_3
    s_sleep 4
    s_add_u32 s98, s98, 1
    s_cmp_gt_u32 s98, 0x40000
    s_cbranch_scc1 L_ok_3
    s_and_b32 s32, s98, 31
    s_cbranch_scc1 L_spin_4
    buffer_load_ubyte v248, v0, s[28:31], 0 offen sc1
    s_waitcnt vmcnt(0)
    v_cmp_gt_u32 vcc, 1, v248
    s_nop 1
    s_cbranch_vccnz L_spin_4
    s_branch L_ok_3
L_slow_8:
    s_mov_b32 s98, 0
L_spin_7:
    buffer_load_dwordx4 v[20:23], v240, s[16:19], s94 offen sc1
    s_waitcnt vmcnt(0)
    v_min_u32 v20, v20, v21
    v_min_u32 v20, v20, v22
    v_cmp_gt_u32 vcc, 1, v20
    s_nop 1
    s_cbranch_vccz L_ok_6
    s_sleep 2
    s_add_u32 s98, s98, 1
    s_cmp_lt_u32 s98, 0x40000
    s_cbranch_scc1 L_spin_7
    s_branch L_ok_6
L_slow_11:
    s_mov_b32 s98, 0
L_spin_10:
    buffer_load_dwordx4 v[20:23], v240, s[16:19], s94 offen sc1
    s_waitcnt vmcnt(0)
    v_min_u32 v20, v20, v21
    v_min_u32 v20, v20, v22
    v_cmp_gt_u32 vcc, 2, v20
    s_nop 1
    s_cbranch_vccz L_ok_9
    s_sleep 2
    s_add_u32 s98, s98, 1
    s_cmp_lt_u32 s98, 0x40000
    s_cbranch_scc1 L_spin_10
    s_branch L_ok_9
L_slow_14:
    s_mov_b32 s98, 0
L_spin_13:
    buffer_load_dwordx4 v[20:23], v240, s[16:19], s48 offen sc1
    s_waitcnt vmcnt(0)
    v_min3_u32 v20, v20, v21, v22
    v_cmp_eq_u32 vcc, 0, v20
    s_nop 1
    s_cbranch_vccz L_ok_12
    s_sleep 2
    s_add_u32 s98, s98, 1
    s_cmp_lt_u32 s98, 0x40000
    s_cbranch_scc1 L_spin_13
    s_branch L_ok_12
L_slow_19:
    s_mov_b32 s98, 0
L_spin_18:
    buffer_load_dword v248, v250, s[16:19], s5 offen sc1
    s_waitcnt vmcnt(0)
    v_cmp_eq_u32 vcc, 0, v248
    s_nop 1
    s_cbranch_vccz L_ok_17
    s_sleep 2
    s_add_u32 s98, s98, 1
    s_cmp_lt_u32 s98, 0x40000
    s_cbranch_scc1 L_spin_18
    s_branch L_ok_17
L_slow_22:
    s_mov_b32 s98, 0
L_spin_21:
    s_add_u32 s33, s58, 0
    buffer_load_dwordx4 v[120:123], v1, s[16:19], s33 offen offset:0 sc1
    buffer_load_dwordx4 v[124:127], v1, s[16:19], s33 offen offset:1024 sc1
    buffer_load_dwordx4 v[128:131], v1, s[16:19], s33 offen offset:2048 sc1
    s_add_u32 s33, s58, 3072
    buffer_load_dwordx4 v[132:135], v1, s[16:19], s33 offen offset:0 sc1
    buffer_load_dwordx4 v[136:139], v1, s[16:19], s33 offen offset:1024 sc1
    buffer_load_dwordx4 v[140:143], v1, s[16:19], s33 offen offset:2048 sc1
    s_waitcnt vmcnt(0)
    v_max3_u32 v20, v120, v124, v128
    v_max3_u32 v21, v132, v136, v140
    v_max_u32 v20, v20, v21
    v_cmp_eq_u32 vcc, -1, v20
    s_nop 1
    s_cbranch_vccz L_ok_20
    s_sleep 1
    s_add_u32 s98, s98, 1
    s_cmp_lt_u32 s98, 0x40000
    s_cbranch_scc1 L_spin_21
    s_branch L_ok_20
L_slow_25:
    s_mov_b32 s98, 0
L_spin_24:
    s_add_u32 s34, s58, 6144
    buffer_load_dwordx4 v[228:231], v1, s[16:19], s34 offen offset:0 sc1
    buffer_load_dwordx4 v[232:235], v1, s[16:19], s34 offen offset:1024 sc1
    buffer_load_dwordx4 v[236:239], v1, s[16:19], s34 offen offset:2048 sc1
    s_waitcnt vmcnt(0)
    v_max3_u32 v22, v228, v232, v236
    v_cmp_eq_u32 vcc, -1, v22
    s_nop 1
    s_cbranch_vccz L_ok_23
    s_sleep 1
    s_add_u32 s98, s98, 1
    s_cmp_lt_u32 s98, 0x40000
    s_cbranch_scc1 L_spin_24
    s_branch L_ok_23
L_slow_30:
    s_mov_b32 s98, 0
L_spin_29:
    buffer_load_dword v35, v254, s[16:19], s4 offen sc1
    s_waitcnt vmcnt(0)
    v_cmp_eq_u32 vcc, 0, v35
    s_nop 1
    s_cbranch_vccz L_ok_28
    s_sleep 8
    s_add_u32 s98, s98, 1
    s_cmp_gt_u32 s98, 0x40000
    s_cbranch_scc1 L_ok_28
    s_and_b32 s32, s98, 31
    s_cbranch_scc1 L_spin_29
    buffer_store_byte v43, v24, s[28:31], s66 offen sc1
    buffer_load_ubyte v35, v0, s[28:31], 0 offen sc1
    s_waitcnt vmcnt(0)
    v_cmp_gt_u32 vcc, 1, v35
    s_nop 1
    s_cbranch_vccnz L_spin_29
    s_branch L_ok_28
.p2align 7
L_const:
.short 2616, 2616, 2616, 2616, 2616, 2616, 2616, 2616, 2616, 2616, 2616, 2616, 2616, 2616, 2616, 2616
.short 2616, 2616, 2616, 2616, 2616, 2616, 2616, 2616, 2616, 2616, 920, 920, 920, 1976, 1976, 1976
.short 1976, 1446, 918, 918, 918, 390, 1974, 1974, 1974, 1444, 916, 916, 916, 388, 1972, 1972
.short 1972, 1442, 914, 914, 914, 386, 1970, 1970, 1970, 1440, 912, 912, 912, 384, 1968, 1968
.short 1968, 1438, 910, 910, 910, 382, 1966, 1966, 1966, 1436, 908, 908, 908, 380, 1964, 1964
.short 1964, 1434, 906, 906, 906, 378, 1962, 1962, 1962, 1432, 904, 904, 904, 376, 1960, 1960
.short 1960, 1430, 902, 902, 902, 374, 1958, 1958, 1958, 1428, 900, 900, 900, 372, 1956, 1956
.short 1956, 1426, 898, 898, 898, 370, 1954, 1954, 1954, 1424, 896, 896, 896, 368, 1952, 1952
.short 1952, 1422, 894, 894, 894, 366, 1950, 1950, 1950, 1420, 892, 892, 892, 364, 1948, 1948
.short 1948, 1418, 890, 890, 890, 362, 1946, 1946, 1946, 1416, 888, 888, 888, 360, 1944, 1944
.short 1944, 1414, 886, 886, 886, 358, 1942, 1942, 1942, 1412, 884, 884, 884, 356, 1940, 1940
.short 1940, 1410, 882, 882, 882, 354, 1938, 1938, 1938, 1408, 880, 880, 880, 352, 1936, 1936
.short 1936, 1406, 878, 878, 878, 350, 1934, 1934, 1934, 1404, 876, 876, 876, 348, 1932, 1932
.short 1932, 1402, 874, 874, 874, 346, 1930, 1930, 1930, 1400, 872, 872, 872, 344, 1928, 1928
.short 1928, 1398, 870, 870, 870, 342, 1926, 1926, 1926, 1396, 868, 868, 868, 340, 1924, 1924
.short 1924, 1394, 866, 866, 866, 338, 1922, 1922, 1922, 1392, 864, 864, 864, 336, 1920, 1920
.short 1920, 1390, 862, 862, 862, 334, 1918, 1918, 1918, 1388, 860, 860, 860, 332, 1916, 1916
.short 1916, 1386, 858, 858, 858, 330, 1914, 1914, 1914, 1384, 856, 856, 856, 328, 1912, 1912
.short 1646, 1382, 1118, 854, 590, 326, 62, 1910, 1644, 1380, 1116, 852, 588, 324, 60, 1908
.short 1642, 1378, 1114, 850, 586, 322, 58, 1906, 1640, 1376, 1112, 848, 584, 320, 56, 1904
.short 1638, 1374, 1110, 846, 582, 318, 54, 1902, 1636, 1372, 1108, 844, 580, 316, 52, 1900
.short 1634, 1370, 1106, 842, 578, 314, 50, 1898, 1632, 1368, 1104, 840, 576, 312, 48, 1896
.short 1630, 1366, 1102, 838, 574, 310, 46, 1894, 1628, 1364, 1100, 836, 572, 308, 44, 1892
.short 1626, 1362, 1098, 834, 570, 306, 42, 1890, 1624, 1360, 1096, 832, 568, 304, 40, 1888
.short 1622, 1358, 1094, 830, 566, 302, 38, 1886, 1620, 1356, 1092, 828, 564, 300, 36, 1884
.short 1618, 1354, 1090, 826, 562, 298, 34, 1882, 1616, 1352, 1088, 824, 560, 296, 32, 1880
.short 1614, 1350, 1086, 822, 558, 294, 30, 1878, 1612, 1348, 1084, 820, 556, 292, 28, 1876
.short 1610, 1346, 1082, 818, 554, 290, 26, 1874, 1608, 1344, 1080, 816, 552, 288, 24, 1872
.short 1606, 1342, 1078, 814, 550, 286, 22, 1870, 1604, 1340, 1076, 812, 548, 284, 20, 1868
.short 1602, 1338, 1074, 810, 546, 282, 18, 1866, 1600, 1336, 1072, 808, 544, 280, 16, 1864
.short 1598, 1334, 1070, 806, 542, 278, 14, 1862, 1596, 1332, 1068, 804, 540, 276, 12, 1860
.short 1594, 1330, 1066, 802, 538, 274, 10, 1858, 1592, 1328, 1064, 800, 536, 272, 8, 1856
.short 1590, 1326, 1062, 798, 534, 270, 6, 1854, 1588, 1324, 1060, 796, 532, 268, 4, 1852
.short 1586, 1322, 1058, 794, 530, 266, 2, 1850, 1584, 1320, 1056, 792, 528, 264, 0, 1848
.short 2616, 2616, 2616, 2616, 2616, 2616, 2616, 2616, 2616, 2616, 2616, 2616, 2616, 2616, 2616, 2616
.short 2616, 2616, 2616, 2616, 2616, 2616, 2616, 2616, 2616, 2616, 2616, 2616, 2616, 2616, 2616, 2616
.short 2616, 2616, 2616, 2616, 2616, 2616, 2616, 2616, 2616, 2616, 2616, 2104, 2104, 2616, 2616, 2616
.short 2616, 2616, 2616, 2616, 2616, 2616, 2616, 2616, 2616, 2616, 2616, 2616, 2616, 2616, 2616, 2616
.short 2616, 2616, 2616, 2616, 2616, 2616, 2616, 2616, 2616, 2616, 2616, 2616, 2616, 2616, 2616, 2616
.short 2102, 2098, 2094, 2090, 2086, 2082, 2078, 2074, 2070, 2066, 2062, 2058, 2054, 2050, 2046, 2042
.short 2038, 2034, 2030, 2026, 2022, 2018, 2014, 2010, 2006, 2002, 1998, 1994, 1990, 1986, 1982, 1978
.short 2616, 2616, 2616, 2616, 2616, 2616, 2616, 2616, 2616, 2616, 2616, 2616, 2616, 2616, 2616, 2616
.short 1046, 1042, 1038, 1034, 1030, 1026, 1022, 1018, 1014, 1010, 1006, 1002, 998, 994, 990, 986
.short 982, 978, 974, 970, 966, 962, 958, 954, 950, 946, 942, 938, 934, 930, 926, 922
.short 2616, 2616, 2616, 2616, 2616, 2616, 2616, 2616, 2616, 2616, 2616, 2616, 2616, 2616, 2616, 2616
.short 2104, 2100, 2096, 2092, 2088, 2084, 2080, 2076, 2072, 2068, 2064, 2060, 2056, 2052, 2048, 2044
.short 2040, 2036, 2032, 2028, 2024, 2020, 2016, 2012, 2008, 2004, 2000, 1996, 1992, 1988, 1984, 1980
.short 2616, 2616, 2616, 2616, 2616, 2616, 2616, 2616, 2616, 2616, 2616, 2616, 2616, 2616, 2616, 2616
.short 2616, 1044, 1040, 1036, 1032, 1028, 1024, 1020, 1016, 1012, 1008, 1004, 1000, 996, 992, 988
.short 984, 980, 976, 972, 968, 964, 960, 956, 952, 948, 944, 940, 936, 932, 928, 924
.short 2616, 2616, 2616, 2616, 2616, 2616, 2616, 2616, 2616, 2616, 2616, 2616, 2616, 2616, 2616, 2616
.short 2358, 2354, 2350, 2346, 2342, 2338, 2334, 2330, 2326, 2322, 2318, 2314, 2310, 2306, 2302, 2298
.short 2294, 2290, 2286, 2282, 2278, 2274, 2270, 2266, 2262, 2258, 2254, 2250, 2246, 2242, 2238, 2234
.short 2230, 2226, 2222, 2218, 2214, 2210, 2206, 2202, 2198, 2194, 2190, 2186, 2182, 2178, 2174, 2170
.short 2166, 2162, 2158, 2154, 2150, 2146, 2142, 2138, 2134, 2130, 2126, 2122, 2118, 2114, 2110, 2106
.short 2616, 2616, 2616, 2616, 2616, 2616, 2616, 2616, 2616, 2616, 2616, 2616, 2616, 2616, 2616, 2616
.short 2616, 2616, 2616, 2616, 2616, 2616, 2616, 2616, 2616, 2616, 2616, 2616, 2616, 2616, 2616, 2616
.short 2360, 2356, 2352, 2348, 2344, 2340, 2336, 2332, 2328, 2324, 2320, 2316, 2312, 2308, 2304, 2300
.short 2296, 2292, 2288, 2284, 2280, 2276, 2272, 2268, 2264, 2260, 2256, 2252, 2248, 2244, 2240, 2236
.short 2232, 2228, 2224, 2220, 2216, 2212, 2208, 2204, 2200, 2196, 2192, 2188, 2184, 2180, 2176, 2172
.short 2168, 2164, 2160, 2156, 2152, 2148, 2144, 2140, 2136, 2132, 2128, 2124, 2120, 2116, 2112, 2108
.short 2616, 2616, 2616, 2616, 2616, 2616, 2616, 2616, 2616, 2616, 2616, 2616, 2616, 2616, 2616, 2616
.short 2616, 2616, 2616, 2616, 2616, 2616, 2616, 2616, 2616, 2616, 2616, 2616, 2616, 2616, 2616, 2616
.short 2616, 2616, 2616, 2616, 2616, 2616, 2616, 2616, 2616, 2616, 2616, 2616, 2616, 2616, 2616, 2616
.short 2616, 2616, 2616, 2616, 2616, 2616, 2616, 2616, 2616, 2616, 2616, 2616, 2616, 2616, 2616, 2616
.short 2616, 2616, 2616, 2616, 2616, 2616, 2616, 2616, 2616, 2616, 2616, 2616, 2616, 2616, 2616, 2616
.short 2616, 2616, 2616, 2616, 2616, 2616, 2616, 2616, 2616, 2616, 2616, 2616, 2616, 2616, 2616, 2616
.short 2616, 2616, 2616, 2616, 2616, 2616, 2616, 2616, 2616, 2616, 2616, 2616, 2616, 2616, 2616, 2616
.short 0, 0, 0, 0, 0, 0, 0, 0
.short 0, 0, 0, 0, 0, 0, 0, 0
.short 0, 0, 0, 0, 0, 0, 0, 0
.short 0, 0, 0, 0, 0, 0, 0, 0
.short 0, 0, 0, 0, 0, 0, 0, 0
.short 0, 0, 0, 0, 0, 0, 0, 0
.short 0, 0, 0, 0, 0, 0, 0, 0
.short 0, 0, 0, 0, 0, 0, 0, 0
.short 0, 0, 0, 0, 0, 0, 0, 0
.short 0, 0, 0, 0, 0, 0, 0, 0
.short 0, 0, 0, 0, 0, 0, 0, 0
.short 0, 0, 0, 0, 0, 0, 0, 0
.short 0, 0, 0, 0, 0, 0, 0, 0
.short 0, 0, 0, 0, 0, 0, 0, 0
.short 0, 0, 0, 0, 0, 0, 0, 0
.short 0, 0, 0, 0, 0, 0, 0, 0
.short 0, 0, 0x3f80, 0x3f80, 0, 0, 0, 0x3f80
.short 0, 0, 0, 0x3f80, 0, 0, 0, 0
.short 0, 0, 0, 0, 0, 0, 0, 0
.short 0, 0, 0, 0, 0, 0, 0, 0
.short 0, 0, 0, 0, 0, 0, 0, 0
.short 0, 0, 0, 0, 0, 0, 0, 0
.short 0, 0, 0, 0, 0, 0, 0, 0
.short 0, 0, 0, 0, 0, 0, 0, 0
.short 0, 0, 0, 0, 0, 0, 0, 0
.short 0, 0, 0, 0, 0, 0, 0, 0
.short 0, 0, 0, 0, 0, 0, 0, 0
.short 0, 0, 0, 0, 0, 0, 0, 0
.short 0, 0, 0, 0, 0, 0, 0, 0
.short 0, 0, 0, 0, 0, 0, 0, 0
.short 0, 0, 0, 0, 0, 0, 0, 0
.short 0, 0, 0, 0, 0, 0, 0, 0
.short 0x3f80, 0x3f80, 0x3f80, 0, 0x3f80, 0x3f80, 0, 0
.short 0x3f80, 0x3f80, 0x3f80, 0x3f80, 0x3f80, 0x3f80, 0x3f80, 0
.short 0x3f80, 0x3f80, 0x3f80, 0x3f80, 0, 0x3f80, 0x3f80, 0x3f80
.short 0, 0x3f80, 0x3f80, 0x3f80, 0, 0, 0x3f80, 0x3f80
.short 0, 0, 0x3f80, 0x3f80, 0, 0, 0, 0x3f80
.short 0, 0, 0, 0x3f80, 0, 0, 0, 0
.short 0, 0, 0, 0, 0, 0, 0, 0
.short 0, 0, 0, 0, 0, 0, 0, 0
.short 0, 0, 0, 0, 0, 0, 0, 0
.short 0, 0, 0, 0, 0, 0, 0, 0
.short 0, 0, 0, 0, 0, 0, 0, 0
.short 0, 0, 0, 0, 0, 0, 0, 0
.short 0, 0, 0, 0, 0, 0, 0, 0
.short 0, 0, 0, 0, 0, 0, 0, 0
.short 0, 0, 0, 0, 0, 0, 0, 0
.short 0, 0, 0, 0, 0, 0, 0, 0
.short 0, 0, 0, 0, 0, 0, 0, 0
.short 0, 0, 0, 0, 0, 0, 0, 0
.short 0x3f80, 0, 0, 0, 0, 0, 0, 0
.short 0x3f80, 0x3f80, 0, 0, 0x3f80, 0, 0, 0
.short 0x3f80, 0x3f80, 0x3f80, 0, 0x3f80, 0x3f80, 0, 0
.short 0x3f80, 0x3f80, 0x3f80, 0x3f80, 0x3f80, 0x3f80, 0x3f80, 0
.short 0x3f80, 0x3f80, 0x3f80, 0x3f80, 0, 0x3f80, 0x3f80, 0x3f80
.short 0, 0x3f80, 0x3f80, 0x3f80, 0, 0, 0x3f80, 0x3f80
.short 0, 0, 0x3f80, 0x3f80, 0, 0, 0, 0x3f80
.short 0, 0, 0, 0x3f80, 0, 0, 0, 0
.short 0, 0, 0, 0, 0, 0, 0, 0
.short 0, 0, 0, 0, 0, 0, 0, 0
.short 0, 0, 0, 0, 0, 0, 0, 0
.short 0, 0, 0, 0, 0, 0, 0, 0
.short 0, 0, 0, 0, 0, 0, 0, 0
.short 0, 0, 0, 0, 0, 0, 0, 0
.short 0, 0, 0, 0, 0, 0, 0, 0
.short 0, 0, 0, 0, 0, 0, 0, 0
.short 0, 0, 0, 0, 0, 0, 0, 0
.short 0, 0, 0, 0, 0, 0, 0, 0
.short 0, 0, 0, 0, 0, 0, 0, 0
.short 0, 0, 0, 0, 0, 0, 0, 0
.short 0x3f80, 0, 0, 0, 0, 0, 0, 0
.short 0x3f80, 0x3f80, 0, 0, 0x3f80, 0, 0, 0
.short 0x3f80, 0x3f80, 0x3f80, 0, 0x3f80, 0x3f80, 0, 0
.short 0x3f80, 0x3f80, 0x3f80, 0x3f80, 0x3f80, 0x3f80, 0x3f80, 0
.short 0x3f80, 0x3f80, 0x3f80, 0x3f80, 0, 0x3f80, 0x3f80, 0x3f80
.short 0, 0x3f80, 0x3f80, 0x3f80, 0, 0, 0x3f80, 0x3f80
.short 0, 0, 0x3f80, 0x3f80, 0, 0, 0, 0x3f80
.short 0, 0, 0, 0x3f80, 0, 0, 0, 0
.short 0, 0, 0, 0, 0, 0, 0, 0
.short 0, 0, 0, 0, 0, 0, 0, 0
.short 0, 0, 0, 0, 0, 0, 0, 0
.short 0, 0, 0, 0, 0, 0, 0, 0
.short 0, 0, 0, 0, 0, 0, 0, 0
.short 0, 0, 0, 0, 0, 0, 0, 0
.short 0, 0, 0, 0, 0, 0, 0, 0
.short 0, 0, 0, 0, 0, 0, 0, 0
.short 0, 0, 0, 0, 0, 0, 0, 0
.short 0, 0, 0, 0, 0, 0, 0, 0
.short 0, 0, 0, 0, 0, 0, 0, 0
.short 0, 0, 0, 0, 0, 0, 0, 0
.short 0x3f80, 0, 0, 0, 0, 0, 0, 0
.short 0x3f80, 0x3f80, 0, 0, 0x3f80, 0, 0, 0
.short 0x3f80, 0x3f80, 0x3f80, 0, 0x3f80, 0x3f80, 0, 0
.short 0x3f80, 0x3f80, 0x3f80, 0x3f80, 0x3f80, 0x3f80, 0x3f80, 0
.short 0x3f80, 0x3f80, 0x3f80, 0x3f80, 0, 0x3f80, 0x3f80, 0x3f80
.short 0, 0x3f80, 0x3f80, 0x3f80, 0, 0, 0x3f80, 0x3f80
.short 0, 0, 0, 0, 0, 0, 0, 0
.short 0, 0, 0, 0, 0, 0, 0, 0
.short 0, 0, 0, 0, 0, 0, 0, 0
.short 0, 0, 0, 0, 0, 0, 0, 0
.short 0, 0, 0, 0, 0, 0, 0, 0
.short 0, 0, 0, 0, 0, 0, 0, 0
.short 0, 0, 0, 0, 0, 0, 0, 0
.short 0, 0, 0, 0, 0, 0, 0, 0
.short 0, 0, 0, 0, 0, 0, 0, 0
.short 0, 0, 0, 0, 0, 0, 0, 0
.short 0, 0, 0, 0, 0, 0, 0, 0
.short 0, 0, 0, 0, 0, 0, 0, 0
.short 0, 0, 0, 0, 0, 0, 0, 0
.short 0, 0, 0, 0, 0, 0, 0, 0
.short 0x3f80, 0, 0, 0, 0, 0, 0, 0
.short 0x3f80, 0x3f80, 0, 0, 0x3f80, 0, 0, 0
.short 0, 0, 0, 0, 0, 0, 0, 0
.short 0, 0, 0, 0, 0, 0, 0, 0
.short 0, 0, 0, 0, 0, 0, 0, 0
.short 0, 0, 0, 0, 0, 0, 0, 0
.short 0, 0, 0, 0, 0, 0, 0, 0
.short 0, 0, 0, 0, 0, 0, 0, 0
.short 0, 0, 0, 0, 0, 0, 0, 0
.short 0, 0, 0, 0, 0, 0, 0, 0
.short 0, 0, 0, 0, 0, 0, 0, 0
.short 0, 0, 0, 0, 0, 0, 0, 0
.short 0, 0, 0, 0, 0, 0, 0, 0
.short 0, 0, 0, 0, 0, 0, 0, 0
.short 0, 0, 0, 0, 0, 0, 0, 0
.short 0, 0, 0, 0, 0, 0, 0, 0
.short 0, 0, 0, 0, 0, 0, 0, 0
.short 0, 0, 0, 0, 0, 0, 0, 0
.short 0, 0, 0, 0, 0, 0, 0, 0
.short 0, 0, 0, 0, 0, 0, 0, 0
.short 0, 0, 0, 0, 0, 0, 0, 0
.short 0, 0, 0, 0, 0, 0, 0, 0
.short 0, 0, 0, 0, 0, 0, 0, 0
.short 0, 0, 0, 0, 0, 0, 0, 0
.short 0, 0, 0, 0, 0, 0, 0, 0
.short 0, 0, 0, 0, 0, 0, 0, 0
.short 0, 0, 0, 0, 0, 0, 0, 0
.short 0, 0, 0, 0, 0, 0, 0, 0
.short 0, 0, 0, 0, 0, 0, 0, 0
.short 0, 0, 0, 0, 0, 0, 0, 0
.short 0, 0, 0, 0, 0, 0, 0, 0
.short 0, 0, 0, 0, 0, 0, 0, 0
.short 0, 0, 0, 0, 0, 0, 0, 0
.short 0, 0, 0, 0, 0, 0, 0, 0
.short 0, 0x3f80, 0x3f80, 0x3f80, 0x3f80, 0, 0, 0
.short 0, 0, 0x3f80, 0x3f80, 0, 0x3f80, 0, 0
.short 0, 0, 0, 0x3f80, 0, 0, 0x3f80, 0
.short 0, 0, 0, 0, 0, 0, 0, 0x3f80
.short 0, 0, 0, 0, 0, 0, 0, 0
.short 0, 0, 0, 0, 0, 0, 0, 0
.short 0, 0, 0, 0, 0, 0, 0, 0
.short 0, 0, 0, 0, 0, 0, 0, 0
.short 0, 0, 0, 0, 0, 0, 0, 0
.short 0, 0, 0, 0, 0, 0, 0, 0
.short 0, 0, 0, 0, 0, 0, 0, 0
.short 0, 0, 0, 0, 0, 0, 0, 0
.short 0, 0, 0, 0, 0, 0, 0, 0
.short 0, 0, 0, 0, 0, 0, 0, 0
.short 0, 0, 0, 0, 0, 0, 0, 0
.short 0, 0, 0, 0, 0, 0, 0, 0
.short 0x3f80, 0x3f80, 0x3f80, 0x3f80, 0, 0, 0, 0
.short 0x3f80, 0x3f80, 0x3f80, 0x3f80, 0, 0, 0, 0
.short 0x3f80, 0x3f80, 0x3f80, 0x3f80, 0, 0, 0, 0
.short 0x3f80, 0x3f80, 0x3f80, 0x3f80, 0, 0, 0, 0
.short 0, 0x3f80, 0x3f80, 0x3f80, 0x3f80, 0, 0, 0
.short 0, 0, 0x3f80, 0x3f80, 0, 0x3f80, 0, 0
.short 0, 0, 0, 0x3f80, 0, 0, 0x3f80, 0
.short 0, 0, 0, 0, 0, 0, 0, 0x3f80
.short 0, 0, 0, 0, 0, 0, 0, 0
.short 0, 0, 0, 0, 0, 0, 0, 0
.short 0, 0, 0, 0, 0, 0, 0, 0
.short 0, 0, 0, 0, 0, 0, 0, 0
.short 0, 0, 0, 0, 0, 0, 0, 0
.short 0, 0, 0, 0, 0, 0, 0, 0
.short 0, 0, 0, 0, 0, 0, 0, 0
.short 0, 0, 0, 0, 0, 0, 0, 0
.short 0, 0, 0, 0, 0x3f80, 0, 0, 0
.short 0x3f80, 0, 0, 0, 0, 0x3f80, 0, 0
.short 0x3f80, 0x3f80, 0, 0, 0, 0, 0x3f80, 0
.short 0x3f80, 0x3f80, 0x3f80, 0, 0, 0, 0, 0x3f80
.short 0x3f80, 0x3f80, 0x3f80, 0x3f80, 0, 0, 0, 0
.short 0x3f80, 0x3f80, 0x3f80, 0x3f80, 0, 0, 0, 0
.short 0x3f80, 0x3f80, 0x3f80, 0x3f80, 0, 0, 0, 0
.short 0x3f80, 0x3f80, 0x3f80, 0x3f80, 0, 0, 0, 0
.short 0, 0x3f80, 0x3f80, 0x3f80, 0x3f80, 0, 0, 0
.short 0, 0, 0x3f80, 0x3f80, 0, 0x3f80, 0, 0
.short 0, 0, 0, 0x3f80, 0, 0, 0x3f80, 0
.short 0, 0, 0, 0, 0, 0, 0, 0x3f80
.short 0, 0, 0, 0, 0, 0, 0, 0
.short 0, 0, 0, 0, 0, 0, 0, 0
.short 0, 0, 0, 0, 0, 0, 0, 0
.short 0, 0, 0, 0, 0, 0, 0, 0
.short 0, 0, 0, 0, 0, 0, 0, 0
.short 0, 0, 0, 0, 0, 0, 0, 0
.short 0, 0, 0, 0, 0, 0, 0, 0
.short 0, 0, 0, 0, 0, 0, 0, 0
.short 0, 0, 0, 0, 0x3f80, 0, 0, 0
.short 0x3f80, 0, 0, 0, 0, 0x3f80, 0, 0
.short 0x3f80, 0x3f80, 0, 0, 0, 0, 0x3f80, 0
.short 0x3f80, 0x3f80, 0x3f80, 0, 0, 0, 0, 0x3f80
.short 0x3f80, 0x3f80, 0x3f80, 0x3f80, 0, 0, 0, 0
.short 0x3f80, 0x3f80, 0x3f80, 0x3f80, 0, 0, 0, 0
.short 0x3f80, 0x3f80, 0x3f80, 0x3f80, 0, 0, 0, 0
.short 0x3f80, 0x3f80, 0x3f80, 0x3f80, 0, 0, 0, 0
.short 0, 0x3f80, 0x3f80, 0x3f80, 0x3f80, 0, 0, 0
.short 0, 0, 0x3f80, 0x3f80, 0, 0x3f80, 0, 0
.short 0, 0, 0, 0x3f80, 0, 0, 0x3f80, 0
.short 0, 0, 0, 0, 0, 0, 0, 0x3f80
.short 0, 0, 0, 0, 0, 0, 0, 0
.short 0, 0, 0, 0, 0, 0, 0, 0
.short 0, 0, 0, 0, 0, 0, 0, 0
.short 0, 0, 0, 0, 0, 0, 0, 0
.short 0, 0, 0, 0, 0, 0, 0, 0
.short 0, 0, 0, 0, 0, 0, 0, 0
.short 0, 0, 0, 0, 0, 0, 0, 0
.short 0, 0, 0, 0, 0, 0, 0, 0
.short 0, 0, 0, 0, 0x3f80, 0, 0, 0
.short 0x3f80, 0, 0, 0, 0, 0x3f80, 0, 0
.short 0x3f80, 0x3f80, 0, 0, 0, 0, 0x3f80, 0
.short 0x3f80, 0x3f80, 0x3f80, 0, 0, 0, 0, 0x3f80
.short 0x3f80, 0x3f80, 0x3f80, 0x3f80, 0, 0, 0, 0
.short 0x3f80, 0x3f80, 0x3f80, 0x3f80, 0, 0, 0, 0
.short 0x3f80, 0x3f80, 0x3f80, 0x3f80, 0, 0, 0, 0
.short 0x3f80, 0x3f80, 0x3f80, 0x3f80, 0, 0, 0, 0
.short 0, 0, 0, 0, 0, 0, 0, 0
.short 0, 0, 0, 0, 0, 0, 0, 0
.short 0, 0, 0, 0, 0, 0, 0, 0
.short 0, 0, 0, 0, 0, 0, 0, 0
.short 0, 0, 0, 0, 0, 0, 0, 0
.short 0, 0, 0, 0, 0, 0, 0, 0
.short 0, 0, 0, 0, 0, 0, 0, 0
.short 0, 0, 0, 0, 0, 0, 0, 0
.short 0, 0, 0, 0, 0, 0, 0, 0
.short 0, 0, 0, 0, 0, 0, 0, 0
.short 0, 0, 0, 0, 0, 0, 0, 0
.short 0, 0, 0, 0, 0, 0, 0, 0
.short 0, 0, 0, 0, 0x3f80, 0, 0, 0
.short 0x3f80, 0, 0, 0, 0, 0x3f80, 0, 0
.short 0x3f80, 0x3f80, 0, 0, 0, 0, 0x3f80, 0
.short 0x3f80, 0x3f80, 0x3f80, 0, 0, 0, 0, 0x3f80
.short 0, 0, 0, 0, 0, 0, 0, 0
.short 0, 0, 0, 0, 0, 0, 0, 0
.short 0, 0, 0, 0, 0, 0, 0, 0
.short 0, 0, 0, 0, 0, 0, 0, 0
.short 0, 0, 0, 0, 0, 0, 0, 0
.short 0, 0, 0, 0, 0, 0, 0, 0
.short 0, 0, 0, 0, 0, 0, 0, 0
.short 0, 0, 0, 0, 0, 0, 0, 0
.short 0, 0, 0, 0, 0, 0, 0, 0
.short 0, 0, 0, 0, 0, 0, 0, 0
.short 0, 0, 0, 0, 0, 0, 0, 0
.short 0, 0, 0, 0, 0, 0, 0, 0
.short 0, 0, 0, 0, 0, 0, 0, 0
.short 0, 0, 0, 0, 0, 0, 0, 0
.short 0, 0, 0, 0, 0, 0, 0, 0
.short 0, 0, 0, 0, 0, 0, 0, 0
L_code_end:
.section .rodata,"a"
.p2align 6
.amdhsa_kernel parallel_sum__ssm_conv_s4__dense_activation_relu__prompt_kernel
  .amdhsa_next_free_vgpr 512
  .amdhsa_next_free_sgpr 102
  .amdhsa_accum_offset 256
  .amdhsa_group_segment_fixed_size 0
  .amdhsa_kernarg_size 120
  .amdhsa_user_sgpr_count 2
  .amdhsa_user_sgpr_kernarg_segment_ptr 1
  .amdhsa_system_sgpr_workgroup_id_x 1
.end_amdhsa_kernel
```
